```python
import torch

def _softmax(x, axis=-1):
    return torch.softmax(x, dim=axis)
def _gelu(x):
    return torch.nn.functional.gelu(x, approximate="tanh")
def _silu(x):
    return torch.nn.functional.silu(x)
def _sigmoid(x):
    return torch.sigmoid(x)
def _layernorm(x, axis=-1, eps=1e-5):
    m = x.mean(dim=axis, keepdim=True)
    v = x.var(dim=axis, keepdim=True, unbiased=False)
    return (x - m) / torch.sqrt(v + eps)
def _scatter_add(tgt, idx, src, axis=0):
    return tgt.clone().index_add_(axis, idx, src)
def _segment_sum(src, seg, n):
    out = torch.zeros((n,) + src.shape[1:], dtype=src.dtype)
    return out.index_add_(0, seg, src)
def _pad(x, pw):
    flat = tuple(v for pair in reversed(pw) for v in pair)
    return torch.nn.functional.pad(x, flat)

kernel_name = 'sequential_preLN__sliding_block__dense_activation_relu__prompt'

def setup_inputs():

    _w = (lambda a: (lambda t: t.to(torch.bfloat16) if t.is_floating_point() else t)(torch.as_tensor(a)))
    def _A_setup():
        B, S, D = 1, 2048, 1024
        return {
            "x": _w((lambda *s: torch.randn(*s, dtype=torch.bfloat16) * 0.05)(B, S, D)),
            "wqkv": _w((lambda *s: torch.randn(*s, dtype=torch.bfloat16) * 0.05)(D, 3 * D)),
            "wo": _w((lambda *s: torch.randn(*s, dtype=torch.bfloat16) * 0.05)(D, D)),
        }
    _A_in = _A_setup()

    def _B_setup():
        B, S, D, Dff = 1, 2048, 1024, 3584
        return {
            "x": _w((lambda *s: torch.randn(*s, dtype=torch.bfloat16) * 0.05)(B, S, D)),
            "w1": _w((lambda *s: torch.randn(*s, dtype=torch.bfloat16) * 0.05)(D, Dff)),
            "w2": _w((lambda *s: torch.randn(*s, dtype=torch.bfloat16) * 0.05)(Dff, D)),
        }
    _B_in = _B_setup()

    return {
        "A_x": _A_in["x"],
        "A_wqkv": _A_in["wqkv"],
        "A_wo": _A_in["wo"],
        "B_x": _B_in["x"],
        "B_w1": _B_in["w1"],
        "B_w2": _B_in["w2"],
    }

def reference(A_x, A_wqkv, A_wo, B_x, B_w1, B_w2):
    def _A_ref(x, wqkv, wo):
        B, S, D = x.shape
        H = 32; Dh = D // H; W = 256
        qkv = (lambda x, *d: x.permute(*d))((x @ wqkv).reshape(B, S, 3, H, Dh), 2, 0, 3, 1, 4)
        q, k, v = qkv[0], qkv[1], qkv[2]
        scores = torch.einsum("bhqd,bhkd->bhqk", q, k) * (Dh ** -0.5)
        idx = torch.arange(S)
        mask = (idx[:, None] - idx[None, :] >= 0) & (idx[:, None] - idx[None, :] < W)
        scores = torch.where(mask[None, None], scores, -1e9)
        p = _softmax(scores, axis=-1)
        o = torch.einsum("bhqk,bhkd->bhqd", p, v)
        return (lambda x, *d: x.permute(*d))(o, 0, 2, 1, 3).reshape(B, S, D) @ wo

    def _B_ref(x, w1, w2):
        h = torch.einsum("bsd,df->bsf", x, w1)
        zero = torch.zeros_like(h)
        h = torch.maximum(h, zero)
        return torch.einsum("bsf,fd->bsd", h, w2)

    x = A_x
    h = x + _A_ref(_layernorm(x, axis=-1), A_wqkv, A_wo)
    h2 = h + _B_ref(_layernorm(h, axis=-1), B_w1, B_w2)
    return h2
```

```asm
; @launch grid=(256,1,1) block=(512,1,1) lds=157696
.amdgcn_target "amdgcn-amd-amdhsa--gfx950"
.text
.globl sequential_preLN__sliding_block__dense_activation_relu__prompt_kernel
.p2align 8
.type sequential_preLN__sliding_block__dense_activation_relu__prompt_kernel,@function
sequential_preLN__sliding_block__dense_activation_relu__prompt_kernel:
  s_cmp_ge_u32 s2, 256
  s_cbranch_scc1 L_sequential_preLN__sliding_block__dense_activation_relu__prompt_kernel_end
  s_load_dwordx16 s[64:79], s[0:1], 0
  s_load_dwordx2 s[12:13], s[0:1], 64
  s_getpc_b64 s[34:35]
L_sequential_preLN__sliding_block__dense_activation_relu__prompt_kernel_pc0:
  v_lshrrev_b32 v1, 6, v0
  s_nop 0
  v_readfirstlane_b32 s3, v1
  v_and_b32 v1, 63, v0
  s_and_b32 s26, s2, 7
  s_lshr_b32 s27, s2, 3
  s_and_b32 s20, s26, 1
  s_lshl_b32 s20, s20, 3
  s_and_b32 s28, s27, 7
  s_add_u32 s20, s20, s28
  s_lshr_b32 s21, s26, 1
  s_lshl_b32 s21, s21, 2
  s_lshr_b32 s28, s27, 3
  s_add_u32 s21, s21, s28
  s_cmp_ge_u32 s3, 4
  s_cbranch_scc1 L_sequential_preLN__sliding_block__dense_activation_relu__prompt_kernel_L1
  s_setprio 0
  s_waitcnt lgkmcnt(0)
  s_mov_b32 s4, s64
  s_and_b32 s5, s65, 0xffff
  s_mov_b32 s6, 4194304
  s_mov_b32 s7, 0x20000
  s_mov_b32 s8, s66
  s_and_b32 s9, s67, 0xffff
  s_mov_b32 s10, 6291456
  s_mov_b32 s11, 0x20000
  s_mov_b32 s16, s68
  s_and_b32 s17, s69, 0xffff
  s_mov_b32 s18, 2097152
  s_mov_b32 s19, 0x20000
  s_mov_b32 s48, s72
  s_and_b32 s49, s73, 0xffff
  s_mov_b32 s50, 7340032
  s_mov_b32 s51, 0x20000
  s_mov_b32 s52, s74
  s_and_b32 s53, s75, 0xffff
  s_mov_b32 s54, 7340032
  s_mov_b32 s55, 0x20000
  s_mov_b32 s56, s76
  s_and_b32 s57, s77, 0xffff
  s_mov_b32 s58, 4194304
  s_mov_b32 s59, 0x20000
  s_mov_b32 s60, s78
  s_and_b32 s61, s79, 0xffff
  s_mov_b32 s62, 256
  s_mov_b32 s63, 0x20000
  s_and_b32 s13, s13, 0xffff
  s_mov_b32 s14, 268435456
  s_mov_b32 s15, 0x20000
  s_cmp_eq_u32 s3, 1
  s_cbranch_scc0 L_sequential_preLN__sliding_block__dense_activation_relu__prompt_kernel_icp
  s_lshr_b32 s36, s2, 3
  s_lshl_b32 s36, s36, 11
  v_and_b32 v2, 15, v1
  v_lshlrev_b32 v2, 7, v2
  v_add_u32 v2, s36, v2
  v_min_u32 v2, L_sequential_preLN__sliding_block__dense_activation_relu__prompt_kernel_end - L_sequential_preLN__sliding_block__dense_activation_relu__prompt_kernel_pc0, v2
  global_load_dword a88, v2, s[34:35]
L_sequential_preLN__sliding_block__dense_activation_relu__prompt_kernel_icp:
  s_lshl_b32 s46, s20, 4
  s_add_u32 s46, s46, s21
  v_cmp_le_u32 vcc, 60, v1
  v_subrev_u32 v3, 60, v1
  s_nop 0
  v_cndmask_b32 v2, v1, v3, vcc
  v_mul_u32_u24 v3, 3277, v2
  v_lshrrev_b32 v3, 16, v3
  v_mul_u32_u24 v112, 20, v3
  v_sub_u32 v2, v2, v112
  s_lshl_b32 s36, s46, 3
  v_add_u32 v112, s36, v2
  v_lshlrev_b32 v112, 11, v112
  v_lshl_add_u32 v112, v3, 7, v112
  v_lshlrev_b32 v113, 6, v3
  s_lshr_b32 s36, s46, 2
  v_add_u32 v113, s36, v113
  v_mul_u32_u24 v113, 6144, v113
  s_and_b32 s36, s46, 3
  s_mul_i32 s36, s36, 12
  s_sub_u32 s36, s36, 8
  v_add_u32 v114, s36, v2
  v_lshl_add_u32 v113, v114, 7, v113
  v_cmp_gt_u32 vcc, 8, v2
  v_mov_b32 v114, s8
  v_mov_b32 v115, s4
  v_cndmask_b32 v114, v114, v115, vcc
  v_mov_b32 v115, s9
  v_mov_b32 v116, s5
  v_cndmask_b32 v115, v115, v116, vcc
  v_cndmask_b32 v113, v113, v112, vcc
  v_mov_b32 v116, 1179648
  v_mov_b32 v117, 384
  v_cndmask_b32 v116, v116, v117, vcc
  v_add_co_u32 v118, vcc, v114, v113
  s_nop 1
  v_addc_co_u32 v119, vcc, 0, v115, vcc
  s_cmp_eq_u32 s3, 0
  s_cbranch_scc0 L_sequential_preLN__sliding_block__dense_activation_relu__prompt_kernel_b1
  global_load_dword a88, v[118:119], off
  v_add_co_u32 v118, vcc, v118, v116
  s_nop 1
  v_addc_co_u32 v119, vcc, 0, v119, vcc
  global_load_dword a88, v[118:119], off
  v_add_co_u32 v118, vcc, v118, v116
  s_nop 1
  v_addc_co_u32 v119, vcc, 0, v119, vcc
L_sequential_preLN__sliding_block__dense_activation_relu__prompt_kernel_b1:
  v_and_b32 v1, 63, v0
  s_lshr_b32 s26, s3, 1
  s_and_b32 s27, s3, 1
  s_lshl_b32 s28, s26, 13
  s_add_u32 s28, s28, 0
  v_and_b32 v2, 15, v1
  v_lshrrev_b32 v3, 4, v1
  v_lshrrev_b32 v16, 1, v2
  v_xor_b32 v3, v3, v16
  v_lshlrev_b32 v3, 4, v3
  v_lshl_add_u32 v3, v2, 7, v3
  v_add_u32 v4, s28, v3
  v_xor_b32 v5, 64, v4
  v_lshrrev_b32 v2, 4, v1
  v_bfe_u32 v3, v1, 2, 2
  v_lshl_add_u32 v2, v2, 3, v3
  v_bfe_u32 v3, v2, 1, 1
  v_bfe_u32 v16, v2, 3, 1
  v_lshl_or_b32 v3, v16, 1, v3
  v_mul_u32_u24 v2, 384, v2
  v_and_b32 v16, 3, v1
  v_lshlrev_b32 v16, 3, v16
  v_add_u32 v2, v2, v16
  v_add_u32 v2, 16384, v2
  s_cmp_eq_u32 s27, 0
  s_cselect_b32 s28, 0, 2
  s_cselect_b32 s29, 0, 0
  v_xor_b32 v16, s28, v3
  v_lshlrev_b32 v16, 5, v16
  v_add_u32 v16, s29, v16
  v_add_u32 v8, v16, v2
  s_cmp_eq_u32 s27, 0
  s_cselect_b32 s28, 1, 3
  s_cselect_b32 s29, 0, 0
  v_xor_b32 v16, s28, v3
  v_lshlrev_b32 v16, 5, v16
  v_add_u32 v16, s29, v16
  v_add_u32 v9, v16, v2
  v_mov_b32 v16, 0
  v_mov_b32 v17, 0
  v_mov_b32 v18, 0
  v_mov_b32 v19, 0
  v_mov_b32 v20, 0
  v_mov_b32 v21, 0
  v_mov_b32 v22, 0
  v_mov_b32 v23, 0
  v_mov_b32 v24, 0
  v_mov_b32 v25, 0
  v_mov_b32 v26, 0
  v_mov_b32 v27, 0
  v_mov_b32 v28, 0
  v_mov_b32 v29, 0
  v_mov_b32 v30, 0
  v_mov_b32 v31, 0
  v_mov_b32 v32, 0
  v_mov_b32 v33, 0
  v_mov_b32 v34, 0
  v_mov_b32 v35, 0
  v_mov_b32 v36, 0
  v_mov_b32 v37, 0
  v_mov_b32 v38, 0
  v_mov_b32 v39, 0
  v_mov_b32 v40, 0
  v_mov_b32 v41, 0
  v_mov_b32 v42, 0
  v_mov_b32 v43, 0
  v_mov_b32 v44, 0
  v_mov_b32 v45, 0
  v_mov_b32 v46, 0
  v_mov_b32 v47, 0
  v_mov_b32 v48, 0
  v_mov_b32 v49, 0
  v_mov_b32 v50, 0
  v_mov_b32 v51, 0
  v_mov_b32 v52, 0
  v_mov_b32 v53, 0
  v_mov_b32 v54, 0
  v_mov_b32 v55, 0
  v_mov_b32 v56, 0
  v_mov_b32 v57, 0
  v_mov_b32 v58, 0
  v_mov_b32 v59, 0
  v_mov_b32 v60, 0
  v_mov_b32 v61, 0
  v_mov_b32 v62, 0
  v_mov_b32 v63, 0
  v_mov_b32 v64, 0
  v_mov_b32 v65, 0
  v_mov_b32 v66, 0
  v_mov_b32 v67, 0
  v_mov_b32 v68, 0
  v_mov_b32 v69, 0
  v_mov_b32 v70, 0
  v_mov_b32 v71, 0
  v_mov_b32 v72, 0
  v_mov_b32 v73, 0
  v_mov_b32 v74, 0
  v_mov_b32 v75, 0
  v_mov_b32 v76, 0
  v_mov_b32 v77, 0
  v_mov_b32 v78, 0
  v_mov_b32 v79, 0
  v_mov_b32 v80, 0
  v_mov_b32 v81, 0
  v_mov_b32 v82, 0
  v_mov_b32 v83, 0
  v_mov_b32 v84, 0
  v_mov_b32 v85, 0
  v_mov_b32 v86, 0
  v_mov_b32 v87, 0
  v_mov_b32 v88, 0
  v_mov_b32 v89, 0
  v_mov_b32 v90, 0
  v_mov_b32 v91, 0
  v_mov_b32 v92, 0
  v_mov_b32 v93, 0
  v_mov_b32 v94, 0
  v_mov_b32 v95, 0
  v_mov_b32 v96, 0
  v_mov_b32 v97, 0
  v_mov_b32 v98, 0
  v_mov_b32 v99, 0
  v_mov_b32 v100, 0
  v_mov_b32 v101, 0
  v_mov_b32 v102, 0
  v_mov_b32 v103, 0
  v_mov_b32 v104, 0
  v_mov_b32 v105, 0
  v_mov_b32 v106, 0
  v_mov_b32 v107, 0
  v_mov_b32 v108, 0
  v_mov_b32 v109, 0
  v_mov_b32 v110, 0
  v_mov_b32 v111, 0
  s_mov_b32 s23, 0
  s_mov_b32 s33, 0x4000
  v_add_u32 v6, s23, v4
  v_add_u32 v7, s23, v5
  v_add_u32 v12, s23, v8
  v_add_u32 v13, s23, v9
  s_barrier
  ds_read_b64_tr_b16 a[16:17], v12 offset:0
  ds_read_b64_tr_b16 a[18:19], v12 offset:1536
  ds_read_b128 a[0:3], v6 offset:0
  ds_read_b128 a[4:7], v6 offset:2048
  ds_read_b128 a[8:11], v6 offset:4096
  ds_read_b128 a[12:15], v6 offset:6144
  ds_read_b64_tr_b16 a[20:21], v13 offset:0
  ds_read_b64_tr_b16 a[22:23], v13 offset:1536
  ds_read_b64_tr_b16 a[24:25], v12 offset:128
  ds_read_b64_tr_b16 a[26:27], v12 offset:1664
  ds_read_b64_tr_b16 a[28:29], v13 offset:128
  ds_read_b64_tr_b16 a[30:31], v13 offset:1664
  ds_read_b64_tr_b16 a[32:33], v12 offset:256
  ds_read_b64_tr_b16 a[34:35], v12 offset:1792
  ds_read_b64_tr_b16 a[36:37], v13 offset:256
  ds_read_b64_tr_b16 a[38:39], v13 offset:1792
  s_mov_b32 s22, 16
  s_waitcnt lgkmcnt(0)
  .p2align 6
L_sequential_preLN__sliding_block__dense_activation_relu__prompt_kernel_gq_c_loop:
  v_mfma_f32_16x16x32_bf16 v[16:19], a[16:19], a[0:3], v[16:19]
  ds_read_b64_tr_b16 a[56:57], v12 offset:12288
  v_mfma_f32_16x16x32_bf16 v[20:23], a[16:19], a[4:7], v[20:23]
  ds_read_b64_tr_b16 a[58:59], v12 offset:13824
  v_mfma_f32_16x16x32_bf16 v[24:27], a[16:19], a[8:11], v[24:27]
  ds_read_b128 a[40:43], v7 offset:0
  v_mfma_f32_16x16x32_bf16 v[28:31], a[16:19], a[12:15], v[28:31]
  ds_read_b128 a[44:47], v7 offset:2048
  v_mfma_f32_16x16x32_bf16 v[32:35], a[20:23], a[0:3], v[32:35]
  ds_read_b128 a[48:51], v7 offset:4096
  v_mfma_f32_16x16x32_bf16 v[36:39], a[20:23], a[4:7], v[36:39]
  ds_read_b128 a[52:55], v7 offset:6144
  v_mfma_f32_16x16x32_bf16 v[40:43], a[20:23], a[8:11], v[40:43]
  ds_read_b64_tr_b16 a[60:61], v13 offset:12288
  v_mfma_f32_16x16x32_bf16 v[44:47], a[20:23], a[12:15], v[44:47]
  ds_read_b64_tr_b16 a[62:63], v13 offset:13824
  v_mfma_f32_16x16x32_bf16 v[48:51], a[24:27], a[0:3], v[48:51]
  ds_read_b64_tr_b16 a[64:65], v12 offset:12416
  v_mfma_f32_16x16x32_bf16 v[52:55], a[24:27], a[4:7], v[52:55]
  ds_read_b64_tr_b16 a[66:67], v12 offset:13952
  v_mfma_f32_16x16x32_bf16 v[56:59], a[24:27], a[8:11], v[56:59]
  ds_read_b64_tr_b16 a[68:69], v13 offset:12416
  v_mfma_f32_16x16x32_bf16 v[60:63], a[24:27], a[12:15], v[60:63]
  ds_read_b64_tr_b16 a[70:71], v13 offset:13952
  v_mfma_f32_16x16x32_bf16 v[64:67], a[28:31], a[0:3], v[64:67]
  ds_read_b64_tr_b16 a[72:73], v12 offset:12544
  v_mfma_f32_16x16x32_bf16 v[68:71], a[28:31], a[4:7], v[68:71]
  ds_read_b64_tr_b16 a[74:75], v12 offset:14080
  v_mfma_f32_16x16x32_bf16 v[72:75], a[28:31], a[8:11], v[72:75]
  ds_read_b64_tr_b16 a[76:77], v13 offset:12544
  v_mfma_f32_16x16x32_bf16 v[76:79], a[28:31], a[12:15], v[76:79]
  ds_read_b64_tr_b16 a[78:79], v13 offset:14080
  v_mfma_f32_16x16x32_bf16 v[80:83], a[0:3], a[32:35], v[80:83]
  s_add_u32 s23, s23, 40960
  v_mfma_f32_16x16x32_bf16 v[84:87], a[4:7], a[32:35], v[84:87]
  s_cmp_eq_u32 s23, 122880
  v_mfma_f32_16x16x32_bf16 v[88:91], a[8:11], a[32:35], v[88:91]
  s_cselect_b32 s23, 0, s23
  v_mfma_f32_16x16x32_bf16 v[92:95], a[12:15], a[32:35], v[92:95]
  v_add_u32 v6, s23, v4
  v_mfma_f32_16x16x32_bf16 v[96:99], a[0:3], a[36:39], v[96:99]
  v_add_u32 v7, s23, v5
  v_mfma_f32_16x16x32_bf16 v[100:103], a[4:7], a[36:39], v[100:103]
  v_add_u32 v12, s23, v8
  v_mfma_f32_16x16x32_bf16 v[104:107], a[8:11], a[36:39], v[104:107]
  v_add_u32 v13, s23, v9
  v_mfma_f32_16x16x32_bf16 v[108:111], a[12:15], a[36:39], v[108:111]
  s_bitcmp1_b32 s33, s22
  s_cbranch_scc1 L_sequential_preLN__sliding_block__dense_activation_relu__prompt_kernel_gq_side
L_sequential_preLN__sliding_block__dense_activation_relu__prompt_kernel_gq_back:
  s_waitcnt lgkmcnt(0)
  s_barrier
  v_mfma_f32_16x16x32_bf16 v[16:19], a[56:59], a[40:43], v[16:19]
  ds_read_b64_tr_b16 a[16:17], v12 offset:0
  v_mfma_f32_16x16x32_bf16 v[20:23], a[56:59], a[44:47], v[20:23]
  ds_read_b64_tr_b16 a[18:19], v12 offset:1536
  v_mfma_f32_16x16x32_bf16 v[24:27], a[56:59], a[48:51], v[24:27]
  ds_read_b128 a[0:3], v6 offset:0
  v_mfma_f32_16x16x32_bf16 v[28:31], a[56:59], a[52:55], v[28:31]
  ds_read_b128 a[4:7], v6 offset:2048
  v_mfma_f32_16x16x32_bf16 v[32:35], a[60:63], a[40:43], v[32:35]
  ds_read_b128 a[8:11], v6 offset:4096
  v_mfma_f32_16x16x32_bf16 v[36:39], a[60:63], a[44:47], v[36:39]
  ds_read_b128 a[12:15], v6 offset:6144
  v_mfma_f32_16x16x32_bf16 v[40:43], a[60:63], a[48:51], v[40:43]
  ds_read_b64_tr_b16 a[20:21], v13 offset:0
  v_mfma_f32_16x16x32_bf16 v[44:47], a[60:63], a[52:55], v[44:47]
  ds_read_b64_tr_b16 a[22:23], v13 offset:1536
  v_mfma_f32_16x16x32_bf16 v[48:51], a[64:67], a[40:43], v[48:51]
  ds_read_b64_tr_b16 a[24:25], v12 offset:128
  v_mfma_f32_16x16x32_bf16 v[52:55], a[64:67], a[44:47], v[52:55]
  ds_read_b64_tr_b16 a[26:27], v12 offset:1664
  v_mfma_f32_16x16x32_bf16 v[56:59], a[64:67], a[48:51], v[56:59]
  ds_read_b64_tr_b16 a[28:29], v13 offset:128
  v_mfma_f32_16x16x32_bf16 v[60:63], a[64:67], a[52:55], v[60:63]
  ds_read_b64_tr_b16 a[30:31], v13 offset:1664
  v_mfma_f32_16x16x32_bf16 v[64:67], a[68:71], a[40:43], v[64:67]
  ds_read_b64_tr_b16 a[32:33], v12 offset:256
  v_mfma_f32_16x16x32_bf16 v[68:71], a[68:71], a[44:47], v[68:71]
  ds_read_b64_tr_b16 a[34:35], v12 offset:1792
  v_mfma_f32_16x16x32_bf16 v[72:75], a[68:71], a[48:51], v[72:75]
  ds_read_b64_tr_b16 a[36:37], v13 offset:256
  v_mfma_f32_16x16x32_bf16 v[76:79], a[68:71], a[52:55], v[76:79]
  ds_read_b64_tr_b16 a[38:39], v13 offset:1792
  v_mfma_f32_16x16x32_bf16 v[80:83], a[40:43], a[72:75], v[80:83]
  s_sub_u32 s22, s22, 1
  v_mfma_f32_16x16x32_bf16 v[84:87], a[44:47], a[72:75], v[84:87]
  v_mfma_f32_16x16x32_bf16 v[88:91], a[48:51], a[72:75], v[88:91]
  v_mfma_f32_16x16x32_bf16 v[92:95], a[52:55], a[72:75], v[92:95]
  v_mfma_f32_16x16x32_bf16 v[96:99], a[40:43], a[76:79], v[96:99]
  s_cmp_lg_u32 s22, 0
  v_mfma_f32_16x16x32_bf16 v[100:103], a[44:47], a[76:79], v[100:103]
  v_mfma_f32_16x16x32_bf16 v[104:107], a[48:51], a[76:79], v[104:107]
  v_mfma_f32_16x16x32_bf16 v[108:111], a[52:55], a[76:79], v[108:111]
  s_waitcnt lgkmcnt(0)
  s_cbranch_scc1 L_sequential_preLN__sliding_block__dense_activation_relu__prompt_kernel_gq_c_loop
  s_branch L_sequential_preLN__sliding_block__dense_activation_relu__prompt_kernel_gq_done
L_sequential_preLN__sliding_block__dense_activation_relu__prompt_kernel_gq_side:
  s_cmp_eq_u32 s3, 0
  s_cbranch_scc0 L_sequential_preLN__sliding_block__dense_activation_relu__prompt_kernel_b21
  global_load_dword a88, v[118:119], off
  v_add_co_u32 v118, vcc, v118, v116
  s_nop 1
  v_addc_co_u32 v119, vcc, 0, v119, vcc
  global_load_dword a88, v[118:119], off
  v_add_co_u32 v118, vcc, v118, v116
  s_nop 1
  v_addc_co_u32 v119, vcc, 0, v119, vcc
  global_load_dword a88, v[118:119], off
  v_add_co_u32 v118, vcc, v118, v116
  s_nop 1
  v_addc_co_u32 v119, vcc, 0, v119, vcc
  s_mov_b64 exec, 0xfffff
  global_load_dword a88, v[118:119], off
  s_mov_b64 exec, -1
L_sequential_preLN__sliding_block__dense_activation_relu__prompt_kernel_b21:
  s_branch L_sequential_preLN__sliding_block__dense_activation_relu__prompt_kernel_gq_back
L_sequential_preLN__sliding_block__dense_activation_relu__prompt_kernel_gq_done:
  s_lshr_b32 s26, s3, 1
  s_and_b32 s27, s3, 1
  v_and_b32 v14, 15, v1
  v_lshrrev_b32 v15, 4, v1
  s_lshl_b32 s28, s26, 9
  s_add_u32 s28, s28, 155648
  v_lshl_add_u32 v10, v14, 3, s28
  ds_read_b64 v[2:3], v10 offset:0
  ds_read_b64 v[4:5], v10 offset:128
  ds_read_b64 v[6:7], v10 offset:256
  ds_read_b64 v[8:9], v10 offset:384
  s_lshl_b32 s29, s27, 7
  s_add_u32 s29, s29, 156672
  v_lshl_add_u32 v11, v15, 4, s29
  v_lshl_add_u32 v12, v14, 2, s29
  v_lshl_add_u32 v13, v15, 5, s28
  v_lshlrev_b32 v14, 4, v1
  s_lshl_b32 s30, s21, 1
  s_add_u32 s30, s30, s27
  s_lshl_b32 s31, s30, 17
  s_lshl_b32 s28, s20, 13
  s_add_u32 s31, s31, s28
  s_lshl_b32 s28, s26, 12
  s_add_u32 s31, s31, s28
  s_mul_i32 s36, s27, 24576
  s_lshl_b32 s37, s26, 12
  s_add_u32 s36, s36, s37
  s_add_u32 s36, s36, 32768
  s_lshl_b32 s38, s27, 13
  s_add_u32 s38, s38, s37
  s_add_u32 s38, s38, 0
  s_mul_i32 s39, s27, 24576
  s_lshl_b32 s37, s26, 11
  s_add_u32 s39, s39, s37
  s_add_u32 s39, s39, 73728
  ds_read_b128 v[112:115], v11 offset:256
  ds_read_b128 v[116:119], v11 offset:320
  v_add_u32 v15, s36, v14
  s_waitcnt lgkmcnt(0)
  v_fmac_f32 v48, v112, v2
  v_fmac_f32 v49, v113, v2
  v_fmac_f32 v50, v114, v2
  v_fmac_f32 v51, v115, v2
  v_mul_f32 v48, v48, v3
  v_mul_f32 v49, v49, v3
  v_mul_f32 v50, v50, v3
  v_mul_f32 v51, v51, v3
  v_cvt_pk_bf16_f32 v120, v48, v49
  v_cvt_pk_bf16_f32 v121, v50, v51
  v_fmac_f32 v64, v116, v2
  v_fmac_f32 v65, v117, v2
  v_fmac_f32 v66, v118, v2
  v_fmac_f32 v67, v119, v2
  v_mul_f32 v64, v64, v3
  v_mul_f32 v65, v65, v3
  v_mul_f32 v66, v66, v3
  v_mul_f32 v67, v67, v3
  v_cvt_pk_bf16_f32 v122, v64, v65
  v_cvt_pk_bf16_f32 v123, v66, v67
  s_add_u32 s28, s31, 8388608
  buffer_store_dwordx4 v[120:123], v14, s[12:15], s28 offen sc1
  ds_write_b128 v15, v[120:123] offset:0
  v_fmac_f32 v52, v112, v4
  v_fmac_f32 v53, v113, v4
  v_fmac_f32 v54, v114, v4
  v_fmac_f32 v55, v115, v4
  v_mul_f32 v52, v52, v5
  v_mul_f32 v53, v53, v5
  v_mul_f32 v54, v54, v5
  v_mul_f32 v55, v55, v5
  v_cvt_pk_bf16_f32 v124, v52, v53
  v_cvt_pk_bf16_f32 v125, v54, v55
  v_fmac_f32 v68, v116, v4
  v_fmac_f32 v69, v117, v4
  v_fmac_f32 v70, v118, v4
  v_fmac_f32 v71, v119, v4
  v_mul_f32 v68, v68, v5
  v_mul_f32 v69, v69, v5
  v_mul_f32 v70, v70, v5
  v_mul_f32 v71, v71, v5
  v_cvt_pk_bf16_f32 v126, v68, v69
  v_cvt_pk_bf16_f32 v127, v70, v71
  s_add_u32 s28, s31, 8389632
  buffer_store_dwordx4 v[124:127], v14, s[12:15], s28 offen sc1
  ds_write_b128 v15, v[124:127] offset:1024
  v_fmac_f32 v56, v112, v6
  v_fmac_f32 v57, v113, v6
  v_fmac_f32 v58, v114, v6
  v_fmac_f32 v59, v115, v6
  v_mul_f32 v56, v56, v7
  v_mul_f32 v57, v57, v7
  v_mul_f32 v58, v58, v7
  v_mul_f32 v59, v59, v7
  v_cvt_pk_bf16_f32 v120, v56, v57
  v_cvt_pk_bf16_f32 v121, v58, v59
  v_fmac_f32 v72, v116, v6
  v_fmac_f32 v73, v117, v6
  v_fmac_f32 v74, v118, v6
  v_fmac_f32 v75, v119, v6
  v_mul_f32 v72, v72, v7
  v_mul_f32 v73, v73, v7
  v_mul_f32 v74, v74, v7
  v_mul_f32 v75, v75, v7
  v_cvt_pk_bf16_f32 v122, v72, v73
  v_cvt_pk_bf16_f32 v123, v74, v75
  s_add_u32 s28, s31, 8390656
  buffer_store_dwordx4 v[120:123], v14, s[12:15], s28 offen sc1
  ds_write_b128 v15, v[120:123] offset:2048
  v_fmac_f32 v60, v112, v8
  v_fmac_f32 v61, v113, v8
  v_fmac_f32 v62, v114, v8
  v_fmac_f32 v63, v115, v8
  v_mul_f32 v60, v60, v9
  v_mul_f32 v61, v61, v9
  v_mul_f32 v62, v62, v9
  v_mul_f32 v63, v63, v9
  v_cvt_pk_bf16_f32 v124, v60, v61
  v_cvt_pk_bf16_f32 v125, v62, v63
  v_fmac_f32 v76, v116, v8
  v_fmac_f32 v77, v117, v8
  v_fmac_f32 v78, v118, v8
  v_fmac_f32 v79, v119, v8
  v_mul_f32 v76, v76, v9
  v_mul_f32 v77, v77, v9
  v_mul_f32 v78, v78, v9
  v_mul_f32 v79, v79, v9
  v_cvt_pk_bf16_f32 v126, v76, v77
  v_cvt_pk_bf16_f32 v127, v78, v79
  s_add_u32 s28, s31, 8391680
  buffer_store_dwordx4 v[124:127], v14, s[12:15], s28 offen sc1
  ds_write_b128 v15, v[124:127] offset:3072
  s_lshl_b32 s31, s30, 17
  s_lshl_b32 s28, s20, 12
  s_add_u32 s31, s31, s28
  s_lshl_b32 s28, s26, 11
  s_add_u32 s31, s31, s28
  ds_read_b32 v10, v12 offset:512
  ds_read_b32 v12, v12 offset:576
  v_add_u32 v15, s39, v14
  ds_read_b128 v[48:51], v13 offset:0
  ds_read_b128 v[52:55], v13 offset:16
  ds_read_b128 v[56:59], v13 offset:128
  ds_read_b128 v[60:63], v13 offset:144
  s_waitcnt lgkmcnt(0)
  v_fmac_f32 v80, v10, v48
  v_fmac_f32 v81, v10, v50
  v_fmac_f32 v82, v10, v52
  v_fmac_f32 v83, v10, v54
  v_mul_f32 v80, v80, v49
  v_mul_f32 v81, v81, v51
  v_mul_f32 v82, v82, v53
  v_mul_f32 v83, v83, v55
  v_cvt_pk_bf16_f32 v120, v80, v81
  v_cvt_pk_bf16_f32 v121, v82, v83
  v_fmac_f32 v84, v10, v56
  v_fmac_f32 v85, v10, v58
  v_fmac_f32 v86, v10, v60
  v_fmac_f32 v87, v10, v62
  v_mul_f32 v84, v84, v57
  v_mul_f32 v85, v85, v59
  v_mul_f32 v86, v86, v61
  v_mul_f32 v87, v87, v63
  v_cvt_pk_bf16_f32 v122, v84, v85
  v_cvt_pk_bf16_f32 v123, v86, v87
  s_add_u32 s28, s31, 12582912
  buffer_store_dwordx4 v[120:123], v14, s[12:15], s28 offen sc1
  ds_write_b128 v15, v[120:123] offset:0
  v_fmac_f32 v96, v12, v48
  v_fmac_f32 v97, v12, v50
  v_fmac_f32 v98, v12, v52
  v_fmac_f32 v99, v12, v54
  v_mul_f32 v96, v96, v49
  v_mul_f32 v97, v97, v51
  v_mul_f32 v98, v98, v53
  v_mul_f32 v99, v99, v55
  v_cvt_pk_bf16_f32 v124, v96, v97
  v_cvt_pk_bf16_f32 v125, v98, v99
  v_fmac_f32 v100, v12, v56
  v_fmac_f32 v101, v12, v58
  v_fmac_f32 v102, v12, v60
  v_fmac_f32 v103, v12, v62
  v_mul_f32 v100, v100, v57
  v_mul_f32 v101, v101, v59
  v_mul_f32 v102, v102, v61
  v_mul_f32 v103, v103, v63
  v_cvt_pk_bf16_f32 v126, v100, v101
  v_cvt_pk_bf16_f32 v127, v102, v103
  s_add_u32 s28, s31, 12648448
  buffer_store_dwordx4 v[124:127], v14, s[12:15], s28 offen sc1
  ds_write_b128 v15, v[124:127] offset:12288
  ds_read_b128 v[48:51], v13 offset:256
  ds_read_b128 v[52:55], v13 offset:272
  ds_read_b128 v[56:59], v13 offset:384
  ds_read_b128 v[60:63], v13 offset:400
  s_waitcnt lgkmcnt(0)
  v_fmac_f32 v88, v10, v48
  v_fmac_f32 v89, v10, v50
  v_fmac_f32 v90, v10, v52
  v_fmac_f32 v91, v10, v54
  v_mul_f32 v88, v88, v49
  v_mul_f32 v89, v89, v51
  v_mul_f32 v90, v90, v53
  v_mul_f32 v91, v91, v55
  v_cvt_pk_bf16_f32 v120, v88, v89
  v_cvt_pk_bf16_f32 v121, v90, v91
  v_fmac_f32 v92, v10, v56
  v_fmac_f32 v93, v10, v58
  v_fmac_f32 v94, v10, v60
  v_fmac_f32 v95, v10, v62
  v_mul_f32 v92, v92, v57
  v_mul_f32 v93, v93, v59
  v_mul_f32 v94, v94, v61
  v_mul_f32 v95, v95, v63
  v_cvt_pk_bf16_f32 v122, v92, v93
  v_cvt_pk_bf16_f32 v123, v94, v95
  s_add_u32 s28, s31, 12583936
  buffer_store_dwordx4 v[120:123], v14, s[12:15], s28 offen sc1
  ds_write_b128 v15, v[120:123] offset:1024
  v_fmac_f32 v104, v12, v48
  v_fmac_f32 v105, v12, v50
  v_fmac_f32 v106, v12, v52
  v_fmac_f32 v107, v12, v54
  v_mul_f32 v104, v104, v49
  v_mul_f32 v105, v105, v51
  v_mul_f32 v106, v106, v53
  v_mul_f32 v107, v107, v55
  v_cvt_pk_bf16_f32 v124, v104, v105
  v_cvt_pk_bf16_f32 v125, v106, v107
  v_fmac_f32 v108, v12, v56
  v_fmac_f32 v109, v12, v58
  v_fmac_f32 v110, v12, v60
  v_fmac_f32 v111, v12, v62
  v_mul_f32 v108, v108, v57
  v_mul_f32 v109, v109, v59
  v_mul_f32 v110, v110, v61
  v_mul_f32 v111, v111, v63
  v_cvt_pk_bf16_f32 v126, v108, v109
  v_cvt_pk_bf16_f32 v127, v110, v111
  s_add_u32 s28, s31, 12649472
  buffer_store_dwordx4 v[124:127], v14, s[12:15], s28 offen sc1
  ds_write_b128 v15, v[124:127] offset:13312
  ds_read_b128 v[112:115], v11 offset:0
  ds_read_b128 v[116:119], v11 offset:64
  v_add_u32 v15, s38, v14
  s_waitcnt lgkmcnt(0)
  v_mul_f32 v10, 0x3e8293ee, v3
  v_fmac_f32 v16, v112, v2
  v_fmac_f32 v17, v113, v2
  v_fmac_f32 v18, v114, v2
  v_fmac_f32 v19, v115, v2
  v_mul_f32 v16, v16, v10
  v_mul_f32 v17, v17, v10
  v_mul_f32 v18, v18, v10
  v_mul_f32 v19, v19, v10
  v_cvt_pk_bf16_f32 v120, v16, v17
  v_cvt_pk_bf16_f32 v121, v18, v19
  v_fmac_f32 v32, v116, v2
  v_fmac_f32 v33, v117, v2
  v_fmac_f32 v34, v118, v2
  v_fmac_f32 v35, v119, v2
  v_mul_f32 v32, v32, v10
  v_mul_f32 v33, v33, v10
  v_mul_f32 v34, v34, v10
  v_mul_f32 v35, v35, v10
  v_cvt_pk_bf16_f32 v122, v32, v33
  v_cvt_pk_bf16_f32 v123, v34, v35
  ds_write_b128 v15, v[120:123] offset:0
  v_mul_f32 v10, 0x3e8293ee, v5
  v_fmac_f32 v20, v112, v4
  v_fmac_f32 v21, v113, v4
  v_fmac_f32 v22, v114, v4
  v_fmac_f32 v23, v115, v4
  v_mul_f32 v20, v20, v10
  v_mul_f32 v21, v21, v10
  v_mul_f32 v22, v22, v10
  v_mul_f32 v23, v23, v10
  v_cvt_pk_bf16_f32 v124, v20, v21
  v_cvt_pk_bf16_f32 v125, v22, v23
  v_fmac_f32 v36, v116, v4
  v_fmac_f32 v37, v117, v4
  v_fmac_f32 v38, v118, v4
  v_fmac_f32 v39, v119, v4
  v_mul_f32 v36, v36, v10
  v_mul_f32 v37, v37, v10
  v_mul_f32 v38, v38, v10
  v_mul_f32 v39, v39, v10
  v_cvt_pk_bf16_f32 v126, v36, v37
  v_cvt_pk_bf16_f32 v127, v38, v39
  ds_write_b128 v15, v[124:127] offset:1024
  v_mul_f32 v10, 0x3e8293ee, v7
  v_fmac_f32 v24, v112, v6
  v_fmac_f32 v25, v113, v6
  v_fmac_f32 v26, v114, v6
  v_fmac_f32 v27, v115, v6
  v_mul_f32 v24, v24, v10
  v_mul_f32 v25, v25, v10
  v_mul_f32 v26, v26, v10
  v_mul_f32 v27, v27, v10
  v_cvt_pk_bf16_f32 v120, v24, v25
  v_cvt_pk_bf16_f32 v121, v26, v27
  v_fmac_f32 v40, v116, v6
  v_fmac_f32 v41, v117, v6
  v_fmac_f32 v42, v118, v6
  v_fmac_f32 v43, v119, v6
  v_mul_f32 v40, v40, v10
  v_mul_f32 v41, v41, v10
  v_mul_f32 v42, v42, v10
  v_mul_f32 v43, v43, v10
  v_cvt_pk_bf16_f32 v122, v40, v41
  v_cvt_pk_bf16_f32 v123, v42, v43
  ds_write_b128 v15, v[120:123] offset:2048
  v_mul_f32 v10, 0x3e8293ee, v9
  v_fmac_f32 v28, v112, v8
  v_fmac_f32 v29, v113, v8
  v_fmac_f32 v30, v114, v8
  v_fmac_f32 v31, v115, v8
  v_mul_f32 v28, v28, v10
  v_mul_f32 v29, v29, v10
  v_mul_f32 v30, v30, v10
  v_mul_f32 v31, v31, v10
  v_cvt_pk_bf16_f32 v124, v28, v29
  v_cvt_pk_bf16_f32 v125, v30, v31
  v_fmac_f32 v44, v116, v8
  v_fmac_f32 v45, v117, v8
  v_fmac_f32 v46, v118, v8
  v_fmac_f32 v47, v119, v8
  v_mul_f32 v44, v44, v10
  v_mul_f32 v45, v45, v10
  v_mul_f32 v46, v46, v10
  v_mul_f32 v47, v47, v10
  v_cvt_pk_bf16_f32 v126, v44, v45
  v_cvt_pk_bf16_f32 v127, v46, v47
  ds_write_b128 v15, v[124:127] offset:3072
  s_waitcnt vmcnt(0) lgkmcnt(0)
  s_barrier
  s_setprio 0
  s_branch L_sequential_preLN__sliding_block__dense_activation_relu__prompt_kernel_ATT
L_sequential_preLN__sliding_block__dense_activation_relu__prompt_kernel_L1:
  s_setprio 3
  v_and_b32 v1, 63, v0
  v_lshrrev_b32 v2, 3, v1
  v_and_b32 v3, 7, v1
  v_add_u32 v15, 0, v2
  v_bfe_u32 v16, v15, 1, 3
  v_xor_b32 v16, v16, v3
  v_lshlrev_b32 v16, 4, v16
  v_lshl_add_u32 v4, v15, 11, v16
  v_add_u32 v15, 8, v2
  v_bfe_u32 v16, v15, 1, 3
  v_xor_b32 v16, v16, v3
  v_lshlrev_b32 v16, 4, v16
  v_lshl_add_u32 v5, v15, 11, v16
  v_add_u32 v15, 16, v2
  v_bfe_u32 v16, v15, 1, 3
  v_xor_b32 v16, v16, v3
  v_lshlrev_b32 v16, 4, v16
  v_lshl_add_u32 v6, v15, 11, v16
  v_add_u32 v15, 24, v2
  v_bfe_u32 v16, v15, 1, 3
  v_xor_b32 v16, v16, v3
  v_lshlrev_b32 v16, 4, v16
  v_lshl_add_u32 v7, v15, 11, v16
  v_add_u32 v2, 0, v1
  v_mul_u32_u24 v3, 2731, v2
  v_lshrrev_b32 v3, 16, v3
  v_mul_u32_u24 v15, 24, v3
  v_sub_u32 v2, v2, v15
  v_bfe_u32 v15, v3, 1, 1
  v_bfe_u32 v16, v3, 3, 1
  v_lshl_or_b32 v15, v16, 1, v15
  v_lshlrev_b32 v15, 1, v15
  v_xor_b32 v2, v2, v15
  v_lshrrev_b32 v15, 3, v2
  v_mul_u32_u24 v15, 2048, v15
  v_and_b32 v2, 7, v2
  v_lshlrev_b32 v2, 4, v2
  v_add_u32 v2, v2, v15
  v_mul_u32_u24 v3, 6144, v3
  v_add_u32 v8, v2, v3
  v_add_u32 v2, 64, v1
  v_mul_u32_u24 v3, 2731, v2
  v_lshrrev_b32 v3, 16, v3
  v_mul_u32_u24 v15, 24, v3
  v_sub_u32 v2, v2, v15
  v_bfe_u32 v15, v3, 1, 1
  v_bfe_u32 v16, v3, 3, 1
  v_lshl_or_b32 v15, v16, 1, v15
  v_lshlrev_b32 v15, 1, v15
  v_xor_b32 v2, v2, v15
  v_lshrrev_b32 v15, 3, v2
  v_mul_u32_u24 v15, 2048, v15
  v_and_b32 v2, 7, v2
  v_lshlrev_b32 v2, 4, v2
  v_add_u32 v2, v2, v15
  v_mul_u32_u24 v3, 6144, v3
  v_add_u32 v9, v2, v3
  v_add_u32 v2, 128, v1
  v_mul_u32_u24 v3, 2731, v2
  v_lshrrev_b32 v3, 16, v3
  v_mul_u32_u24 v15, 24, v3
  v_sub_u32 v2, v2, v15
  v_bfe_u32 v15, v3, 1, 1
  v_bfe_u32 v16, v3, 3, 1
  v_lshl_or_b32 v15, v16, 1, v15
  v_lshlrev_b32 v15, 1, v15
  v_xor_b32 v2, v2, v15
  v_lshrrev_b32 v15, 3, v2
  v_mul_u32_u24 v15, 2048, v15
  v_and_b32 v2, 7, v2
  v_lshlrev_b32 v2, 4, v2
  v_add_u32 v2, v2, v15
  v_mul_u32_u24 v3, 6144, v3
  v_add_u32 v10, v2, v3
  v_add_u32 v2, 192, v1
  v_mul_u32_u24 v3, 2731, v2
  v_lshrrev_b32 v3, 16, v3
  v_mul_u32_u24 v15, 24, v3
  v_sub_u32 v2, v2, v15
  v_bfe_u32 v15, v3, 1, 1
  v_bfe_u32 v16, v3, 3, 1
  v_lshl_or_b32 v15, v16, 1, v15
  v_lshlrev_b32 v15, 1, v15
  v_xor_b32 v2, v2, v15
  v_lshrrev_b32 v15, 3, v2
  v_mul_u32_u24 v15, 2048, v15
  v_and_b32 v2, 7, v2
  v_lshlrev_b32 v2, 4, v2
  v_add_u32 v2, v2, v15
  v_mul_u32_u24 v3, 6144, v3
  v_add_u32 v11, v2, v3
  v_add_u32 v2, 256, v1
  v_mul_u32_u24 v3, 2731, v2
  v_lshrrev_b32 v3, 16, v3
  v_mul_u32_u24 v15, 24, v3
  v_sub_u32 v2, v2, v15
  v_bfe_u32 v15, v3, 1, 1
  v_bfe_u32 v16, v3, 3, 1
  v_lshl_or_b32 v15, v16, 1, v15
  v_lshlrev_b32 v15, 1, v15
  v_xor_b32 v2, v2, v15
  v_lshrrev_b32 v15, 3, v2
  v_mul_u32_u24 v15, 2048, v15
  v_and_b32 v2, 7, v2
  v_lshlrev_b32 v2, 4, v2
  v_add_u32 v2, v2, v15
  v_mul_u32_u24 v3, 6144, v3
  v_add_u32 v12, v2, v3
  v_add_u32 v2, 320, v1
  v_mul_u32_u24 v3, 2731, v2
  v_lshrrev_b32 v3, 16, v3
  v_mul_u32_u24 v15, 24, v3
  v_sub_u32 v2, v2, v15
  v_bfe_u32 v15, v3, 1, 1
  v_bfe_u32 v16, v3, 3, 1
  v_lshl_or_b32 v15, v16, 1, v15
  v_lshlrev_b32 v15, 1, v15
  v_xor_b32 v2, v2, v15
  v_lshrrev_b32 v15, 3, v2
  v_mul_u32_u24 v15, 2048, v15
  v_and_b32 v2, 7, v2
  v_lshlrev_b32 v2, 4, v2
  v_add_u32 v2, v2, v15
  v_mul_u32_u24 v3, 6144, v3
  v_add_u32 v13, v2, v3
  s_sub_u32 s26, s3, 4
  s_lshl_b32 s24, s20, 18
  s_lshl_b32 s27, s26, 16
  s_add_u32 s24, s24, s27
  s_mul_i32 s44, s26, 4096
  s_add_u32 s44, s44, 0
  s_lshl_b32 s25, s21, 7
  s_mul_i32 s27, s26, 98304
  s_add_u32 s25, s25, s27
  s_mul_i32 s45, s26, 6144
  s_add_u32 s45, s45, 16384
  s_mov_b32 s23, 0
  s_waitcnt lgkmcnt(0)
  s_mov_b32 s4, s64
  s_and_b32 s5, s65, 0xffff
  s_mov_b32 s6, 4194304
  s_mov_b32 s7, 0x20000
  s_mov_b32 s8, s66
  s_and_b32 s9, s67, 0xffff
  s_mov_b32 s10, 6291456
  s_mov_b32 s11, 0x20000
  s_mov_b32 s16, s68
  s_and_b32 s17, s69, 0xffff
  s_mov_b32 s18, 2097152
  s_mov_b32 s19, 0x20000
  s_mov_b32 s48, s72
  s_and_b32 s49, s73, 0xffff
  s_mov_b32 s50, 7340032
  s_mov_b32 s51, 0x20000
  s_mov_b32 s52, s74
  s_and_b32 s53, s75, 0xffff
  s_mov_b32 s54, 7340032
  s_mov_b32 s55, 0x20000
  s_mov_b32 s56, s76
  s_and_b32 s57, s77, 0xffff
  s_mov_b32 s58, 4194304
  s_mov_b32 s59, 0x20000
  s_mov_b32 s60, s78
  s_and_b32 s61, s79, 0xffff
  s_mov_b32 s62, 256
  s_mov_b32 s63, 0x20000
  s_and_b32 s13, s13, 0xffff
  s_mov_b32 s14, 268435456
  s_mov_b32 s15, 0x20000
  s_mov_b32 s23, 0
  s_add_u32 m0, s23, s44
  s_nop 0
  buffer_load_dwordx4 v4, s[4:7], s24 offen  lds
  s_add_u32 m0, m0, 1024
  s_nop 0
  buffer_load_dwordx4 v5, s[4:7], s24 offen  lds
  s_add_u32 m0, m0, 1024
  s_nop 0
  buffer_load_dwordx4 v6, s[4:7], s24 offen  lds
  s_add_u32 m0, m0, 1024
  s_nop 0
  buffer_load_dwordx4 v7, s[4:7], s24 offen  lds
  s_add_u32 s24, s24, 128
  s_mov_b32 s23, 0
  s_add_u32 m0, s23, s45
  s_mov_b32 s30, s25
  buffer_load_dwordx4 v8, s[8:11], s30 offen lds
  s_add_u32 m0, m0, 1024
  s_nop 0
  buffer_load_dwordx4 v9, s[8:11], s30 offen lds
  s_add_u32 m0, m0, 1024
  s_nop 0
  buffer_load_dwordx4 v10, s[8:11], s30 offen lds
  s_add_u32 m0, m0, 1024
  s_nop 0
  buffer_load_dwordx4 v11, s[8:11], s30 offen lds
  s_add_u32 m0, m0, 1024
  s_nop 0
  buffer_load_dwordx4 v12, s[8:11], s30 offen lds
  s_add_u32 m0, m0, 1024
  s_nop 0
  buffer_load_dwordx4 v13, s[8:11], s30 offen lds
  s_add_u32 s25, s25, 393216
  s_mov_b32 s23, 40960
  s_add_u32 m0, s23, s44
  s_nop 0
  buffer_load_dwordx4 v4, s[4:7], s24 offen  lds
  s_add_u32 m0, m0, 1024
  s_nop 0
  buffer_load_dwordx4 v5, s[4:7], s24 offen  lds
  s_add_u32 m0, m0, 1024
  s_nop 0
  buffer_load_dwordx4 v6, s[4:7], s24 offen  lds
  s_add_u32 m0, m0, 1024
  s_nop 0
  buffer_load_dwordx4 v7, s[4:7], s24 offen  lds
  s_add_u32 s24, s24, 128
  s_mov_b32 s23, 40960
  s_add_u32 m0, s23, s45
  s_mov_b32 s30, s25
  buffer_load_dwordx4 v8, s[8:11], s30 offen lds
  s_add_u32 m0, m0, 1024
  s_nop 0
  buffer_load_dwordx4 v9, s[8:11], s30 offen lds
  s_add_u32 m0, m0, 1024
  s_nop 0
  buffer_load_dwordx4 v10, s[8:11], s30 offen lds
  s_add_u32 m0, m0, 1024
  s_nop 0
  buffer_load_dwordx4 v11, s[8:11], s30 offen lds
  s_add_u32 m0, m0, 1024
  s_nop 0
  buffer_load_dwordx4 v12, s[8:11], s30 offen lds
  s_add_u32 m0, m0, 1024
  s_nop 0
  buffer_load_dwordx4 v13, s[8:11], s30 offen lds
  s_add_u32 s25, s25, 393216
  s_mov_b32 s40, 0x00010001
  s_mov_b32 s41, 0x00010001
  v_mov_b32 v17, 0
  v_mov_b32 v18, 0
  v_mov_b32 v19, 0
  s_cmp_eq_u32 s3, 4
  s_cbranch_scc0 L_sequential_preLN__sliding_block__dense_activation_relu__prompt_kernel_w4_z
  s_lshl_b32 s36, s20, 4
  s_add_u32 s36, s36, s21
  s_lshl_b32 s36, s36, 7
  v_mov_b32 v2, s36
  v_add_u32 v2, 3145728, v2
  v_mov_b32 v3, s36
  v_add_u32 v3, 3178496, v3
  v_cmp_eq_u32 vcc, 1, v1
  s_nop 1
  v_cndmask_b32 v2, v2, v3, vcc
  s_lshl_b32 s36, s20, 7
  s_mul_i32 s37, s36, 1
  s_add_u32 s37, s37, 3211264
  v_mov_b32 v3, s37
  v_cmp_eq_u32 vcc, 2, v1
  s_nop 1
  v_cndmask_b32 v2, v2, v3, vcc
  s_mul_i32 s37, s36, 1
  s_add_u32 s37, s37, 3213312
  v_mov_b32 v3, s37
  v_cmp_eq_u32 vcc, 3, v1
  s_nop 1
  v_cndmask_b32 v2, v2, v3, vcc
  s_mul_i32 s37, s36, 2
  s_add_u32 s37, s37, 3215360
  v_mov_b32 v3, s37
  v_cmp_eq_u32 vcc, 4, v1
  s_nop 1
  v_cndmask_b32 v2, v2, v3, vcc
  s_mul_i32 s37, s36, 2
  s_add_u32 s37, s37, 3215488
  v_mov_b32 v3, s37
  v_cmp_eq_u32 vcc, 5, v1
  s_nop 1
  v_cndmask_b32 v2, v2, v3, vcc
  s_add_u32 s37, s36, 3221504
  v_mov_b32 v3, s37
  v_cmp_eq_u32 vcc, 8, v1
  s_nop 1
  v_cndmask_b32 v2, v2, v3, vcc
  s_lshl_b32 s37, s21, 7
  s_add_u32 s37, s37, 3219456
  v_mov_b32 v3, s37
  v_cmp_eq_u32 vcc, 6, v1
  s_nop 1
  v_cndmask_b32 v2, v2, v3, vcc
  s_lshl_b32 s37, s21, 7
  s_add_u32 s37, s37, 3223552
  v_mov_b32 v3, s37
  v_cmp_eq_u32 vcc, 7, v1
  s_nop 1
  v_cndmask_b32 v2, v2, v3, vcc
  s_mov_b32 s36, 3
  s_cmp_eq_u32 s21, 0
  s_cselect_b32 s37, 0x13c, 0
  s_or_b32 s36, s36, s37
  s_cmp_eq_u32 s20, 0
  s_cselect_b32 s37, 0xc0, 0
  s_or_b32 s36, s36, s37
  s_mov_b32 s37, 0
  v_mov_b32 v20, 0
  v_mov_b32 v21, 0
  v_mov_b32 v22, 0
  v_mov_b32 v23, 0
  s_mov_b64 exec, s[36:37]
  buffer_store_dwordx4 v[20:23], v2, s[12:15], 0 offen sc1
  s_mov_b64 exec, -1
L_sequential_preLN__sliding_block__dense_activation_relu__prompt_kernel_w4_z:
  s_waitcnt vmcnt(10)
  s_barrier
  s_mov_b32 s23, 81920
  s_add_u32 m0, s23, s44
  s_nop 0
  buffer_load_dwordx4 v4, s[4:7], s24 offen  lds
  s_add_u32 m0, m0, 1024
  s_nop 0
  buffer_load_dwordx4 v5, s[4:7], s24 offen  lds
  s_add_u32 m0, m0, 1024
  s_nop 0
  buffer_load_dwordx4 v6, s[4:7], s24 offen  lds
  s_add_u32 m0, m0, 1024
  s_nop 0
  buffer_load_dwordx4 v7, s[4:7], s24 offen  lds
  s_add_u32 s24, s24, 128
  s_mov_b32 s23, 81920
  s_add_u32 m0, s23, s45
  s_mov_b32 s30, s25
  buffer_load_dwordx4 v8, s[8:11], s30 offen lds
  s_add_u32 m0, m0, 1024
  s_nop 0
  buffer_load_dwordx4 v9, s[8:11], s30 offen lds
  s_add_u32 m0, m0, 1024
  s_nop 0
  buffer_load_dwordx4 v10, s[8:11], s30 offen lds
  s_add_u32 m0, m0, 1024
  s_nop 0
  buffer_load_dwordx4 v11, s[8:11], s30 offen lds
  s_add_u32 m0, m0, 1024
  s_nop 0
  buffer_load_dwordx4 v12, s[8:11], s30 offen lds
  s_add_u32 m0, m0, 1024
  s_nop 0
  buffer_load_dwordx4 v13, s[8:11], s30 offen lds
  s_add_u32 s25, s25, 393216
  s_sub_u32 s26, s3, 4
  s_lshl_b32 s36, s20, 7
  s_lshl_b32 s37, s21, 3
  s_add_u32 s36, s36, s37
  s_lshl_b32 s37, s26, 1
  s_add_u32 s42, s36, s37
  s_lshl_b32 s37, s42, 11
  v_lshlrev_b32 v2, 5, v1
  buffer_load_dwordx4 v[84:87], v2, s[4:7], s37 offen
  buffer_load_dwordx4 v[88:91], v2, s[4:7], s37 offen offset:16
  buffer_load_dwordx4 v[92:95], v2, s[4:7], s37 offen offset:2048
  buffer_load_dwordx4 v[108:111], v2, s[4:7], s37 offen offset:2064
  s_waitcnt vmcnt(14)
  s_barrier
  s_mov_b32 s23, 0
  s_add_u32 m0, s23, s44
  s_nop 0
  buffer_load_dwordx4 v4, s[4:7], s24 offen  lds
  s_add_u32 m0, m0, 1024
  s_nop 0
  buffer_load_dwordx4 v5, s[4:7], s24 offen  lds
  s_add_u32 m0, m0, 1024
  s_nop 0
  buffer_load_dwordx4 v6, s[4:7], s24 offen  lds
  s_add_u32 m0, m0, 1024
  s_nop 0
  buffer_load_dwordx4 v7, s[4:7], s24 offen  lds
  s_add_u32 s24, s24, 128
  s_mov_b32 s23, 0
  s_add_u32 m0, s23, s45
  s_mov_b32 s30, s25
  buffer_load_dwordx4 v8, s[8:11], s30 offen lds
  s_add_u32 m0, m0, 1024
  s_nop 0
  buffer_load_dwordx4 v9, s[8:11], s30 offen lds
  s_add_u32 m0, m0, 1024
  s_nop 0
  buffer_load_dwordx4 v10, s[8:11], s30 offen lds
  s_add_u32 m0, m0, 1024
  s_nop 0
  buffer_load_dwordx4 v11, s[8:11], s30 offen lds
  s_add_u32 m0, m0, 1024
  s_nop 0
  buffer_load_dwordx4 v12, s[8:11], s30 offen lds
  s_add_u32 m0, m0, 1024
  s_nop 0
  buffer_load_dwordx4 v13, s[8:11], s30 offen lds
  s_add_u32 s25, s25, 393216
  s_cmp_eq_u32 s3, 4
  s_cbranch_scc0 L_sequential_preLN__sliding_block__dense_activation_relu__prompt_kernel_w4_init
  s_and_b32 s28, s2, 3
  s_lshl_b32 s28, s28, 6
  v_mov_b32 v2, 0
  v_mov_b32 v3, 1
  s_mov_b64 exec, 1
  buffer_atomic_add v3, v2, s[60:63], s28 offen sc1
  s_mov_b64 exec, -1
L_sequential_preLN__sliding_block__dense_activation_relu__prompt_kernel_w4_init:
  s_sub_u32 s26, s3, 4
  s_mul_i32 s36, s20, 393216
  s_lshl_b32 s37, s21, 7
  s_add_u32 s36, s36, s37
  s_mul_i32 s37, s26, 98304
  s_add_u32 s36, s36, s37
  s_mul_i32 s37, s26, 6144
  s_add_u32 s37, s37, 122880
  s_mov_b32 m0, s37
  s_mov_b32 s30, s36
  buffer_load_dwordx4 v8, s[8:11], s30 offen lds
  s_add_u32 m0, m0, 1024
  s_nop 0
  buffer_load_dwordx4 v9, s[8:11], s30 offen lds
  s_add_u32 m0, m0, 1024
  s_nop 0
  buffer_load_dwordx4 v10, s[8:11], s30 offen lds
  s_add_u32 m0, m0, 1024
  s_nop 0
  buffer_load_dwordx4 v11, s[8:11], s30 offen lds
  s_add_u32 m0, m0, 1024
  s_nop 0
  buffer_load_dwordx4 v12, s[8:11], s30 offen lds
  s_add_u32 m0, m0, 1024
  s_nop 0
  buffer_load_dwordx4 v13, s[8:11], s30 offen lds
  s_waitcnt vmcnt(16)
  s_barrier
  s_mov_b32 s23, 40960
  s_add_u32 m0, s23, s44
  s_nop 0
  buffer_load_dwordx4 v4, s[4:7], s24 offen  lds
  v_lshlrev_b32 v24, 16, v84
  v_and_b32 v25, 0xffff0000, v84
  v_lshlrev_b32 v26, 16, v85
  v_and_b32 v27, 0xffff0000, v85
  v_lshlrev_b32 v28, 16, v86
  v_and_b32 v29, 0xffff0000, v86
  s_add_u32 m0, m0, 1024
  s_nop 0
  buffer_load_dwordx4 v5, s[4:7], s24 offen  lds
  v_lshlrev_b32 v30, 16, v87
  v_and_b32 v31, 0xffff0000, v87
  v_lshlrev_b32 v32, 16, v88
  v_and_b32 v33, 0xffff0000, v88
  v_lshlrev_b32 v34, 16, v89
  v_and_b32 v35, 0xffff0000, v89
  s_add_u32 m0, m0, 1024
  s_nop 0
  buffer_load_dwordx4 v6, s[4:7], s24 offen  lds
  v_lshlrev_b32 v36, 16, v90
  v_and_b32 v37, 0xffff0000, v90
  v_lshlrev_b32 v38, 16, v91
  v_and_b32 v39, 0xffff0000, v91
  v_add_f32 v20, v24, v25
  v_add_f32 v20, v20, v26
  s_add_u32 m0, m0, 1024
  s_nop 0
  buffer_load_dwordx4 v7, s[4:7], s24 offen  lds
  v_add_f32 v20, v20, v27
  v_add_f32 v20, v20, v28
  v_add_f32 v20, v20, v29
  v_add_f32 v20, v20, v30
  v_add_f32 v20, v20, v31
  v_add_f32 v20, v20, v32
  s_add_u32 s24, s24, 128
  s_mov_b32 s23, 40960
  s_add_u32 m0, s23, s45
  s_mov_b32 s30, s25
  buffer_load_dwordx4 v8, s[8:11], s30 offen lds
  v_add_f32 v20, v20, v33
  v_add_f32 v20, v20, v34
  v_add_f32 v20, v20, v35
  v_add_f32 v20, v20, v36
  v_add_f32 v20, v20, v37
  v_add_f32 v20, v20, v38
  s_add_u32 m0, m0, 1024
  s_nop 0
  buffer_load_dwordx4 v9, s[8:11], s30 offen lds
  v_add_f32 v20, v20, v39
  s_nop 1
  v_add_f32_dpp v20, v20, v20 row_ror:8 row_mask:0xf bank_mask:0xf
  s_nop 1
  v_add_f32_dpp v20, v20, v20 row_ror:4 row_mask:0xf bank_mask:0xf
  s_nop 1
  s_add_u32 m0, m0, 1024
  s_nop 0
  buffer_load_dwordx4 v10, s[8:11], s30 offen lds
  v_add_f32_dpp v20, v20, v20 row_ror:2 row_mask:0xf bank_mask:0xf
  s_nop 1
  v_add_f32_dpp v20, v20, v20 row_ror:1 row_mask:0xf bank_mask:0xf
  v_mov_b32 v16, v20
  s_nop 1
  v_permlane16_swap_b32 v20, v16
  s_add_u32 m0, m0, 1024
  s_nop 0
  buffer_load_dwordx4 v11, s[8:11], s30 offen lds
  s_nop 1
  v_add_f32 v20, v20, v16
  v_mov_b32 v16, v20
  s_nop 1
  v_permlane32_swap_b32 v20, v16
  s_nop 1
  s_add_u32 m0, m0, 1024
  s_nop 0
  buffer_load_dwordx4 v12, s[8:11], s30 offen lds
  v_add_f32 v20, v20, v16
  v_mul_f32 v20, 0xba800000, v20
  v_add_f32 v24, v20, v24
  v_add_f32 v25, v20, v25
  s_add_u32 m0, m0, 1024
  s_nop 0
  buffer_load_dwordx4 v13, s[8:11], s30 offen lds
  s_add_u32 s25, s25, 393216
  s_waitcnt vmcnt(16)
  s_barrier
  s_mov_b32 s23, 81920
  s_add_u32 m0, s23, s44
  s_nop 0
  buffer_load_dwordx4 v4, s[4:7], s24 offen  lds
  v_add_f32 v26, v20, v26
  v_add_f32 v27, v20, v27
  v_add_f32 v28, v20, v28
  v_add_f32 v29, v20, v29
  v_add_f32 v30, v20, v30
  v_add_f32 v31, v20, v31
  s_add_u32 m0, m0, 1024
  s_nop 0
  buffer_load_dwordx4 v5, s[4:7], s24 offen  lds
  v_add_f32 v32, v20, v32
  v_add_f32 v33, v20, v33
  v_add_f32 v34, v20, v34
  v_add_f32 v35, v20, v35
  v_add_f32 v36, v20, v36
  v_add_f32 v37, v20, v37
  s_add_u32 m0, m0, 1024
  s_nop 0
  buffer_load_dwordx4 v6, s[4:7], s24 offen  lds
  v_add_f32 v38, v20, v38
  v_add_f32 v39, v20, v39
  v_mul_f32 v21, v24, v24
  v_fmac_f32 v21, v25, v25
  v_fmac_f32 v21, v26, v26
  v_fmac_f32 v21, v27, v27
  s_add_u32 m0, m0, 1024
  s_nop 0
  buffer_load_dwordx4 v7, s[4:7], s24 offen  lds
  v_fmac_f32 v21, v28, v28
  v_fmac_f32 v21, v29, v29
  v_fmac_f32 v21, v30, v30
  v_fmac_f32 v21, v31, v31
  v_fmac_f32 v21, v32, v32
  v_fmac_f32 v21, v33, v33
  s_add_u32 s24, s24, 128
  s_mov_b32 s23, 81920
  s_add_u32 m0, s23, s45
  s_mov_b32 s30, s25
  buffer_load_dwordx4 v8, s[8:11], s30 offen lds
  v_fmac_f32 v21, v34, v34
  v_fmac_f32 v21, v35, v35
  v_fmac_f32 v21, v36, v36
  v_fmac_f32 v21, v37, v37
  v_fmac_f32 v21, v38, v38
  v_fmac_f32 v21, v39, v39
  s_add_u32 m0, m0, 1024
  s_nop 0
  buffer_load_dwordx4 v9, s[8:11], s30 offen lds
  s_nop 1
  v_add_f32_dpp v21, v21, v21 row_ror:8 row_mask:0xf bank_mask:0xf
  s_nop 1
  v_add_f32_dpp v21, v21, v21 row_ror:4 row_mask:0xf bank_mask:0xf
  s_nop 1
  v_add_f32_dpp v21, v21, v21 row_ror:2 row_mask:0xf bank_mask:0xf
  s_add_u32 m0, m0, 1024
  s_nop 0
  buffer_load_dwordx4 v10, s[8:11], s30 offen lds
  s_nop 1
  v_add_f32_dpp v21, v21, v21 row_ror:1 row_mask:0xf bank_mask:0xf
  v_mov_b32 v16, v21
  s_nop 1
  v_permlane16_swap_b32 v21, v16
  s_nop 1
  s_add_u32 m0, m0, 1024
  s_nop 0
  buffer_load_dwordx4 v11, s[8:11], s30 offen lds
  v_add_f32 v21, v21, v16
  v_mov_b32 v16, v21
  s_nop 1
  v_permlane32_swap_b32 v21, v16
  s_nop 1
  v_add_f32 v21, v21, v16
  s_add_u32 m0, m0, 1024
  s_nop 0
  buffer_load_dwordx4 v12, s[8:11], s30 offen lds
  v_mov_b32 v16, 0x3727c5ac
  v_fmac_f32 v16, 0x3a800000, v21
  v_rsq_f32 v21, v16
  s_nop 1
  s_add_u32 m0, m0, 1024
  s_nop 0
  buffer_load_dwordx4 v13, s[8:11], s30 offen lds
  s_add_u32 s25, s25, 393216
  s_waitcnt vmcnt(20)
  s_waitcnt vmcnt(10)
  s_barrier
  s_mov_b32 s23, 0
  s_add_u32 m0, s23, s44
  s_nop 0
  buffer_load_dwordx4 v4, s[4:7], s24 offen  lds
  v_lshlrev_b32 v24, 16, v92
  v_and_b32 v25, 0xffff0000, v92
  v_lshlrev_b32 v26, 16, v93
  v_and_b32 v27, 0xffff0000, v93
  v_lshlrev_b32 v28, 16, v94
  v_and_b32 v29, 0xffff0000, v94
  s_add_u32 m0, m0, 1024
  s_nop 0
  buffer_load_dwordx4 v5, s[4:7], s24 offen  lds
  v_lshlrev_b32 v30, 16, v95
  v_and_b32 v31, 0xffff0000, v95
  v_lshlrev_b32 v32, 16, v108
  v_and_b32 v33, 0xffff0000, v108
  v_lshlrev_b32 v34, 16, v109
  v_and_b32 v35, 0xffff0000, v109
  s_add_u32 m0, m0, 1024
  s_nop 0
  buffer_load_dwordx4 v6, s[4:7], s24 offen  lds
  v_lshlrev_b32 v36, 16, v110
  v_and_b32 v37, 0xffff0000, v110
  v_lshlrev_b32 v38, 16, v111
  v_and_b32 v39, 0xffff0000, v111
  v_add_f32 v22, v24, v25
  v_add_f32 v22, v22, v26
  s_add_u32 m0, m0, 1024
  s_nop 0
  buffer_load_dwordx4 v7, s[4:7], s24 offen  lds
  v_add_f32 v22, v22, v27
  v_add_f32 v22, v22, v28
  v_add_f32 v22, v22, v29
  v_add_f32 v22, v22, v30
  v_add_f32 v22, v22, v31
  v_add_f32 v22, v22, v32
  s_add_u32 s24, s24, 128
  s_mov_b32 s23, 0
  s_add_u32 m0, s23, s45
  s_mov_b32 s30, s25
  buffer_load_dwordx4 v8, s[8:11], s30 offen lds
  v_add_f32 v22, v22, v33
  v_add_f32 v22, v22, v34
  v_add_f32 v22, v22, v35
  v_add_f32 v22, v22, v36
  v_add_f32 v22, v22, v37
  v_add_f32 v22, v22, v38
  s_add_u32 m0, m0, 1024
  s_nop 0
  buffer_load_dwordx4 v9, s[8:11], s30 offen lds
  v_add_f32 v22, v22, v39
  s_nop 1
  v_add_f32_dpp v22, v22, v22 row_ror:8 row_mask:0xf bank_mask:0xf
  s_nop 1
  v_add_f32_dpp v22, v22, v22 row_ror:4 row_mask:0xf bank_mask:0xf
  s_nop 1
  s_add_u32 m0, m0, 1024
  s_nop 0
  buffer_load_dwordx4 v10, s[8:11], s30 offen lds
  v_add_f32_dpp v22, v22, v22 row_ror:2 row_mask:0xf bank_mask:0xf
  s_nop 1
  v_add_f32_dpp v22, v22, v22 row_ror:1 row_mask:0xf bank_mask:0xf
  v_mov_b32 v16, v22
  s_nop 1
  v_permlane16_swap_b32 v22, v16
  s_add_u32 m0, m0, 1024
  s_nop 0
  buffer_load_dwordx4 v11, s[8:11], s30 offen lds
  s_nop 1
  v_add_f32 v22, v22, v16
  v_mov_b32 v16, v22
  s_nop 1
  v_permlane32_swap_b32 v22, v16
  s_nop 1
  s_add_u32 m0, m0, 1024
  s_nop 0
  buffer_load_dwordx4 v12, s[8:11], s30 offen lds
  v_add_f32 v22, v22, v16
  v_mul_f32 v22, 0xba800000, v22
  v_add_f32 v24, v22, v24
  v_add_f32 v25, v22, v25
  s_add_u32 m0, m0, 1024
  s_nop 0
  buffer_load_dwordx4 v13, s[8:11], s30 offen lds
  s_add_u32 s25, s25, 393216
  s_waitcnt vmcnt(10)
  s_barrier
  s_mov_b32 s23, 40960
  s_add_u32 m0, s23, s44
  s_nop 0
  buffer_load_dwordx4 v4, s[4:7], s24 offen  lds
  v_add_f32 v26, v22, v26
  v_add_f32 v27, v22, v27
  v_add_f32 v28, v22, v28
  v_add_f32 v29, v22, v29
  v_add_f32 v30, v22, v30
  v_add_f32 v31, v22, v31
  s_add_u32 m0, m0, 1024
  s_nop 0
  buffer_load_dwordx4 v5, s[4:7], s24 offen  lds
  v_add_f32 v32, v22, v32
  v_add_f32 v33, v22, v33
  v_add_f32 v34, v22, v34
  v_add_f32 v35, v22, v35
  v_add_f32 v36, v22, v36
  v_add_f32 v37, v22, v37
  s_add_u32 m0, m0, 1024
  s_nop 0
  buffer_load_dwordx4 v6, s[4:7], s24 offen  lds
  v_add_f32 v38, v22, v38
  v_add_f32 v39, v22, v39
  v_mul_f32 v23, v24, v24
  v_fmac_f32 v23, v25, v25
  v_fmac_f32 v23, v26, v26
  v_fmac_f32 v23, v27, v27
  s_add_u32 m0, m0, 1024
  s_nop 0
  buffer_load_dwordx4 v7, s[4:7], s24 offen  lds
  v_fmac_f32 v23, v28, v28
  v_fmac_f32 v23, v29, v29
  v_fmac_f32 v23, v30, v30
  v_fmac_f32 v23, v31, v31
  v_fmac_f32 v23, v32, v32
  v_fmac_f32 v23, v33, v33
  s_add_u32 s24, s24, 128
  s_mov_b32 s23, 40960
  s_add_u32 m0, s23, s45
  s_mov_b32 s30, s25
  buffer_load_dwordx4 v8, s[8:11], s30 offen lds
  v_fmac_f32 v23, v34, v34
  v_fmac_f32 v23, v35, v35
  v_fmac_f32 v23, v36, v36
  v_fmac_f32 v23, v37, v37
  v_fmac_f32 v23, v38, v38
  v_fmac_f32 v23, v39, v39
  s_add_u32 m0, m0, 1024
  s_nop 0
  buffer_load_dwordx4 v9, s[8:11], s30 offen lds
  s_nop 1
  v_add_f32_dpp v23, v23, v23 row_ror:8 row_mask:0xf bank_mask:0xf
  s_nop 1
  v_add_f32_dpp v23, v23, v23 row_ror:4 row_mask:0xf bank_mask:0xf
  s_nop 1
  v_add_f32_dpp v23, v23, v23 row_ror:2 row_mask:0xf bank_mask:0xf
  s_add_u32 m0, m0, 1024
  s_nop 0
  buffer_load_dwordx4 v10, s[8:11], s30 offen lds
  s_nop 1
  v_add_f32_dpp v23, v23, v23 row_ror:1 row_mask:0xf bank_mask:0xf
  v_mov_b32 v16, v23
  s_nop 1
  v_permlane16_swap_b32 v23, v16
  s_nop 1
  s_add_u32 m0, m0, 1024
  s_nop 0
  buffer_load_dwordx4 v11, s[8:11], s30 offen lds
  v_add_f32 v23, v23, v16
  v_mov_b32 v16, v23
  s_nop 1
  v_permlane32_swap_b32 v23, v16
  s_nop 1
  v_add_f32 v23, v23, v16
  s_add_u32 m0, m0, 1024
  s_nop 0
  buffer_load_dwordx4 v12, s[8:11], s30 offen lds
  v_mov_b32 v16, 0x3727c5ac
  v_fmac_f32 v16, 0x3a800000, v23
  v_rsq_f32 v23, v16
  s_nop 1
  s_add_u32 m0, m0, 1024
  s_nop 0
  buffer_load_dwordx4 v13, s[8:11], s30 offen lds
  s_add_u32 s25, s25, 393216
  s_lshl_b32 s28, s42, 3
  s_add_u32 s28, s28, 1048576
  v_mov_b32 v2, 0
  s_mov_b64 exec, 1
  buffer_store_dwordx4 v[20:23], v2, s[12:15], s28 offen sc1
  s_mov_b64 exec, -1
  s_waitcnt vmcnt(11)
  s_barrier
  s_mov_b32 s23, 81920
  s_add_u32 m0, s23, s44
  s_nop 0
  buffer_load_dwordx4 v4, s[4:7], s24 offen  lds
  s_add_u32 m0, m0, 1024
  s_nop 0
  buffer_load_dwordx4 v5, s[4:7], s24 offen  lds
  s_add_u32 m0, m0, 1024
  s_nop 0
  buffer_load_dwordx4 v6, s[4:7], s24 offen  lds
  s_add_u32 m0, m0, 1024
  s_nop 0
  buffer_load_dwordx4 v7, s[4:7], s24 offen  lds
  s_add_u32 s24, s24, 128
  s_mov_b32 s23, 81920
  s_add_u32 m0, s23, s45
  s_mov_b32 s30, s25
  buffer_load_dwordx4 v8, s[8:11], s30 offen lds
  s_add_u32 m0, m0, 1024
  s_nop 0
  buffer_load_dwordx4 v9, s[8:11], s30 offen lds
  s_add_u32 m0, m0, 1024
  s_nop 0
  buffer_load_dwordx4 v10, s[8:11], s30 offen lds
  s_add_u32 m0, m0, 1024
  s_nop 0
  buffer_load_dwordx4 v11, s[8:11], s30 offen lds
  s_add_u32 m0, m0, 1024
  s_nop 0
  buffer_load_dwordx4 v12, s[8:11], s30 offen lds
  s_add_u32 m0, m0, 1024
  s_nop 0
  buffer_load_dwordx4 v13, s[8:11], s30 offen lds
  s_add_u32 s25, s25, 393216
  s_sub_u32 s36, s3, 4
  s_mul_i32 s36, s36, 3
  v_lshrrev_b32 v2, 4, v1
  v_bfe_u32 v3, v1, 2, 2
  v_lshl_add_u32 v2, v2, 3, v3
  v_bfe_u32 v3, v2, 1, 1
  v_bfe_u32 v16, v2, 3, 1
  v_lshl_or_b32 v3, v16, 1, v3
  v_mul_u32_u24 v2, 384, v2
  v_and_b32 v16, 3, v1
  v_lshlrev_b32 v16, 3, v16
  v_add_u32 v2, v2, v16
  v_add_u32 v2, 122880, v2
  v_mov_b32 v56, 0x3f803f80
  v_mov_b32 v57, 0x3f803f80
  v_mov_b32 v58, 0x3f803f80
  v_mov_b32 v59, 0x3f803f80
  s_add_u32 s37, s36, 0
  s_and_b32 s38, s37, 3
  s_andn2_b32 s39, s37, 3
  s_lshl_b32 s39, s39, 5
  v_xor_b32 v16, s38, v3
  v_lshlrev_b32 v16, 5, v16
  v_add_u32 v16, s39, v16
  v_add_u32 v20, v16, v2
  ds_read_b64_tr_b16 v[60:61], v20 offset:0
  ds_read_b64_tr_b16 v[62:63], v20 offset:1536
  ds_read_b64_tr_b16 v[64:65], v20 offset:12288
  ds_read_b64_tr_b16 v[66:67], v20 offset:13824
  s_add_u32 s37, s36, 1
  s_and_b32 s38, s37, 3
  s_andn2_b32 s39, s37, 3
  s_lshl_b32 s39, s39, 5
  v_xor_b32 v16, s38, v3
  v_lshlrev_b32 v16, 5, v16
  v_add_u32 v16, s39, v16
  v_add_u32 v21, v16, v2
  ds_read_b64_tr_b16 v[68:69], v21 offset:0
  ds_read_b64_tr_b16 v[70:71], v21 offset:1536
  ds_read_b64_tr_b16 v[72:73], v21 offset:12288
  ds_read_b64_tr_b16 v[74:75], v21 offset:13824
  s_add_u32 s37, s36, 2
  s_and_b32 s38, s37, 3
  s_andn2_b32 s39, s37, 3
  s_lshl_b32 s39, s39, 5
  v_xor_b32 v16, s38, v3
  v_lshlrev_b32 v16, 5, v16
  v_add_u32 v16, s39, v16
  v_add_u32 v22, v16, v2
  ds_read_b64_tr_b16 v[76:77], v22 offset:0
  ds_read_b64_tr_b16 v[78:79], v22 offset:1536
  ds_read_b64_tr_b16 v[80:81], v22 offset:12288
  ds_read_b64_tr_b16 v[82:83], v22 offset:13824
  s_waitcnt lgkmcnt(0)
  v_mfma_f32_16x16x32_bf16 v[24:27], v[60:63], v[56:59], 0
  v_mfma_f32_16x16x32_bf16 v[28:31], v[68:71], v[56:59], 0
  v_mfma_f32_16x16x32_bf16 v[32:35], v[76:79], v[56:59], 0
  v_mfma_f32_16x16x32_bf16 v[24:27], v[64:67], v[56:59], v[24:27]
  v_mfma_f32_16x16x32_bf16 v[28:31], v[72:75], v[56:59], v[28:31]
  v_mfma_f32_16x16x32_bf16 v[32:35], v[80:83], v[56:59], v[32:35]
  s_lshl_b32 s28, s20, 4
  s_add_u32 s28, s28, s21
  s_mul_i32 s28, s28, 768
  s_add_u32 s28, s28, 1114112
  s_lshl_b32 s37, s36, 6
  s_add_u32 s28, s28, s37
  v_lshrrev_b32 v2, 4, v1
  v_lshlrev_b32 v2, 4, v2
  s_nop 7
  s_mov_b64 exec, s[40:41]
  buffer_store_dwordx4 v[24:27], v2, s[12:15], s28 offen offset:0 sc1
  buffer_store_dwordx4 v[28:31], v2, s[12:15], s28 offen offset:64 sc1
  buffer_store_dwordx4 v[32:35], v2, s[12:15], s28 offen offset:128 sc1
  s_mov_b64 exec, -1
  s_waitcnt vmcnt(14)
  s_barrier
  s_cmp_eq_u32 s3, 4
  s_cbranch_scc0 L_sequential_preLN__sliding_block__dense_activation_relu__prompt_kernel_w4_pi
  v_and_b32 v19, 3, v1
  v_lshlrev_b32 v19, 6, v19
  v_mov_b32 v17, 64
  buffer_load_dword v18, v19, s[60:63], 0 offen sc1
L_sequential_preLN__sliding_block__dense_activation_relu__prompt_kernel_w4_pi:
  s_mov_b32 s23, 0
  s_add_u32 m0, s23, s44
  s_nop 0
  buffer_load_dwordx4 v4, s[4:7], s24 offen  lds
  v_and_b32 v1, 63, v0
  v_lshlrev_b32 v96, 4, v1
  v_add_u32 v2, 0, v1
  v_mul_u32_u24 v3, 8193, v2
  s_add_u32 m0, m0, 1024
  s_nop 0
  buffer_load_dwordx4 v5, s[4:7], s24 offen  lds
  v_lshrrev_b32 v3, 16, v3
  v_mul_u32_u24 v15, 8, v3
  v_sub_u32 v2, v2, v15
  v_bfe_u32 v15, v3, 1, 2
  s_add_u32 m0, m0, 1024
  s_nop 0
  buffer_load_dwordx4 v6, s[4:7], s24 offen  lds
  v_lshlrev_b32 v15, 1, v15
  v_xor_b32 v2, v2, v15
  v_lshlrev_b32 v2, 4, v2
  v_mul_u32_u24 v3, 2048, v3
  s_add_u32 m0, m0, 1024
  s_nop 0
  buffer_load_dwordx4 v7, s[4:7], s24 offen  lds
  v_add_u32 v97, v2, v3
  v_and_b32 v1, 63, v0
  v_add_u32 v2, 0, v1
  v_mul_u32_u24 v3, 4097, v2
  s_add_u32 s24, s24, 128
  s_mov_b32 s23, 0
  s_add_u32 m0, s23, s45
  s_mov_b32 s30, s25
  buffer_load_dwordx4 v8, s[8:11], s30 offen lds
  v_lshrrev_b32 v3, 16, v3
  v_mul_u32_u24 v15, 16, v3
  v_sub_u32 v2, v2, v15
  v_and_b32 v15, 7, v3
  s_add_u32 m0, m0, 1024
  s_nop 0
  buffer_load_dwordx4 v9, s[8:11], s30 offen lds
  v_lshlrev_b32 v15, 1, v15
  v_xor_b32 v2, v2, v15
  v_lshlrev_b32 v2, 4, v2
  v_mul_u32_u24 v3, 2048, v3
  s_add_u32 m0, m0, 1024
  s_nop 0
  buffer_load_dwordx4 v10, s[8:11], s30 offen lds
  v_add_u32 v105, v2, v3
  v_add_u32 v2, 64, v1
  v_mul_u32_u24 v3, 4097, v2
  v_lshrrev_b32 v3, 16, v3
  s_add_u32 m0, m0, 1024
  s_nop 0
  buffer_load_dwordx4 v11, s[8:11], s30 offen lds
  v_mul_u32_u24 v15, 16, v3
  v_sub_u32 v2, v2, v15
  v_and_b32 v15, 7, v3
  v_lshlrev_b32 v15, 1, v15
  s_add_u32 m0, m0, 1024
  s_nop 0
  buffer_load_dwordx4 v12, s[8:11], s30 offen lds
  v_xor_b32 v2, v2, v15
  v_lshlrev_b32 v2, 4, v2
  v_mul_u32_u24 v3, 2048, v3
  v_add_u32 v106, v2, v3
  s_add_u32 m0, m0, 1024
  s_nop 0
  buffer_load_dwordx4 v13, s[8:11], s30 offen lds
  s_add_u32 s25, s25, 393216
  s_waitcnt vmcnt(13)
  s_barrier
  s_mov_b32 s23, 40960
  s_add_u32 m0, s23, s44
  s_nop 0
  buffer_load_dwordx4 v4, s[4:7], s24 offen  lds
  v_and_b32 v1, 63, v0
  v_add_u32 v2, 0, v1
  v_mul_u32_u24 v3, 2341, v2
  v_lshrrev_b32 v3, 16, v3
  v_mul_u32_u24 v15, 28, v3
  s_add_u32 m0, m0, 1024
  s_nop 0
  buffer_load_dwordx4 v5, s[4:7], s24 offen  lds
  v_sub_u32 v2, v2, v15
  v_bfe_u32 v15, v3, 2, 1
  v_lshlrev_b32 v15, 1, v15
  v_xor_b32 v2, v2, v15
  v_lshlrev_b32 v2, 4, v2
  s_add_u32 m0, m0, 1024
  s_nop 0
  buffer_load_dwordx4 v6, s[4:7], s24 offen  lds
  v_mul_u32_u24 v3, 7168, v3
  v_add_u32 v98, v2, v3
  v_add_u32 v2, 64, v1
  v_mul_u32_u24 v3, 2341, v2
  v_lshrrev_b32 v3, 16, v3
  s_add_u32 m0, m0, 1024
  s_nop 0
  buffer_load_dwordx4 v7, s[4:7], s24 offen  lds
  v_mul_u32_u24 v15, 28, v3
  v_sub_u32 v2, v2, v15
  v_bfe_u32 v15, v3, 2, 1
  v_lshlrev_b32 v15, 1, v15
  v_xor_b32 v2, v2, v15
  s_add_u32 s24, s24, 128
  s_mov_b32 s23, 40960
  s_add_u32 m0, s23, s45
  s_mov_b32 s30, s25
  buffer_load_dwordx4 v8, s[8:11], s30 offen lds
  v_lshlrev_b32 v2, 4, v2
  v_mul_u32_u24 v3, 7168, v3
  v_add_u32 v99, v2, v3
  v_add_u32 v2, 128, v1
  v_mul_u32_u24 v3, 2341, v2
  s_add_u32 m0, m0, 1024
  s_nop 0
  buffer_load_dwordx4 v9, s[8:11], s30 offen lds
  v_lshrrev_b32 v3, 16, v3
  v_mul_u32_u24 v15, 28, v3
  v_sub_u32 v2, v2, v15
  v_bfe_u32 v15, v3, 2, 1
  v_lshlrev_b32 v15, 1, v15
  s_add_u32 m0, m0, 1024
  s_nop 0
  buffer_load_dwordx4 v10, s[8:11], s30 offen lds
  v_xor_b32 v2, v2, v15
  v_lshlrev_b32 v2, 4, v2
  v_mul_u32_u24 v3, 7168, v3
  v_add_u32 v100, v2, v3
  v_add_u32 v2, 192, v1
  s_add_u32 m0, m0, 1024
  s_nop 0
  buffer_load_dwordx4 v11, s[8:11], s30 offen lds
  v_mul_u32_u24 v3, 2341, v2
  v_lshrrev_b32 v3, 16, v3
  v_mul_u32_u24 v15, 28, v3
  v_sub_u32 v2, v2, v15
  v_bfe_u32 v15, v3, 2, 1
  s_add_u32 m0, m0, 1024
  s_nop 0
  buffer_load_dwordx4 v12, s[8:11], s30 offen lds
  v_lshlrev_b32 v15, 1, v15
  v_xor_b32 v2, v2, v15
  v_lshlrev_b32 v2, 4, v2
  v_mul_u32_u24 v3, 7168, v3
  v_add_u32 v101, v2, v3
  s_add_u32 m0, m0, 1024
  s_nop 0
  buffer_load_dwordx4 v13, s[8:11], s30 offen lds
  s_add_u32 s25, s25, 393216
  s_waitcnt vmcnt(10)
  s_cmp_eq_u32 s3, 4
  s_cbranch_scc0 L_sequential_preLN__sliding_block__dense_activation_relu__prompt_kernel_w4_cinit
  v_cmp_ge_u32 vcc, v18, v17
  s_nop 1
  s_cmp_eq_u64 vcc, exec
  s_cbranch_scc1 L_sequential_preLN__sliding_block__dense_activation_relu__prompt_kernel_w4_cinit
  s_mov_b32 s31, 40000
L_sequential_preLN__sliding_block__dense_activation_relu__prompt_kernel_poll_init:
  buffer_load_dword v18, v19, s[60:63], 0 offen sc1
  s_waitcnt vmcnt(0)
  v_cmp_ge_u32 vcc, v18, v17
  s_nop 1
  s_cmp_eq_u64 vcc, exec
  s_cbranch_scc1 L_sequential_preLN__sliding_block__dense_activation_relu__prompt_kernel_pdone_init
  s_sub_u32 s31, s31, 1
  s_cmp_eq_u32 s31, 0
  s_cbranch_scc1 L_sequential_preLN__sliding_block__dense_activation_relu__prompt_kernel_pdone_init
  s_nop 0
  s_branch L_sequential_preLN__sliding_block__dense_activation_relu__prompt_kernel_poll_init
L_sequential_preLN__sliding_block__dense_activation_relu__prompt_kernel_pdone_init:
L_sequential_preLN__sliding_block__dense_activation_relu__prompt_kernel_w4_cinit:
  s_barrier
  s_mov_b32 s23, 81920
  s_add_u32 m0, s23, s44
  s_nop 0
  buffer_load_dwordx4 v4, s[4:7], s24 offen  lds
  s_add_u32 m0, m0, 1024
  s_nop 0
  buffer_load_dwordx4 v5, s[4:7], s24 offen  lds
  s_add_u32 m0, m0, 1024
  s_nop 0
  buffer_load_dwordx4 v6, s[4:7], s24 offen  lds
  s_add_u32 m0, m0, 1024
  s_nop 0
  buffer_load_dwordx4 v7, s[4:7], s24 offen  lds
  s_add_u32 s24, s24, 128
  s_mov_b32 s23, 81920
  s_add_u32 m0, s23, s45
  s_mov_b32 s30, s25
  buffer_load_dwordx4 v8, s[8:11], s30 offen lds
  s_add_u32 m0, m0, 1024
  s_nop 0
  buffer_load_dwordx4 v9, s[8:11], s30 offen lds
  s_add_u32 m0, m0, 1024
  s_nop 0
  buffer_load_dwordx4 v10, s[8:11], s30 offen lds
  s_add_u32 m0, m0, 1024
  s_nop 0
  buffer_load_dwordx4 v11, s[8:11], s30 offen lds
  s_add_u32 m0, m0, 1024
  s_nop 0
  buffer_load_dwordx4 v12, s[8:11], s30 offen lds
  s_add_u32 m0, m0, 1024
  s_nop 0
  buffer_load_dwordx4 v13, s[8:11], s30 offen lds
  s_add_u32 s25, s25, 393216
  s_cmp_eq_u32 s3, 4
  s_cbranch_scc0 L_sequential_preLN__sliding_block__dense_activation_relu__prompt_kernel_w4_sq
  s_lshl_b32 s28, s20, 7
  s_add_u32 s28, s28, 3221504
  v_mov_b32 v2, 0
  v_mov_b32 v3, 1
  s_mov_b64 exec, 1
  buffer_atomic_add v3, v2, s[12:15], s28 offen sc1
  s_mov_b64 exec, -1
  s_lshl_b32 s28, s21, 7
  s_add_u32 s28, s28, 3223552
  v_mov_b32 v2, 0
  v_mov_b32 v3, 1
  s_mov_b64 exec, 1
  buffer_atomic_add v3, v2, s[12:15], s28 offen sc1
  s_mov_b64 exec, -1
L_sequential_preLN__sliding_block__dense_activation_relu__prompt_kernel_w4_sq:
  s_waitcnt vmcnt(10)
  s_barrier
  s_mov_b32 s23, 0
  s_add_u32 m0, s23, s44
  s_nop 0
  buffer_load_dwordx4 v4, s[4:7], s24 offen  lds
  v_and_b32 v1, 63, v0
  v_add_u32 v2, 256, v1
  v_mul_u32_u24 v3, 2341, v2
  v_lshrrev_b32 v3, 16, v3
  s_add_u32 m0, m0, 1024
  s_nop 0
  buffer_load_dwordx4 v5, s[4:7], s24 offen  lds
  v_mul_u32_u24 v15, 28, v3
  v_sub_u32 v2, v2, v15
  v_bfe_u32 v15, v3, 2, 1
  v_lshlrev_b32 v15, 1, v15
  s_add_u32 m0, m0, 1024
  s_nop 0
  buffer_load_dwordx4 v6, s[4:7], s24 offen  lds
  v_xor_b32 v2, v2, v15
  v_lshlrev_b32 v2, 4, v2
  v_mul_u32_u24 v3, 7168, v3
  v_add_u32 v102, v2, v3
  s_add_u32 m0, m0, 1024
  s_nop 0
  buffer_load_dwordx4 v7, s[4:7], s24 offen  lds
  v_add_u32 v2, 320, v1
  v_mul_u32_u24 v3, 2341, v2
  v_lshrrev_b32 v3, 16, v3
  v_mul_u32_u24 v15, 28, v3
  s_add_u32 s24, s24, 128
  s_mov_b32 s23, 0
  s_add_u32 m0, s23, s45
  s_mov_b32 s30, s25
  buffer_load_dwordx4 v8, s[8:11], s30 offen lds
  v_sub_u32 v2, v2, v15
  v_bfe_u32 v15, v3, 2, 1
  v_lshlrev_b32 v15, 1, v15
  v_xor_b32 v2, v2, v15
  s_add_u32 m0, m0, 1024
  s_nop 0
  buffer_load_dwordx4 v9, s[8:11], s30 offen lds
  v_lshlrev_b32 v2, 4, v2
  v_mul_u32_u24 v3, 7168, v3
  v_add_u32 v103, v2, v3
  v_add_u32 v2, 384, v1
  s_add_u32 m0, m0, 1024
  s_nop 0
  buffer_load_dwordx4 v10, s[8:11], s30 offen lds
  v_mul_u32_u24 v3, 2341, v2
  v_lshrrev_b32 v3, 16, v3
  v_mul_u32_u24 v15, 28, v3
  v_sub_u32 v2, v2, v15
  s_add_u32 m0, m0, 1024
  s_nop 0
  buffer_load_dwordx4 v11, s[8:11], s30 offen lds
  v_bfe_u32 v15, v3, 2, 1
  v_lshlrev_b32 v15, 1, v15
  v_xor_b32 v2, v2, v15
  v_lshlrev_b32 v2, 4, v2
  s_add_u32 m0, m0, 1024
  s_nop 0
  buffer_load_dwordx4 v12, s[8:11], s30 offen lds
  v_mul_u32_u24 v3, 7168, v3
  v_add_u32 v104, v2, v3
  s_add_u32 m0, m0, 1024
  s_nop 0
  buffer_load_dwordx4 v13, s[8:11], s30 offen lds
  s_add_u32 s25, s25, 393216
  s_waitcnt vmcnt(10)
  s_barrier
  s_cmp_eq_u32 s3, 4
  s_cbranch_scc0 L_sequential_preLN__sliding_block__dense_activation_relu__prompt_kernel_w4_ps
  s_lshl_b32 s29, s20, 7
  s_add_u32 s29, s29, 3221504
  v_mov_b32 v19, s29
  s_lshl_b32 s29, s21, 7
  s_add_u32 s29, s29, 3223552
  v_mov_b32 v2, s29
  v_cmp_eq_u32 vcc, 1, v1
  s_nop 1
  v_cndmask_b32 v19, v19, v2, vcc
  v_mov_b32 v17, 16
  buffer_load_dword v18, v19, s[12:15], 0 offen sc1
L_sequential_preLN__sliding_block__dense_activation_relu__prompt_kernel_w4_ps:
  s_mov_b32 s23, 40960
  s_add_u32 m0, s23, s44
  s_nop 0
  buffer_load_dwordx4 v4, s[4:7], s24 offen  lds
  s_add_u32 m0, m0, 1024
  s_nop 0
  buffer_load_dwordx4 v5, s[4:7], s24 offen  lds
  s_add_u32 m0, m0, 1024
  s_nop 0
  buffer_load_dwordx4 v6, s[4:7], s24 offen  lds
  s_add_u32 m0, m0, 1024
  s_nop 0
  buffer_load_dwordx4 v7, s[4:7], s24 offen  lds
  s_add_u32 s24, s24, 128
  s_mov_b32 s23, 40960
  s_add_u32 m0, s23, s45
  s_mov_b32 s30, s25
  buffer_load_dwordx4 v8, s[8:11], s30 offen lds
  s_add_u32 m0, m0, 1024
  s_nop 0
  buffer_load_dwordx4 v9, s[8:11], s30 offen lds
  s_add_u32 m0, m0, 1024
  s_nop 0
  buffer_load_dwordx4 v10, s[8:11], s30 offen lds
  s_add_u32 m0, m0, 1024
  s_nop 0
  buffer_load_dwordx4 v11, s[8:11], s30 offen lds
  s_add_u32 m0, m0, 1024
  s_nop 0
  buffer_load_dwordx4 v12, s[8:11], s30 offen lds
  s_add_u32 m0, m0, 1024
  s_nop 0
  buffer_load_dwordx4 v13, s[8:11], s30 offen lds
  s_add_u32 s25, s25, 393216
  s_waitcnt vmcnt(10)
  s_barrier
  s_mov_b32 s23, 81920
  s_add_u32 m0, s23, s44
  s_nop 0
  buffer_load_dwordx4 v4, s[4:7], s24 offen  lds
  s_add_u32 m0, m0, 1024
  s_nop 0
  buffer_load_dwordx4 v5, s[4:7], s24 offen  lds
  s_add_u32 m0, m0, 1024
  s_nop 0
  buffer_load_dwordx4 v6, s[4:7], s24 offen  lds
  s_add_u32 m0, m0, 1024
  s_nop 0
  buffer_load_dwordx4 v7, s[4:7], s24 offen  lds
  s_add_u32 s24, s24, 128
  s_mov_b32 s23, 81920
  s_add_u32 m0, s23, s45
  s_mov_b32 s30, s25
  buffer_load_dwordx4 v8, s[8:11], s30 offen lds
  s_add_u32 m0, m0, 1024
  s_nop 0
  buffer_load_dwordx4 v9, s[8:11], s30 offen lds
  s_add_u32 m0, m0, 1024
  s_nop 0
  buffer_load_dwordx4 v10, s[8:11], s30 offen lds
  s_add_u32 m0, m0, 1024
  s_nop 0
  buffer_load_dwordx4 v11, s[8:11], s30 offen lds
  s_add_u32 m0, m0, 1024
  s_nop 0
  buffer_load_dwordx4 v12, s[8:11], s30 offen lds
  s_add_u32 m0, m0, 1024
  s_nop 0
  buffer_load_dwordx4 v13, s[8:11], s30 offen lds
  s_add_u32 s25, s25, 393216
  s_waitcnt vmcnt(10)
  s_cmp_eq_u32 s3, 4
  s_cbranch_scc0 L_sequential_preLN__sliding_block__dense_activation_relu__prompt_kernel_w4_csq
  v_cmp_ge_u32 vcc, v18, v17
  s_nop 1
  s_cmp_eq_u64 vcc, exec
  s_cbranch_scc1 L_sequential_preLN__sliding_block__dense_activation_relu__prompt_kernel_w4_csq
  s_mov_b32 s31, 40000
L_sequential_preLN__sliding_block__dense_activation_relu__prompt_kernel_poll_sq:
  buffer_load_dword v18, v19, s[12:15], 0 offen sc1
  s_waitcnt vmcnt(0)
  v_cmp_ge_u32 vcc, v18, v17
  s_nop 1
  s_cmp_eq_u64 vcc, exec
  s_cbranch_scc1 L_sequential_preLN__sliding_block__dense_activation_relu__prompt_kernel_pdone_sq
  s_sub_u32 s31, s31, 1
  s_cmp_eq_u32 s31, 0
  s_cbranch_scc1 L_sequential_preLN__sliding_block__dense_activation_relu__prompt_kernel_pdone_sq
  s_nop 0
  s_branch L_sequential_preLN__sliding_block__dense_activation_relu__prompt_kernel_poll_sq
L_sequential_preLN__sliding_block__dense_activation_relu__prompt_kernel_pdone_sq:
L_sequential_preLN__sliding_block__dense_activation_relu__prompt_kernel_w4_csq:
  s_barrier
  s_mov_b32 s23, 0
  s_add_u32 m0, s23, s44
  s_nop 0
  buffer_load_dwordx4 v4, s[4:7], s24 offen  lds
  s_add_u32 m0, m0, 1024
  s_nop 0
  buffer_load_dwordx4 v5, s[4:7], s24 offen  lds
  s_add_u32 m0, m0, 1024
  s_nop 0
  buffer_load_dwordx4 v6, s[4:7], s24 offen  lds
  s_add_u32 m0, m0, 1024
  s_nop 0
  buffer_load_dwordx4 v7, s[4:7], s24 offen  lds
  s_add_u32 s24, s24, 128
  s_mov_b32 s23, 0
  s_add_u32 m0, s23, s45
  s_mov_b32 s30, s25
  buffer_load_dwordx4 v8, s[8:11], s30 offen lds
  s_add_u32 m0, m0, 1024
  s_nop 0
  buffer_load_dwordx4 v9, s[8:11], s30 offen lds
  s_add_u32 m0, m0, 1024
  s_nop 0
  buffer_load_dwordx4 v10, s[8:11], s30 offen lds
  s_add_u32 m0, m0, 1024
  s_nop 0
  buffer_load_dwordx4 v11, s[8:11], s30 offen lds
  s_add_u32 m0, m0, 1024
  s_nop 0
  buffer_load_dwordx4 v12, s[8:11], s30 offen lds
  s_add_u32 m0, m0, 1024
  s_nop 0
  buffer_load_dwordx4 v13, s[8:11], s30 offen lds
  s_add_u32 s25, s25, 393216
  v_lshrrev_b32 v2, 4, v1
  v_mul_u32_u24 v2, 12288, v2
  v_and_b32 v3, 15, v1
  v_lshl_add_u32 v17, v3, 4, v2
  s_mul_i32 s30, s21, 768
  s_sub_u32 s26, s3, 4
  s_mul_i32 s27, s26, 192
  s_add_u32 s30, s30, s27
  s_add_u32 s30, s30, 1114112
  buffer_load_dwordx4 v[60:63], v17, s[12:15], s30 offen sc1
  s_add_u32 s30, s30, 49152
  buffer_load_dwordx4 v[64:67], v17, s[12:15], s30 offen sc1
  s_add_u32 s30, s30, 49152
  buffer_load_dwordx4 v[68:71], v17, s[12:15], s30 offen sc1
  s_add_u32 s30, s30, 49152
  buffer_load_dwordx4 v[72:75], v17, s[12:15], s30 offen sc1
  s_add_u32 s30, s30, 49152
  s_lshl_b32 s30, s20, 10
  s_add_u32 s30, s30, 1048576
  v_lshlrev_b32 v17, 4, v1
  s_mov_b32 m0, 155648
  s_nop 0
  buffer_load_dwordx4 v17, s[12:15], s30 offen sc1 lds
  s_waitcnt vmcnt(15)
  s_barrier
  s_lshl_b32 s28, s20, 4
  s_add_u32 s28, s28, s21
  s_lshl_b32 s28, s28, 2
  s_sub_u32 s26, s3, 4
  s_add_u32 s28, s28, s26
  s_lshl_b32 s28, s28, 12
  s_add_u32 s28, s28, 41943040
  v_lshlrev_b32 v2, 4, v1
  v_mov_b32 v84, -1
  v_mov_b32 v85, -1
  v_mov_b32 v86, -1
  v_mov_b32 v87, -1
  buffer_store_dwordx4 v[84:87], v2, s[12:15], s28 offen offset:0 sc1
  buffer_store_dwordx4 v[84:87], v2, s[12:15], s28 offen offset:1024 sc1
  buffer_store_dwordx4 v[84:87], v2, s[12:15], s28 offen offset:2048 sc1
  buffer_store_dwordx4 v[84:87], v2, s[12:15], s28 offen offset:3072 sc1
  s_waitcnt vmcnt(9)
  s_barrier
  s_waitcnt vmcnt(4)
  v_add_f32 v76, v60, v64
  v_add_f32 v77, v61, v65
  v_add_f32 v78, v62, v66
  v_add_f32 v79, v63, v67
  v_add_f32 v76, v76, v68
  v_add_f32 v77, v77, v69
  v_add_f32 v78, v78, v70
  v_add_f32 v79, v79, v71
  v_add_f32 v76, v76, v72
  v_add_f32 v77, v77, v73
  v_add_f32 v78, v78, v74
  v_add_f32 v79, v79, v75
  v_mov_b32 v16, v76
  s_nop 1
  v_permlane16_swap_b32 v76, v16
  s_nop 1
  v_add_f32 v76, v76, v16
  v_mov_b32 v16, v76
  s_nop 1
  v_permlane32_swap_b32 v76, v16
  s_nop 1
  v_add_f32 v76, v76, v16
  v_mov_b32 v16, v77
  s_nop 1
  v_permlane16_swap_b32 v77, v16
  s_nop 1
  v_add_f32 v77, v77, v16
  v_mov_b32 v16, v77
  s_nop 1
  v_permlane32_swap_b32 v77, v16
  s_nop 1
  v_add_f32 v77, v77, v16
  v_mov_b32 v16, v78
  s_nop 1
  v_permlane16_swap_b32 v78, v16
  s_nop 1
  v_add_f32 v78, v78, v16
  v_mov_b32 v16, v78
  s_nop 1
  v_permlane32_swap_b32 v78, v16
  s_nop 1
  v_add_f32 v78, v78, v16
  v_mov_b32 v16, v79
  s_nop 1
  v_permlane16_swap_b32 v79, v16
  s_nop 1
  v_add_f32 v79, v79, v16
  v_mov_b32 v16, v79
  s_nop 1
  v_permlane32_swap_b32 v79, v16
  s_nop 1
  v_add_f32 v79, v79, v16
  s_sub_u32 s26, s3, 4
  s_mul_i32 s27, s26, 192
  s_add_u32 s27, s27, 156672
  v_and_b32 v3, 15, v1
  v_lshl_add_u32 v2, v3, 4, s27
  v_cmp_gt_u32 vcc, 12, v1
  s_and_saveexec_b64 s[34:35], vcc
  ds_write_b128 v2, v[76:79]
  s_mov_b64 exec, s[34:35]
  s_waitcnt lgkmcnt(0)
  s_barrier
  s_setprio 0
  s_barrier
  s_cmp_eq_u32 s3, 4
  s_cbranch_scc0 L_sequential_preLN__sliding_block__dense_activation_relu__prompt_kernel_w4_kv
  s_lshl_b32 s28, s20, 4
  s_add_u32 s28, s28, s21
  s_lshl_b32 s28, s28, 7
  s_add_u32 s28, s28, 3145728
  v_mov_b32 v2, 0
  v_mov_b32 v3, 1
  s_mov_b64 exec, 1
  buffer_store_dword v3, v2, s[12:15], s28 offen sc1
  s_mov_b64 exec, -1
  s_cmp_eq_u32 s20, 0
  s_cbranch_scc1 L_sequential_preLN__sliding_block__dense_activation_relu__prompt_kernel_kv_nopoll
  s_sub_u32 s29, s28, 2048
  s_sub_u32 s30, s28, 4096
  s_cmp_eq_u32 s20, 1
  s_cselect_b32 s30, s29, s30
  v_mov_b32 v19, s29
  v_mov_b32 v3, s30
  v_cmp_eq_u32 vcc, 1, v1
  s_nop 1
  v_cndmask_b32 v19, v19, v3, vcc
  v_mov_b32 v17, 1
  s_mov_b32 s31, 40000
L_sequential_preLN__sliding_block__dense_activation_relu__prompt_kernel_poll_kv:
  buffer_load_dword v18, v19, s[12:15], 0 offen sc1
  s_waitcnt vmcnt(0)
  v_cmp_ge_u32 vcc, v18, v17
  s_nop 1
  s_cmp_eq_u64 vcc, exec
  s_cbranch_scc1 L_sequential_preLN__sliding_block__dense_activation_relu__prompt_kernel_pdone_kv
  s_sub_u32 s31, s31, 1
  s_cmp_eq_u32 s31, 0
  s_cbranch_scc1 L_sequential_preLN__sliding_block__dense_activation_relu__prompt_kernel_pdone_kv
  s_nop 0
  s_branch L_sequential_preLN__sliding_block__dense_activation_relu__prompt_kernel_poll_kv
L_sequential_preLN__sliding_block__dense_activation_relu__prompt_kernel_pdone_kv:
L_sequential_preLN__sliding_block__dense_activation_relu__prompt_kernel_kv_nopoll:
L_sequential_preLN__sliding_block__dense_activation_relu__prompt_kernel_w4_kv:
L_sequential_preLN__sliding_block__dense_activation_relu__prompt_kernel_ATT:
  s_barrier
  v_lshlrev_b32 v2, 4, v1
  s_and_b32 s26, s3, 1
  s_lshr_b32 s27, s3, 1
  s_lshl_b32 s28, s21, 1
  s_add_u32 s28, s28, s26
  s_lshr_b32 s36, s27, 1
  s_add_u32 s36, s36, s20
  s_cmp_ge_u32 s36, 2
  s_cbranch_scc0 L_sequential_preLN__sliding_block__dense_activation_relu__prompt_kernel_hk
  s_lshl_b32 s29, s28, 17
  s_lshl_b32 s30, s20, 13
  s_add_u32 s29, s29, s30
  s_lshl_b32 s30, s27, 12
  s_add_u32 s29, s29, s30
  s_add_u32 s29, s29, 8372224
  s_mul_i32 s31, s26, 24576
  s_add_u32 s31, s31, s30
  s_add_u32 m0, s31, 16384
  s_nop 0
  buffer_load_dwordx4 v2, s[12:15], s29 offen offset:0 sc1 lds
  buffer_load_dwordx4 v2, s[12:15], s29 offen offset:1024 sc1 lds
  buffer_load_dwordx4 v2, s[12:15], s29 offen offset:2048 sc1 lds
  buffer_load_dwordx4 v2, s[12:15], s29 offen offset:3072 sc1 lds
L_sequential_preLN__sliding_block__dense_activation_relu__prompt_kernel_hk:
  s_and_b32 s37, s27, 1
  s_add_u32 s36, s37, s20
  s_cmp_ge_u32 s36, 2
  s_cbranch_scc0 L_sequential_preLN__sliding_block__dense_activation_relu__prompt_kernel_hv
  s_lshr_b32 s38, s27, 1
  s_lshl_b32 s29, s28, 1
  s_add_u32 s29, s29, s38
  s_lshl_b32 s29, s29, 16
  s_lshl_b32 s30, s20, 12
  s_add_u32 s29, s29, s30
  s_lshl_b32 s30, s37, 12
  s_add_u32 s29, s29, s30
  s_add_u32 s29, s29, 12574720
  s_lshl_b32 s31, s26, 1
  s_add_u32 s31, s31, s38
  s_mul_i32 s31, s31, 12288
  s_add_u32 s31, s31, s30
  s_add_u32 m0, s31, 65536
  s_nop 0
  buffer_load_dwordx4 v2, s[12:15], s29 offen offset:0 sc1 lds
  buffer_load_dwordx4 v2, s[12:15], s29 offen offset:1024 sc1 lds
  buffer_load_dwordx4 v2, s[12:15], s29 offen offset:2048 sc1 lds
  buffer_load_dwordx4 v2, s[12:15], s29 offen offset:3072 sc1 lds
L_sequential_preLN__sliding_block__dense_activation_relu__prompt_kernel_hv:
  s_waitcnt vmcnt(0)
  s_barrier
  s_cmp_ge_u32 s3, 4
  s_cbranch_scc0 L_sequential_preLN__sliding_block__dense_activation_relu__prompt_kernel_nocs1
  s_cmp_eq_u32 s3, 7
  s_cbranch_scc0 L_sequential_preLN__sliding_block__dense_activation_relu__prompt_kernel_wpf2
  s_lshl_b32 s46, s20, 4
  s_add_u32 s46, s46, s21
  v_lshrrev_b32 v2, 4, v1
  s_lshl_b32 s36, s46, 2
  v_add_u32 v2, s36, v2
  v_lshlrev_b32 v2, 11, v2
  v_and_b32 v3, 15, v1
  v_lshl_add_u32 v120, v3, 7, v2
  buffer_load_dword a88, v120, s[16:19], 0 offen
L_sequential_preLN__sliding_block__dense_activation_relu__prompt_kernel_wpf2:
  s_sub_u32 s26, s3, 4
  s_mul_i32 s25, s20, 458752
  s_mul_i32 s27, s21, 448
  s_add_u32 s25, s25, s27
  s_mul_i32 s27, s26, 114688
  s_add_u32 s25, s25, s27
  s_mul_i32 s37, s26, 7168
  s_add_u32 s37, s37, 114688
  s_mov_b32 m0, s37
  s_mov_b32 s30, s25
  buffer_load_dwordx4 v98, s[48:51], s30 offen lds
  s_add_u32 m0, m0, 1024
  s_nop 0
  buffer_load_dwordx4 v99, s[48:51], s30 offen lds
  s_add_u32 m0, m0, 1024
  s_nop 0
  buffer_load_dwordx4 v100, s[48:51], s30 offen lds
  s_add_u32 m0, m0, 1024
  s_nop 0
  buffer_load_dwordx4 v101, s[48:51], s30 offen lds
  s_add_u32 m0, m0, 1024
  s_nop 0
  buffer_load_dwordx4 v102, s[48:51], s30 offen lds
  s_add_u32 m0, m0, 1024
  s_nop 0
  buffer_load_dwordx4 v103, s[48:51], s30 offen lds
  s_add_u32 m0, m0, 1024
  s_nop 0
  buffer_load_dwordx4 v104, s[48:51], s30 offen lds
L_sequential_preLN__sliding_block__dense_activation_relu__prompt_kernel_nocs1:
  s_and_b32 s26, s3, 1
  s_lshr_b32 s27, s3, 1
  v_lshlrev_b32 v2, 4, v1
  s_lshl_b32 s28, s26, 13
  s_lshl_b32 s29, s27, 11
  s_add_u32 s28, s28, s29
  s_add_u32 s28, s28, 0
  v_add_u32 v3, s28, v2
  ds_read_b128 a[0:3], v3
  ds_read_b128 a[4:7], v3 offset:1024
  s_lshl_b32 s28, s20, 2
  s_add_u32 s28, s28, s27
  s_sub_i32 s36, 8, s28
  s_max_i32 s36, s36, 0
  s_mul_i32 s28, s26, 24576
  s_lshl_b32 s29, s27, 11
  s_add_u32 s29, s29, s28
  s_add_u32 s29, s29, 16384
  v_add_u32 v4, s29, v2
  s_lshl_b32 s29, s27, 10
  s_add_u32 s29, s29, s28
  s_add_u32 s29, s29, 65536
  v_add_u32 v5, s29, v2
  v_and_b32 v8, 15, v1
  v_lshrrev_b32 v9, 4, v1
  v_lshlrev_b32 v9, 2, v9
  v_mov_b32 v10, 0xf149f2ca
  v_add_u32 v11, 0, v9
  v_cmp_gt_u32 vcc, v11, v8
  s_nop 1
  v_cndmask_b32_e64 v40, v10, 0, vcc
  v_cndmask_b32 v44, 0, v10, vcc
  v_add_u32 v11, 1, v9
  v_cmp_gt_u32 vcc, v11, v8
  s_nop 1
  v_cndmask_b32_e64 v41, v10, 0, vcc
  v_cndmask_b32 v45, 0, v10, vcc
  v_add_u32 v11, 2, v9
  v_cmp_gt_u32 vcc, v11, v8
  s_nop 1
  v_cndmask_b32_e64 v42, v10, 0, vcc
  v_cndmask_b32 v46, 0, v10, vcc
  v_add_u32 v11, 3, v9
  v_cmp_gt_u32 vcc, v11, v8
  s_nop 1
  v_cndmask_b32_e64 v43, v10, 0, vcc
  v_cndmask_b32 v47, 0, v10, vcc
  v_mov_b32 v12, 0x3f803f80
  v_accvgpr_write_b32 a40, v12
  v_accvgpr_write_b32 a41, v12
  v_accvgpr_write_b32 a42, v12
  v_accvgpr_write_b32 a43, v12
  v_mov_b32 v6, v10
  v_mov_b32 v7, v10
  v_mov_b32 v72, 0
  v_mov_b32 v73, 0
  v_mov_b32 v74, 0
  v_mov_b32 v75, 0
  v_mov_b32 v76, 0
  v_mov_b32 v77, 0
  v_mov_b32 v78, 0
  v_mov_b32 v79, 0
  v_mov_b32 v80, 0
  v_mov_b32 v81, 0
  v_mov_b32 v82, 0
  v_mov_b32 v83, 0
  v_mov_b32 v84, 0
  v_mov_b32 v85, 0
  v_mov_b32 v86, 0
  v_mov_b32 v87, 0
  v_mov_b32 v88, 0
  v_mov_b32 v89, 0
  v_mov_b32 v90, 0
  v_mov_b32 v91, 0
  v_mov_b32 v92, 0
  v_mov_b32 v93, 0
  v_mov_b32 v94, 0
  v_mov_b32 v95, 0
  s_lshl_b32 s28, s36, 11
  v_add_u32 v11, s28, v4
  ds_read_b128 a[8:11], v11
  ds_read_b128 a[12:15], v11 offset:1024
  ds_read_b128 a[16:19], v11
  ds_read_b128 a[20:23], v11 offset:1024
  s_cmp_eq_u32 s36, 1
  s_cbranch_scc1 L_sequential_preLN__sliding_block__dense_activation_relu__prompt_kernel_a1_1
  s_cmp_eq_u32 s36, 2
  s_cbranch_scc1 L_sequential_preLN__sliding_block__dense_activation_relu__prompt_kernel_a1_2
  s_cmp_eq_u32 s36, 3
  s_cbranch_scc1 L_sequential_preLN__sliding_block__dense_activation_relu__prompt_kernel_a1_3
  s_cmp_eq_u32 s36, 4
  s_cbranch_scc1 L_sequential_preLN__sliding_block__dense_activation_relu__prompt_kernel_a1_4
  s_cmp_eq_u32 s36, 5
  s_cbranch_scc1 L_sequential_preLN__sliding_block__dense_activation_relu__prompt_kernel_a1_5
  s_cmp_eq_u32 s36, 6
  s_cbranch_scc1 L_sequential_preLN__sliding_block__dense_activation_relu__prompt_kernel_a1_6
  s_cmp_eq_u32 s36, 7
  s_cbranch_scc1 L_sequential_preLN__sliding_block__dense_activation_relu__prompt_kernel_a1_7
  s_cmp_eq_u32 s36, 8
  s_cbranch_scc1 L_sequential_preLN__sliding_block__dense_activation_relu__prompt_kernel_a1_8
L_sequential_preLN__sliding_block__dense_activation_relu__prompt_kernel_a1_0:
  s_waitcnt lgkmcnt(0)
  v_mfma_f32_16x16x32_bf16 v[16:19], a[8:11], a[0:3], v[40:43]
  v_mfma_f32_16x16x32_bf16 v[20:23], a[12:15], a[0:3], 0
  v_mfma_f32_16x16x32_bf16 v[28:31], a[12:15], a[4:7], v[40:43]
  ds_read_b128 a[16:19], v4 offset:2048
  ds_read_b128 a[20:23], v4 offset:3072
  s_nop 5
  v_max3_f32 v6, v6, v16, v17
  v_max3_f32 v6, v6, v18, v19
  v_max3_f32 v6, v6, v20, v21
  v_max3_f32 v6, v6, v22, v23
  s_nop 1
  v_max3_f32 v7, v7, v28, v29
  v_max3_f32 v7, v7, v30, v31
L_sequential_preLN__sliding_block__dense_activation_relu__prompt_kernel_a1_1:
  s_waitcnt lgkmcnt(0)
  v_mfma_f32_16x16x32_bf16 v[16:19], a[16:19], a[0:3], 0
  v_mfma_f32_16x16x32_bf16 v[20:23], a[20:23], a[0:3], 0
  v_mfma_f32_16x16x32_bf16 v[24:27], a[16:19], a[4:7], 0
  v_mfma_f32_16x16x32_bf16 v[28:31], a[20:23], a[4:7], 0
  ds_read_b128 a[8:11], v4 offset:4096
  ds_read_b128 a[12:15], v4 offset:5120
  s_nop 5
  v_max3_f32 v6, v6, v16, v17
  v_max3_f32 v6, v6, v18, v19
  v_max3_f32 v6, v6, v20, v21
  v_max3_f32 v6, v6, v22, v23
  v_max3_f32 v7, v7, v24, v25
  v_max3_f32 v7, v7, v26, v27
  s_nop 1
  v_max3_f32 v7, v7, v28, v29
  v_max3_f32 v7, v7, v30, v31
L_sequential_preLN__sliding_block__dense_activation_relu__prompt_kernel_a1_2:
  s_waitcnt lgkmcnt(0)
  v_mfma_f32_16x16x32_bf16 v[16:19], a[8:11], a[0:3], 0
  v_mfma_f32_16x16x32_bf16 v[20:23], a[12:15], a[0:3], 0
  v_mfma_f32_16x16x32_bf16 v[24:27], a[8:11], a[4:7], 0
  v_mfma_f32_16x16x32_bf16 v[28:31], a[12:15], a[4:7], 0
  ds_read_b128 a[16:19], v4 offset:6144
  ds_read_b128 a[20:23], v4 offset:7168
  s_nop 5
  v_max3_f32 v6, v6, v16, v17
  v_max3_f32 v6, v6, v18, v19
  v_max3_f32 v6, v6, v20, v21
  v_max3_f32 v6, v6, v22, v23
  v_max3_f32 v7, v7, v24, v25
  v_max3_f32 v7, v7, v26, v27
  s_nop 1
  v_max3_f32 v7, v7, v28, v29
  v_max3_f32 v7, v7, v30, v31
L_sequential_preLN__sliding_block__dense_activation_relu__prompt_kernel_a1_3:
  s_waitcnt lgkmcnt(0)
  v_mfma_f32_16x16x32_bf16 v[16:19], a[16:19], a[0:3], 0
  v_mfma_f32_16x16x32_bf16 v[20:23], a[20:23], a[0:3], 0
  v_mfma_f32_16x16x32_bf16 v[24:27], a[16:19], a[4:7], 0
  v_mfma_f32_16x16x32_bf16 v[28:31], a[20:23], a[4:7], 0
  ds_read_b128 a[8:11], v4 offset:8192
  ds_read_b128 a[12:15], v4 offset:9216
  s_nop 5
  v_max3_f32 v6, v6, v16, v17
  v_max3_f32 v6, v6, v18, v19
  v_max3_f32 v6, v6, v20, v21
  v_max3_f32 v6, v6, v22, v23
  v_max3_f32 v7, v7, v24, v25
  v_max3_f32 v7, v7, v26, v27
  s_nop 1
  v_max3_f32 v7, v7, v28, v29
  v_max3_f32 v7, v7, v30, v31
L_sequential_preLN__sliding_block__dense_activation_relu__prompt_kernel_a1_4:
  s_waitcnt lgkmcnt(0)
  v_mfma_f32_16x16x32_bf16 v[16:19], a[8:11], a[0:3], 0
  v_mfma_f32_16x16x32_bf16 v[20:23], a[12:15], a[0:3], 0
  v_mfma_f32_16x16x32_bf16 v[24:27], a[8:11], a[4:7], 0
  v_mfma_f32_16x16x32_bf16 v[28:31], a[12:15], a[4:7], 0
  ds_read_b128 a[16:19], v4 offset:10240
  ds_read_b128 a[20:23], v4 offset:11264
  s_nop 5
  v_max3_f32 v6, v6, v16, v17
  v_max3_f32 v6, v6, v18, v19
  v_max3_f32 v6, v6, v20, v21
  v_max3_f32 v6, v6, v22, v23
  v_max3_f32 v7, v7, v24, v25
  v_max3_f32 v7, v7, v26, v27
  s_nop 1
  v_max3_f32 v7, v7, v28, v29
  v_max3_f32 v7, v7, v30, v31
L_sequential_preLN__sliding_block__dense_activation_relu__prompt_kernel_a1_5:
  s_waitcnt lgkmcnt(0)
  v_mfma_f32_16x16x32_bf16 v[16:19], a[16:19], a[0:3], 0
  v_mfma_f32_16x16x32_bf16 v[20:23], a[20:23], a[0:3], 0
  v_mfma_f32_16x16x32_bf16 v[24:27], a[16:19], a[4:7], 0
  v_mfma_f32_16x16x32_bf16 v[28:31], a[20:23], a[4:7], 0
  ds_read_b128 a[8:11], v4 offset:12288
  ds_read_b128 a[12:15], v4 offset:13312
  s_nop 5
  v_max3_f32 v6, v6, v16, v17
  v_max3_f32 v6, v6, v18, v19
  v_max3_f32 v6, v6, v20, v21
  v_max3_f32 v6, v6, v22, v23
  v_max3_f32 v7, v7, v24, v25
  v_max3_f32 v7, v7, v26, v27
  s_nop 1
  v_max3_f32 v7, v7, v28, v29
  v_max3_f32 v7, v7, v30, v31
L_sequential_preLN__sliding_block__dense_activation_relu__prompt_kernel_a1_6:
  s_waitcnt lgkmcnt(0)
  v_mfma_f32_16x16x32_bf16 v[16:19], a[8:11], a[0:3], 0
  v_mfma_f32_16x16x32_bf16 v[20:23], a[12:15], a[0:3], 0
  v_mfma_f32_16x16x32_bf16 v[24:27], a[8:11], a[4:7], 0
  v_mfma_f32_16x16x32_bf16 v[28:31], a[12:15], a[4:7], 0
  ds_read_b128 a[16:19], v4 offset:14336
  ds_read_b128 a[20:23], v4 offset:15360
  s_nop 5
  v_max3_f32 v6, v6, v16, v17
  v_max3_f32 v6, v6, v18, v19
  v_max3_f32 v6, v6, v20, v21
  v_max3_f32 v6, v6, v22, v23
  v_max3_f32 v7, v7, v24, v25
  v_max3_f32 v7, v7, v26, v27
  s_nop 1
  v_max3_f32 v7, v7, v28, v29
  v_max3_f32 v7, v7, v30, v31
L_sequential_preLN__sliding_block__dense_activation_relu__prompt_kernel_a1_7:
  s_waitcnt lgkmcnt(0)
  v_mfma_f32_16x16x32_bf16 v[16:19], a[16:19], a[0:3], 0
  v_mfma_f32_16x16x32_bf16 v[20:23], a[20:23], a[0:3], 0
  v_mfma_f32_16x16x32_bf16 v[24:27], a[16:19], a[4:7], 0
  v_mfma_f32_16x16x32_bf16 v[28:31], a[20:23], a[4:7], 0
  ds_read_b128 a[8:11], v4 offset:16384
  ds_read_b128 a[12:15], v4 offset:17408
  s_nop 5
  v_max3_f32 v6, v6, v16, v17
  v_max3_f32 v6, v6, v18, v19
  v_max3_f32 v6, v6, v20, v21
  v_max3_f32 v6, v6, v22, v23
  v_max3_f32 v7, v7, v24, v25
  v_max3_f32 v7, v7, v26, v27
  s_nop 1
  v_max3_f32 v7, v7, v28, v29
  v_max3_f32 v7, v7, v30, v31
L_sequential_preLN__sliding_block__dense_activation_relu__prompt_kernel_a1_8:
  s_waitcnt lgkmcnt(0)
  v_mfma_f32_16x16x32_bf16 v[16:19], a[8:11], a[0:3], v[44:47]
  v_mfma_f32_16x16x32_bf16 v[24:27], a[8:11], a[4:7], 0
  v_mfma_f32_16x16x32_bf16 v[28:31], a[12:15], a[4:7], v[44:47]
  s_nop 5
  v_max3_f32 v6, v6, v16, v17
  v_max3_f32 v6, v6, v18, v19
  v_max3_f32 v7, v7, v24, v25
  v_max3_f32 v7, v7, v26, v27
  s_nop 1
  v_max3_f32 v7, v7, v28, v29
  v_max3_f32 v7, v7, v30, v31
  v_mov_b32 v8, v6
  s_nop 1
  v_permlane16_swap_b32 v6, v8
  s_nop 1
  v_max_f32 v6, v6, v8
  v_mov_b32 v8, v6
  s_nop 1
  v_permlane32_swap_b32 v6, v8
  s_nop 1
  v_max_f32 v6, v6, v8
  v_mov_b32 v8, v7
  s_nop 1
  v_permlane16_swap_b32 v7, v8
  s_nop 1
  v_max_f32 v7, v7, v8
  v_mov_b32 v8, v7
  s_nop 1
  v_permlane32_swap_b32 v7, v8
  s_nop 1
  v_max_f32 v7, v7, v8
  v_sub_f32 v48, 0, v6
  v_sub_f32 v52, 0, v7
  v_sub_f32 v56, v40, v6
  v_sub_f32 v60, v44, v6
  v_sub_f32 v64, v40, v7
  v_sub_f32 v68, v44, v7
  v_sub_f32 v49, 0, v6
  v_sub_f32 v53, 0, v7
  v_sub_f32 v57, v41, v6
  v_sub_f32 v61, v45, v6
  v_sub_f32 v65, v41, v7
  v_sub_f32 v69, v45, v7
  v_sub_f32 v50, 0, v6
  v_sub_f32 v54, 0, v7
  v_sub_f32 v58, v42, v6
  v_sub_f32 v62, v46, v6
  v_sub_f32 v66, v42, v7
  v_sub_f32 v70, v46, v7
  v_sub_f32 v51, 0, v6
  v_sub_f32 v55, 0, v7
  v_sub_f32 v59, v43, v6
  v_sub_f32 v63, v47, v6
  v_sub_f32 v67, v43, v7
  v_sub_f32 v71, v47, v7
  ds_read_b128 a[8:11], v11
  ds_read_b128 a[12:15], v11 offset:1024
  ds_read_b128 a[16:19], v11
  ds_read_b128 a[20:23], v11 offset:1024
  s_lshl_b32 s28, s36, 10
  v_add_u32 v11, s28, v5
  ds_read_b128 a[24:27], v11
  ds_read_b128 a[28:31], v11 offset:12288
  ds_read_b128 a[32:35], v11
  ds_read_b128 a[36:39], v11 offset:12288
  s_cmp_eq_u32 s36, 1
  s_cbranch_scc1 L_sequential_preLN__sliding_block__dense_activation_relu__prompt_kernel_a2_1
  s_cmp_eq_u32 s36, 2
  s_cbranch_scc1 L_sequential_preLN__sliding_block__dense_activation_relu__prompt_kernel_a2_2
  s_cmp_eq_u32 s36, 3
  s_cbranch_scc1 L_sequential_preLN__sliding_block__dense_activation_relu__prompt_kernel_a2_3
  s_cmp_eq_u32 s36, 4
  s_cbranch_scc1 L_sequential_preLN__sliding_block__dense_activation_relu__prompt_kernel_a2_4
  s_cmp_eq_u32 s36, 5
  s_cbranch_scc1 L_sequential_preLN__sliding_block__dense_activation_relu__prompt_kernel_a2_5
  s_cmp_eq_u32 s36, 6
  s_cbranch_scc1 L_sequential_preLN__sliding_block__dense_activation_relu__prompt_kernel_a2_6
  s_cmp_eq_u32 s36, 7
  s_cbranch_scc1 L_sequential_preLN__sliding_block__dense_activation_relu__prompt_kernel_a2_7
  s_cmp_eq_u32 s36, 8
  s_cbranch_scc1 L_sequential_preLN__sliding_block__dense_activation_relu__prompt_kernel_a2_8
L_sequential_preLN__sliding_block__dense_activation_relu__prompt_kernel_a2_0:
  s_waitcnt lgkmcnt(0)
  v_mfma_f32_16x16x32_bf16 v[16:19], a[8:11], a[0:3], v[56:59]
  v_mfma_f32_16x16x32_bf16 v[20:23], a[12:15], a[0:3], v[48:51]
  v_mfma_f32_16x16x32_bf16 v[28:31], a[12:15], a[4:7], v[64:67]
  ds_read_b128 a[16:19], v4 offset:2048
  ds_read_b128 a[20:23], v4 offset:3072
  ds_read_b128 a[32:35], v5 offset:1024
  ds_read_b128 a[36:39], v5 offset:13312
  s_nop 3
  v_exp_f32 v16, v16
  v_exp_f32 v17, v17
  v_exp_f32 v18, v18
  v_exp_f32 v19, v19
  v_exp_f32 v20, v20
  v_exp_f32 v21, v21
  v_exp_f32 v22, v22
  v_exp_f32 v23, v23
  v_cvt_pk_bf16_f32 v32, v16, v17
  v_cvt_pk_bf16_f32 v33, v18, v19
  v_cvt_pk_bf16_f32 v34, v20, v21
  v_cvt_pk_bf16_f32 v35, v22, v23
  v_exp_f32 v28, v28
  v_exp_f32 v29, v29
  v_exp_f32 v30, v30
  v_exp_f32 v31, v31
  v_mfma_f32_16x16x32_bf16 v[72:75], a[24:27], v[32:35], v[72:75]
  v_mfma_f32_16x16x32_bf16 v[76:79], a[28:31], v[32:35], v[76:79]
  v_mfma_f32_16x16x32_bf16 v[80:83], a[40:43], v[32:35], v[80:83]
  v_mov_b32 v36, 0
  v_mov_b32 v37, 0
  v_cvt_pk_bf16_f32 v38, v28, v29
  v_cvt_pk_bf16_f32 v39, v30, v31
  s_nop 1
  v_mfma_f32_16x16x32_bf16 v[84:87], a[24:27], v[36:39], v[84:87]
  v_mfma_f32_16x16x32_bf16 v[88:91], a[28:31], v[36:39], v[88:91]
  v_mfma_f32_16x16x32_bf16 v[92:95], a[40:43], v[36:39], v[92:95]
L_sequential_preLN__sliding_block__dense_activation_relu__prompt_kernel_a2_1:
  s_waitcnt lgkmcnt(0)
  v_mfma_f32_16x16x32_bf16 v[16:19], a[16:19], a[0:3], v[48:51]
  v_mfma_f32_16x16x32_bf16 v[20:23], a[20:23], a[0:3], v[48:51]
  v_mfma_f32_16x16x32_bf16 v[24:27], a[16:19], a[4:7], v[52:55]
  v_mfma_f32_16x16x32_bf16 v[28:31], a[20:23], a[4:7], v[52:55]
  ds_read_b128 a[8:11], v4 offset:4096
  ds_read_b128 a[12:15], v4 offset:5120
  ds_read_b128 a[24:27], v5 offset:2048
  ds_read_b128 a[28:31], v5 offset:14336
  s_nop 3
  v_exp_f32 v16, v16
  v_exp_f32 v17, v17
  v_exp_f32 v18, v18
  v_exp_f32 v19, v19
  v_exp_f32 v20, v20
  v_exp_f32 v21, v21
  v_exp_f32 v22, v22
  v_exp_f32 v23, v23
  v_cvt_pk_bf16_f32 v32, v16, v17
  v_cvt_pk_bf16_f32 v33, v18, v19
  v_cvt_pk_bf16_f32 v34, v20, v21
  v_cvt_pk_bf16_f32 v35, v22, v23
  v_exp_f32 v24, v24
  v_exp_f32 v25, v25
  v_exp_f32 v26, v26
  v_exp_f32 v27, v27
  v_exp_f32 v28, v28
  v_exp_f32 v29, v29
  v_exp_f32 v30, v30
  v_exp_f32 v31, v31
  v_mfma_f32_16x16x32_bf16 v[72:75], a[32:35], v[32:35], v[72:75]
  v_mfma_f32_16x16x32_bf16 v[76:79], a[36:39], v[32:35], v[76:79]
  v_mfma_f32_16x16x32_bf16 v[80:83], a[40:43], v[32:35], v[80:83]
  v_cvt_pk_bf16_f32 v36, v24, v25
  v_cvt_pk_bf16_f32 v37, v26, v27
  v_cvt_pk_bf16_f32 v38, v28, v29
  v_cvt_pk_bf16_f32 v39, v30, v31
  s_nop 1
  v_mfma_f32_16x16x32_bf16 v[84:87], a[32:35], v[36:39], v[84:87]
  v_mfma_f32_16x16x32_bf16 v[88:91], a[36:39], v[36:39], v[88:91]
  v_mfma_f32_16x16x32_bf16 v[92:95], a[40:43], v[36:39], v[92:95]
L_sequential_preLN__sliding_block__dense_activation_relu__prompt_kernel_a2_2:
  s_waitcnt lgkmcnt(0)
  v_mfma_f32_16x16x32_bf16 v[16:19], a[8:11], a[0:3], v[48:51]
  v_mfma_f32_16x16x32_bf16 v[20:23], a[12:15], a[0:3], v[48:51]
  v_mfma_f32_16x16x32_bf16 v[24:27], a[8:11], a[4:7], v[52:55]
  v_mfma_f32_16x16x32_bf16 v[28:31], a[12:15], a[4:7], v[52:55]
  ds_read_b128 a[16:19], v4 offset:6144
  ds_read_b128 a[20:23], v4 offset:7168
  ds_read_b128 a[32:35], v5 offset:3072
  ds_read_b128 a[36:39], v5 offset:15360
  s_nop 3
  v_exp_f32 v16, v16
  v_exp_f32 v17, v17
  v_exp_f32 v18, v18
  v_exp_f32 v19, v19
  v_exp_f32 v20, v20
  v_exp_f32 v21, v21
  v_exp_f32 v22, v22
  v_exp_f32 v23, v23
  v_cvt_pk_bf16_f32 v32, v16, v17
  v_cvt_pk_bf16_f32 v33, v18, v19
  v_cvt_pk_bf16_f32 v34, v20, v21
  v_cvt_pk_bf16_f32 v35, v22, v23
  v_exp_f32 v24, v24
  v_exp_f32 v25, v25
  v_exp_f32 v26, v26
  v_exp_f32 v27, v27
  v_exp_f32 v28, v28
  v_exp_f32 v29, v29
  v_exp_f32 v30, v30
  v_exp_f32 v31, v31
  v_mfma_f32_16x16x32_bf16 v[72:75], a[24:27], v[32:35], v[72:75]
  v_mfma_f32_16x16x32_bf16 v[76:79], a[28:31], v[32:35], v[76:79]
  v_mfma_f32_16x16x32_bf16 v[80:83], a[40:43], v[32:35], v[80:83]
  v_cvt_pk_bf16_f32 v36, v24, v25
  v_cvt_pk_bf16_f32 v37, v26, v27
  v_cvt_pk_bf16_f32 v38, v28, v29
  v_cvt_pk_bf16_f32 v39, v30, v31
  s_nop 1
  v_mfma_f32_16x16x32_bf16 v[84:87], a[24:27], v[36:39], v[84:87]
  v_mfma_f32_16x16x32_bf16 v[88:91], a[28:31], v[36:39], v[88:91]
  v_mfma_f32_16x16x32_bf16 v[92:95], a[40:43], v[36:39], v[92:95]
L_sequential_preLN__sliding_block__dense_activation_relu__prompt_kernel_a2_3:
  s_waitcnt lgkmcnt(0)
  v_mfma_f32_16x16x32_bf16 v[16:19], a[16:19], a[0:3], v[48:51]
  v_mfma_f32_16x16x32_bf16 v[20:23], a[20:23], a[0:3], v[48:51]
  v_mfma_f32_16x16x32_bf16 v[24:27], a[16:19], a[4:7], v[52:55]
  v_mfma_f32_16x16x32_bf16 v[28:31], a[20:23], a[4:7], v[52:55]
  ds_read_b128 a[8:11], v4 offset:8192
  ds_read_b128 a[12:15], v4 offset:9216
  ds_read_b128 a[24:27], v5 offset:4096
  ds_read_b128 a[28:31], v5 offset:16384
  s_nop 3
  v_exp_f32 v16, v16
  v_exp_f32 v17, v17
  v_exp_f32 v18, v18
  v_exp_f32 v19, v19
  v_exp_f32 v20, v20
  v_exp_f32 v21, v21
  v_exp_f32 v22, v22
  v_exp_f32 v23, v23
  v_cvt_pk_bf16_f32 v32, v16, v17
  v_cvt_pk_bf16_f32 v33, v18, v19
  v_cvt_pk_bf16_f32 v34, v20, v21
  v_cvt_pk_bf16_f32 v35, v22, v23
  v_exp_f32 v24, v24
  v_exp_f32 v25, v25
  v_exp_f32 v26, v26
  v_exp_f32 v27, v27
  v_exp_f32 v28, v28
  v_exp_f32 v29, v29
  v_exp_f32 v30, v30
  v_exp_f32 v31, v31
  v_mfma_f32_16x16x32_bf16 v[72:75], a[32:35], v[32:35], v[72:75]
  v_mfma_f32_16x16x32_bf16 v[76:79], a[36:39], v[32:35], v[76:79]
  v_mfma_f32_16x16x32_bf16 v[80:83], a[40:43], v[32:35], v[80:83]
  v_cvt_pk_bf16_f32 v36, v24, v25
  v_cvt_pk_bf16_f32 v37, v26, v27
  v_cvt_pk_bf16_f32 v38, v28, v29
  v_cvt_pk_bf16_f32 v39, v30, v31
  s_nop 1
  v_mfma_f32_16x16x32_bf16 v[84:87], a[32:35], v[36:39], v[84:87]
  v_mfma_f32_16x16x32_bf16 v[88:91], a[36:39], v[36:39], v[88:91]
  v_mfma_f32_16x16x32_bf16 v[92:95], a[40:43], v[36:39], v[92:95]
L_sequential_preLN__sliding_block__dense_activation_relu__prompt_kernel_a2_4:
  s_waitcnt lgkmcnt(0)
  v_mfma_f32_16x16x32_bf16 v[16:19], a[8:11], a[0:3], v[48:51]
  v_mfma_f32_16x16x32_bf16 v[20:23], a[12:15], a[0:3], v[48:51]
  v_mfma_f32_16x16x32_bf16 v[24:27], a[8:11], a[4:7], v[52:55]
  v_mfma_f32_16x16x32_bf16 v[28:31], a[12:15], a[4:7], v[52:55]
  ds_read_b128 a[16:19], v4 offset:10240
  ds_read_b128 a[20:23], v4 offset:11264
  ds_read_b128 a[32:35], v5 offset:5120
  ds_read_b128 a[36:39], v5 offset:17408
  s_nop 3
  v_exp_f32 v16, v16
  v_exp_f32 v17, v17
  v_exp_f32 v18, v18
  v_exp_f32 v19, v19
  v_exp_f32 v20, v20
  v_exp_f32 v21, v21
  v_exp_f32 v22, v22
  v_exp_f32 v23, v23
  v_cvt_pk_bf16_f32 v32, v16, v17
  v_cvt_pk_bf16_f32 v33, v18, v19
  v_cvt_pk_bf16_f32 v34, v20, v21
  v_cvt_pk_bf16_f32 v35, v22, v23
  v_exp_f32 v24, v24
  v_exp_f32 v25, v25
  v_exp_f32 v26, v26
  v_exp_f32 v27, v27
  v_exp_f32 v28, v28
  v_exp_f32 v29, v29
  v_exp_f32 v30, v30
  v_exp_f32 v31, v31
  v_mfma_f32_16x16x32_bf16 v[72:75], a[24:27], v[32:35], v[72:75]
  v_mfma_f32_16x16x32_bf16 v[76:79], a[28:31], v[32:35], v[76:79]
  v_mfma_f32_16x16x32_bf16 v[80:83], a[40:43], v[32:35], v[80:83]
  v_cvt_pk_bf16_f32 v36, v24, v25
  v_cvt_pk_bf16_f32 v37, v26, v27
  v_cvt_pk_bf16_f32 v38, v28, v29
  v_cvt_pk_bf16_f32 v39, v30, v31
  s_nop 1
  v_mfma_f32_16x16x32_bf16 v[84:87], a[24:27], v[36:39], v[84:87]
  v_mfma_f32_16x16x32_bf16 v[88:91], a[28:31], v[36:39], v[88:91]
  v_mfma_f32_16x16x32_bf16 v[92:95], a[40:43], v[36:39], v[92:95]
L_sequential_preLN__sliding_block__dense_activation_relu__prompt_kernel_a2_5:
  s_waitcnt lgkmcnt(0)
  v_mfma_f32_16x16x32_bf16 v[16:19], a[16:19], a[0:3], v[48:51]
  v_mfma_f32_16x16x32_bf16 v[20:23], a[20:23], a[0:3], v[48:51]
  v_mfma_f32_16x16x32_bf16 v[24:27], a[16:19], a[4:7], v[52:55]
  v_mfma_f32_16x16x32_bf16 v[28:31], a[20:23], a[4:7], v[52:55]
  ds_read_b128 a[8:11], v4 offset:12288
  ds_read_b128 a[12:15], v4 offset:13312
  ds_read_b128 a[24:27], v5 offset:6144
  ds_read_b128 a[28:31], v5 offset:18432
  s_nop 3
  v_exp_f32 v16, v16
  v_exp_f32 v17, v17
  v_exp_f32 v18, v18
  v_exp_f32 v19, v19
  v_exp_f32 v20, v20
  v_exp_f32 v21, v21
  v_exp_f32 v22, v22
  v_exp_f32 v23, v23
  v_cvt_pk_bf16_f32 v32, v16, v17
  v_cvt_pk_bf16_f32 v33, v18, v19
  v_cvt_pk_bf16_f32 v34, v20, v21
  v_cvt_pk_bf16_f32 v35, v22, v23
  v_exp_f32 v24, v24
  v_exp_f32 v25, v25
  v_exp_f32 v26, v26
  v_exp_f32 v27, v27
  v_exp_f32 v28, v28
  v_exp_f32 v29, v29
  v_exp_f32 v30, v30
  v_exp_f32 v31, v31
  v_mfma_f32_16x16x32_bf16 v[72:75], a[32:35], v[32:35], v[72:75]
  v_mfma_f32_16x16x32_bf16 v[76:79], a[36:39], v[32:35], v[76:79]
  v_mfma_f32_16x16x32_bf16 v[80:83], a[40:43], v[32:35], v[80:83]
  v_cvt_pk_bf16_f32 v36, v24, v25
  v_cvt_pk_bf16_f32 v37, v26, v27
  v_cvt_pk_bf16_f32 v38, v28, v29
  v_cvt_pk_bf16_f32 v39, v30, v31
  s_nop 1
  v_mfma_f32_16x16x32_bf16 v[84:87], a[32:35], v[36:39], v[84:87]
  v_mfma_f32_16x16x32_bf16 v[88:91], a[36:39], v[36:39], v[88:91]
  v_mfma_f32_16x16x32_bf16 v[92:95], a[40:43], v[36:39], v[92:95]
L_sequential_preLN__sliding_block__dense_activation_relu__prompt_kernel_a2_6:
  s_waitcnt lgkmcnt(0)
  v_mfma_f32_16x16x32_bf16 v[16:19], a[8:11], a[0:3], v[48:51]
  v_mfma_f32_16x16x32_bf16 v[20:23], a[12:15], a[0:3], v[48:51]
  v_mfma_f32_16x16x32_bf16 v[24:27], a[8:11], a[4:7], v[52:55]
  v_mfma_f32_16x16x32_bf16 v[28:31], a[12:15], a[4:7], v[52:55]
  ds_read_b128 a[16:19], v4 offset:14336
  ds_read_b128 a[20:23], v4 offset:15360
  ds_read_b128 a[32:35], v5 offset:7168
  ds_read_b128 a[36:39], v5 offset:19456
  s_nop 3
  v_exp_f32 v16, v16
  v_exp_f32 v17, v17
  v_exp_f32 v18, v18
  v_exp_f32 v19, v19
  v_exp_f32 v20, v20
  v_exp_f32 v21, v21
  v_exp_f32 v22, v22
  v_exp_f32 v23, v23
  v_cvt_pk_bf16_f32 v32, v16, v17
  v_cvt_pk_bf16_f32 v33, v18, v19
  v_cvt_pk_bf16_f32 v34, v20, v21
  v_cvt_pk_bf16_f32 v35, v22, v23
  v_exp_f32 v24, v24
  v_exp_f32 v25, v25
  v_exp_f32 v26, v26
  v_exp_f32 v27, v27
  v_exp_f32 v28, v28
  v_exp_f32 v29, v29
  v_exp_f32 v30, v30
  v_exp_f32 v31, v31
  v_mfma_f32_16x16x32_bf16 v[72:75], a[24:27], v[32:35], v[72:75]
  v_mfma_f32_16x16x32_bf16 v[76:79], a[28:31], v[32:35], v[76:79]
  v_mfma_f32_16x16x32_bf16 v[80:83], a[40:43], v[32:35], v[80:83]
  v_cvt_pk_bf16_f32 v36, v24, v25
  v_cvt_pk_bf16_f32 v37, v26, v27
  v_cvt_pk_bf16_f32 v38, v28, v29
  v_cvt_pk_bf16_f32 v39, v30, v31
  s_nop 1
  v_mfma_f32_16x16x32_bf16 v[84:87], a[24:27], v[36:39], v[84:87]
  v_mfma_f32_16x16x32_bf16 v[88:91], a[28:31], v[36:39], v[88:91]
  v_mfma_f32_16x16x32_bf16 v[92:95], a[40:43], v[36:39], v[92:95]
L_sequential_preLN__sliding_block__dense_activation_relu__prompt_kernel_a2_7:
  s_waitcnt lgkmcnt(0)
  v_mfma_f32_16x16x32_bf16 v[16:19], a[16:19], a[0:3], v[48:51]
  v_mfma_f32_16x16x32_bf16 v[20:23], a[20:23], a[0:3], v[48:51]
  v_mfma_f32_16x16x32_bf16 v[24:27], a[16:19], a[4:7], v[52:55]
  v_mfma_f32_16x16x32_bf16 v[28:31], a[20:23], a[4:7], v[52:55]
  ds_read_b128 a[8:11], v4 offset:16384
  ds_read_b128 a[12:15], v4 offset:17408
  ds_read_b128 a[24:27], v5 offset:8192
  ds_read_b128 a[28:31], v5 offset:20480
  s_nop 3
  v_exp_f32 v16, v16
  v_exp_f32 v17, v17
  v_exp_f32 v18, v18
  v_exp_f32 v19, v19
  v_exp_f32 v20, v20
  v_exp_f32 v21, v21
  v_exp_f32 v22, v22
  v_exp_f32 v23, v23
  v_cvt_pk_bf16_f32 v32, v16, v17
  v_cvt_pk_bf16_f32 v33, v18, v19
  v_cvt_pk_bf16_f32 v34, v20, v21
  v_cvt_pk_bf16_f32 v35, v22, v23
  v_exp_f32 v24, v24
  v_exp_f32 v25, v25
  v_exp_f32 v26, v26
  v_exp_f32 v27, v27
  v_exp_f32 v28, v28
  v_exp_f32 v29, v29
  v_exp_f32 v30, v30
  v_exp_f32 v31, v31
  v_mfma_f32_16x16x32_bf16 v[72:75], a[32:35], v[32:35], v[72:75]
  v_mfma_f32_16x16x32_bf16 v[76:79], a[36:39], v[32:35], v[76:79]
  v_mfma_f32_16x16x32_bf16 v[80:83], a[40:43], v[32:35], v[80:83]
  v_cvt_pk_bf16_f32 v36, v24, v25
  v_cvt_pk_bf16_f32 v37, v26, v27
  v_cvt_pk_bf16_f32 v38, v28, v29
  v_cvt_pk_bf16_f32 v39, v30, v31
  s_nop 1
  v_mfma_f32_16x16x32_bf16 v[84:87], a[32:35], v[36:39], v[84:87]
  v_mfma_f32_16x16x32_bf16 v[88:91], a[36:39], v[36:39], v[88:91]
  v_mfma_f32_16x16x32_bf16 v[92:95], a[40:43], v[36:39], v[92:95]
L_sequential_preLN__sliding_block__dense_activation_relu__prompt_kernel_a2_8:
  s_waitcnt lgkmcnt(0)
  v_mfma_f32_16x16x32_bf16 v[16:19], a[8:11], a[0:3], v[60:63]
  v_mfma_f32_16x16x32_bf16 v[24:27], a[8:11], a[4:7], v[52:55]
  v_mfma_f32_16x16x32_bf16 v[28:31], a[12:15], a[4:7], v[68:71]
  s_nop 7
  v_exp_f32 v16, v16
  v_exp_f32 v17, v17
  v_exp_f32 v18, v18
  v_exp_f32 v19, v19
  s_nop 0
  v_cvt_pk_bf16_f32 v32, v16, v17
  v_cvt_pk_bf16_f32 v33, v18, v19
  v_mov_b32 v34, 0
  v_mov_b32 v35, 0
  v_exp_f32 v24, v24
  v_exp_f32 v25, v25
  v_exp_f32 v26, v26
  v_exp_f32 v27, v27
  v_exp_f32 v28, v28
  v_exp_f32 v29, v29
  v_exp_f32 v30, v30
  v_exp_f32 v31, v31
  v_mfma_f32_16x16x32_bf16 v[72:75], a[24:27], v[32:35], v[72:75]
  v_mfma_f32_16x16x32_bf16 v[76:79], a[28:31], v[32:35], v[76:79]
  v_mfma_f32_16x16x32_bf16 v[80:83], a[40:43], v[32:35], v[80:83]
  v_cvt_pk_bf16_f32 v36, v24, v25
  v_cvt_pk_bf16_f32 v37, v26, v27
  v_cvt_pk_bf16_f32 v38, v28, v29
  v_cvt_pk_bf16_f32 v39, v30, v31
  s_nop 1
  v_mfma_f32_16x16x32_bf16 v[84:87], a[24:27], v[36:39], v[84:87]
  v_mfma_f32_16x16x32_bf16 v[88:91], a[28:31], v[36:39], v[88:91]
  v_mfma_f32_16x16x32_bf16 v[92:95], a[40:43], v[36:39], v[92:95]
  s_nop 7
  s_nop 1
  s_lshl_b32 s28, s21, 1
  s_add_u32 s28, s28, s26
  s_lshl_b32 s28, s28, 17
  s_lshl_b32 s29, s20, 13
  s_add_u32 s28, s28, s29
  s_lshl_b32 s29, s27, 11
  s_add_u32 s28, s28, s29
  s_add_u32 s28, s28, 16777216
  v_rcp_f32 v8, v80
  s_nop 1
  v_mul_f32 v72, v72, v8
  v_mul_f32 v73, v73, v8
  v_mul_f32 v74, v74, v8
  v_mul_f32 v75, v75, v8
  v_mul_f32 v76, v76, v8
  v_mul_f32 v77, v77, v8
  v_mul_f32 v78, v78, v8
  v_mul_f32 v79, v79, v8
  v_cvt_pk_bf16_f32 v16, v72, v73
  v_cvt_pk_bf16_f32 v17, v74, v75
  v_cvt_pk_bf16_f32 v18, v76, v77
  v_cvt_pk_bf16_f32 v19, v78, v79
  buffer_store_dwordx4 v[16:19], v2, s[12:15], s28 offen offset:0 sc1
  v_rcp_f32 v8, v92
  s_nop 1
  v_mul_f32 v84, v84, v8
  v_mul_f32 v85, v85, v8
  v_mul_f32 v86, v86, v8
  v_mul_f32 v87, v87, v8
  v_mul_f32 v88, v88, v8
  v_mul_f32 v89, v89, v8
  v_mul_f32 v90, v90, v8
  v_mul_f32 v91, v91, v8
  v_cvt_pk_bf16_f32 v20, v84, v85
  v_cvt_pk_bf16_f32 v21, v86, v87
  v_cvt_pk_bf16_f32 v22, v88, v89
  v_cvt_pk_bf16_f32 v23, v90, v91
  buffer_store_dwordx4 v[20:23], v2, s[12:15], s28 offen offset:1024 sc1
  s_barrier
  s_cmp_ge_u32 s3, 4
  s_cbranch_scc1 L_sequential_preLN__sliding_block__dense_activation_relu__prompt_kernel_L3
  s_setprio 0
  v_and_b32 v1, 63, v0
  s_lshr_b32 s26, s3, 1
  s_and_b32 s27, s3, 1
  s_lshl_b32 s28, s26, 12
  s_add_u32 s28, s28, 0
  v_lshlrev_b32 v4, 4, v1
  v_add_u32 v4, s28, v4
  v_lshrrev_b32 v2, 2, v1
  v_bfe_u32 v3, v2, 1, 2
  v_mul_u32_u24 v2, 128, v2
  v_and_b32 v16, 3, v1
  v_lshlrev_b32 v16, 3, v16
  v_add_u32 v2, v2, v16
  v_add_u32 v2, 32768, v2
  s_cmp_eq_u32 s27, 0
  s_cselect_b32 s28, 0, 2
  s_cselect_b32 s29, 0, 0
  v_xor_b32 v16, s28, v3
  v_lshlrev_b32 v16, 5, v16
  v_add_u32 v16, s29, v16
  v_add_u32 v8, v16, v2
  s_cmp_eq_u32 s27, 0
  s_cselect_b32 s28, 1, 3
  s_cselect_b32 s29, 0, 0
  v_xor_b32 v16, s28, v3
  v_lshlrev_b32 v16, 5, v16
  v_add_u32 v16, s29, v16
  v_add_u32 v9, v16, v2
  v_mov_b32 v16, 0
  v_mov_b32 v17, 0
  v_mov_b32 v18, 0
  v_mov_b32 v19, 0
  v_mov_b32 v20, 0
  v_mov_b32 v21, 0
  v_mov_b32 v22, 0
  v_mov_b32 v23, 0
  v_mov_b32 v24, 0
  v_mov_b32 v25, 0
  v_mov_b32 v26, 0
  v_mov_b32 v27, 0
  v_mov_b32 v28, 0
  v_mov_b32 v29, 0
  v_mov_b32 v30, 0
  v_mov_b32 v31, 0
  v_mov_b32 v32, 0
  v_mov_b32 v33, 0
  v_mov_b32 v34, 0
  v_mov_b32 v35, 0
  v_mov_b32 v36, 0
  v_mov_b32 v37, 0
  v_mov_b32 v38, 0
  v_mov_b32 v39, 0
  v_mov_b32 v40, 0
  v_mov_b32 v41, 0
  v_mov_b32 v42, 0
  v_mov_b32 v43, 0
  v_mov_b32 v44, 0
  v_mov_b32 v45, 0
  v_mov_b32 v46, 0
  v_mov_b32 v47, 0
  v_and_b32 v2, 15, v1
  v_lshrrev_b32 v3, 4, v1
  v_lshlrev_b32 v2, 11, v2
  v_lshl_add_u32 v2, v3, 3, v2
  s_lshl_b32 s28, s20, 18
  s_lshl_b32 s29, s26, 17
  s_add_u32 s28, s28, s29
  s_lshl_b32 s29, s21, 7
  s_add_u32 s28, s28, s29
  s_lshl_b32 s29, s27, 6
  s_add_u32 s28, s28, s29
  buffer_load_dwordx2 v[64:65], v2, s[4:7], s28 offen offset:0
  buffer_load_dwordx2 v[66:67], v2, s[4:7], s28 offen offset:32
  s_add_u32 s28, s28, 32768
  buffer_load_dwordx2 v[68:69], v2, s[4:7], s28 offen offset:0
  buffer_load_dwordx2 v[70:71], v2, s[4:7], s28 offen offset:32
  s_add_u32 s28, s28, 32768
  buffer_load_dwordx2 v[72:73], v2, s[4:7], s28 offen offset:0
  buffer_load_dwordx2 v[74:75], v2, s[4:7], s28 offen offset:32
  s_add_u32 s28, s28, 32768
  buffer_load_dwordx2 v[76:77], v2, s[4:7], s28 offen offset:0
  buffer_load_dwordx2 v[78:79], v2, s[4:7], s28 offen offset:32
  s_add_u32 s28, s28, 32768
  s_waitcnt vmcnt(8)
  s_barrier
  s_barrier
  s_mov_b32 s23, 0
  v_add_u32 v6, s23, v4
  v_add_u32 v12, s23, v8
  v_add_u32 v13, s23, v9
  s_barrier
  ds_read_b64_tr_b16 a[16:17], v12 offset:0
  ds_read_b64_tr_b16 a[18:19], v12 offset:2048
  ds_read_b128 a[0:3], v6 offset:0
  ds_read_b128 a[4:7], v6 offset:1024
  ds_read_b128 a[8:11], v6 offset:2048
  ds_read_b128 a[12:15], v6 offset:3072
  ds_read_b64_tr_b16 a[20:21], v13 offset:0
  ds_read_b64_tr_b16 a[22:23], v13 offset:2048
  s_mov_b32 s22, 8
  s_waitcnt lgkmcnt(0)
  .p2align 6
L_sequential_preLN__sliding_block__dense_activation_relu__prompt_kernel_g3_c_loop:
  v_mfma_f32_16x16x32_bf16 v[16:19], a[16:19], a[0:3], v[16:19]
  ds_read_b64_tr_b16 a[40:41], v12 offset:4096
  ds_read_b64_tr_b16 a[42:43], v12 offset:6144
  v_mfma_f32_16x16x32_bf16 v[20:23], a[16:19], a[4:7], v[20:23]
  ds_read_b128 a[24:27], v6 offset:8192
  ds_read_b128 a[28:31], v6 offset:9216
  v_mfma_f32_16x16x32_bf16 v[24:27], a[16:19], a[8:11], v[24:27]
  ds_read_b128 a[32:35], v6 offset:10240
  v_mfma_f32_16x16x32_bf16 v[28:31], a[16:19], a[12:15], v[28:31]
  ds_read_b128 a[36:39], v6 offset:11264
  ds_read_b64_tr_b16 a[44:45], v13 offset:4096
  v_mfma_f32_16x16x32_bf16 v[32:35], a[20:23], a[0:3], v[32:35]
  ds_read_b64_tr_b16 a[46:47], v13 offset:6144
  v_mfma_f32_16x16x32_bf16 v[36:39], a[20:23], a[4:7], v[36:39]
  v_mfma_f32_16x16x32_bf16 v[40:43], a[20:23], a[8:11], v[40:43]
  v_mfma_f32_16x16x32_bf16 v[44:47], a[20:23], a[12:15], v[44:47]
  s_waitcnt lgkmcnt(0)
  v_mfma_f32_16x16x32_bf16 v[16:19], a[40:43], a[24:27], v[16:19]
  ds_read_b64_tr_b16 a[16:17], v12 offset:8192
  ds_read_b64_tr_b16 a[18:19], v12 offset:10240
  v_mfma_f32_16x16x32_bf16 v[20:23], a[40:43], a[28:31], v[20:23]
  ds_read_b128 a[0:3], v6 offset:16384
  ds_read_b128 a[4:7], v6 offset:17408
  v_mfma_f32_16x16x32_bf16 v[24:27], a[40:43], a[32:35], v[24:27]
  ds_read_b128 a[8:11], v6 offset:18432
  v_mfma_f32_16x16x32_bf16 v[28:31], a[40:43], a[36:39], v[28:31]
  ds_read_b128 a[12:15], v6 offset:19456
  ds_read_b64_tr_b16 a[20:21], v13 offset:8192
  v_mfma_f32_16x16x32_bf16 v[32:35], a[44:47], a[24:27], v[32:35]
  ds_read_b64_tr_b16 a[22:23], v13 offset:10240
  v_mfma_f32_16x16x32_bf16 v[36:39], a[44:47], a[28:31], v[36:39]
  v_mfma_f32_16x16x32_bf16 v[40:43], a[44:47], a[32:35], v[40:43]
  v_mfma_f32_16x16x32_bf16 v[44:47], a[44:47], a[36:39], v[44:47]
  s_waitcnt lgkmcnt(0)
  v_mfma_f32_16x16x32_bf16 v[16:19], a[16:19], a[0:3], v[16:19]
  ds_read_b64_tr_b16 a[40:41], v12 offset:12288
  ds_read_b64_tr_b16 a[42:43], v12 offset:14336
  v_mfma_f32_16x16x32_bf16 v[20:23], a[16:19], a[4:7], v[20:23]
  ds_read_b128 a[24:27], v6 offset:24576
  ds_read_b128 a[28:31], v6 offset:25600
  v_mfma_f32_16x16x32_bf16 v[24:27], a[16:19], a[8:11], v[24:27]
  ds_read_b128 a[32:35], v6 offset:26624
  v_mfma_f32_16x16x32_bf16 v[28:31], a[16:19], a[12:15], v[28:31]
  ds_read_b128 a[36:39], v6 offset:27648
  ds_read_b64_tr_b16 a[44:45], v13 offset:12288
  v_mfma_f32_16x16x32_bf16 v[32:35], a[20:23], a[0:3], v[32:35]
  ds_read_b64_tr_b16 a[46:47], v13 offset:14336
  v_mfma_f32_16x16x32_bf16 v[36:39], a[20:23], a[4:7], v[36:39]
  s_add_u32 s23, s23, 49152
  s_cmp_eq_u32 s23, 147456
  v_mfma_f32_16x16x32_bf16 v[40:43], a[20:23], a[8:11], v[40:43]
  s_cselect_b32 s23, 0, s23
  v_add_u32 v6, s23, v4
  v_mfma_f32_16x16x32_bf16 v[44:47], a[20:23], a[12:15], v[44:47]
  v_add_u32 v12, s23, v8
  v_add_u32 v13, s23, v9
  s_waitcnt lgkmcnt(0)
  s_barrier
  v_mfma_f32_16x16x32_bf16 v[16:19], a[40:43], a[24:27], v[16:19]
  ds_read_b64_tr_b16 a[16:17], v12 offset:0
  ds_read_b64_tr_b16 a[18:19], v12 offset:2048
  v_mfma_f32_16x16x32_bf16 v[20:23], a[40:43], a[28:31], v[20:23]
  ds_read_b128 a[0:3], v6 offset:0
  ds_read_b128 a[4:7], v6 offset:1024
  v_mfma_f32_16x16x32_bf16 v[24:27], a[40:43], a[32:35], v[24:27]
  ds_read_b128 a[8:11], v6 offset:2048
  v_mfma_f32_16x16x32_bf16 v[28:31], a[40:43], a[36:39], v[28:31]
  ds_read_b128 a[12:15], v6 offset:3072
  ds_read_b64_tr_b16 a[20:21], v13 offset:0
  v_mfma_f32_16x16x32_bf16 v[32:35], a[44:47], a[24:27], v[32:35]
  ds_read_b64_tr_b16 a[22:23], v13 offset:2048
  v_mfma_f32_16x16x32_bf16 v[36:39], a[44:47], a[28:31], v[36:39]
  s_sub_u32 s22, s22, 1
  v_mfma_f32_16x16x32_bf16 v[40:43], a[44:47], a[32:35], v[40:43]
  s_cmp_lg_u32 s22, 0
  v_mfma_f32_16x16x32_bf16 v[44:47], a[44:47], a[36:39], v[44:47]
  s_waitcnt lgkmcnt(0)
  s_cbranch_scc1 L_sequential_preLN__sliding_block__dense_activation_relu__prompt_kernel_g3_c_loop
  s_nop 7
  s_waitcnt vmcnt(0)
  s_lshr_b32 s26, s3, 1
  s_and_b32 s27, s3, 1
  v_lshlrev_b32 v14, 4, v1
  s_lshl_b32 s28, s21, 1
  s_add_u32 s28, s28, s27
  s_lshl_b32 s28, s28, 17
  s_lshl_b32 s29, s20, 13
  s_add_u32 s28, s28, s29
  s_lshl_b32 s29, s26, 12
  s_add_u32 s28, s28, s29
  s_add_u32 s28, s28, 20971520
  v_lshlrev_b32 v2, 16, v64
  v_and_b32 v3, 0xffff0000, v64
  v_add_f32 v16, v16, v2
  v_add_f32 v17, v17, v3
  v_cvt_pk_bf16_f32 v96, v16, v17
  v_lshlrev_b32 v2, 16, v65
  v_and_b32 v3, 0xffff0000, v65
  v_add_f32 v18, v18, v2
  v_add_f32 v19, v19, v3
  v_cvt_pk_bf16_f32 v97, v18, v19
  v_lshlrev_b32 v2, 16, v66
  v_and_b32 v3, 0xffff0000, v66
  v_add_f32 v32, v32, v2
  v_add_f32 v33, v33, v3
  v_cvt_pk_bf16_f32 v98, v32, v33
  v_lshlrev_b32 v2, 16, v67
  v_and_b32 v3, 0xffff0000, v67
  v_add_f32 v34, v34, v2
  v_add_f32 v35, v35, v3
  v_cvt_pk_bf16_f32 v99, v34, v35
  buffer_store_dwordx4 v[96:99], v14, s[12:15], s28 offen offset:0 sc1
  v_lshlrev_b32 v2, 16, v68
  v_and_b32 v3, 0xffff0000, v68
  v_add_f32 v20, v20, v2
  v_add_f32 v21, v21, v3
  v_cvt_pk_bf16_f32 v100, v20, v21
  v_lshlrev_b32 v2, 16, v69
  v_and_b32 v3, 0xffff0000, v69
  v_add_f32 v22, v22, v2
  v_add_f32 v23, v23, v3
  v_cvt_pk_bf16_f32 v101, v22, v23
  v_lshlrev_b32 v2, 16, v70
  v_and_b32 v3, 0xffff0000, v70
  v_add_f32 v36, v36, v2
  v_add_f32 v37, v37, v3
  v_cvt_pk_bf16_f32 v102, v36, v37
  v_lshlrev_b32 v2, 16, v71
  v_and_b32 v3, 0xffff0000, v71
  v_add_f32 v38, v38, v2
  v_add_f32 v39, v39, v3
  v_cvt_pk_bf16_f32 v103, v38, v39
  buffer_store_dwordx4 v[100:103], v14, s[12:15], s28 offen offset:1024 sc1
  v_lshlrev_b32 v2, 16, v72
  v_and_b32 v3, 0xffff0000, v72
  v_add_f32 v24, v24, v2
  v_add_f32 v25, v25, v3
  v_cvt_pk_bf16_f32 v104, v24, v25
  v_lshlrev_b32 v2, 16, v73
  v_and_b32 v3, 0xffff0000, v73
  v_add_f32 v26, v26, v2
  v_add_f32 v27, v27, v3
  v_cvt_pk_bf16_f32 v105, v26, v27
  v_lshlrev_b32 v2, 16, v74
  v_and_b32 v3, 0xffff0000, v74
  v_add_f32 v40, v40, v2
  v_add_f32 v41, v41, v3
  v_cvt_pk_bf16_f32 v106, v40, v41
  v_lshlrev_b32 v2, 16, v75
  v_and_b32 v3, 0xffff0000, v75
  v_add_f32 v42, v42, v2
  v_add_f32 v43, v43, v3
  v_cvt_pk_bf16_f32 v107, v42, v43
  buffer_store_dwordx4 v[104:107], v14, s[12:15], s28 offen offset:2048 sc1
  v_lshlrev_b32 v2, 16, v76
  v_and_b32 v3, 0xffff0000, v76
  v_add_f32 v28, v28, v2
  v_add_f32 v29, v29, v3
  v_cvt_pk_bf16_f32 v108, v28, v29
  v_lshlrev_b32 v2, 16, v77
  v_and_b32 v3, 0xffff0000, v77
  v_add_f32 v30, v30, v2
  v_add_f32 v31, v31, v3
  v_cvt_pk_bf16_f32 v109, v30, v31
  v_lshlrev_b32 v2, 16, v78
  v_and_b32 v3, 0xffff0000, v78
  v_add_f32 v44, v44, v2
  v_add_f32 v45, v45, v3
  v_cvt_pk_bf16_f32 v110, v44, v45
  v_lshlrev_b32 v2, 16, v79
  v_and_b32 v3, 0xffff0000, v79
  v_add_f32 v46, v46, v2
  v_add_f32 v47, v47, v3
  v_cvt_pk_bf16_f32 v111, v46, v47
  buffer_store_dwordx4 v[108:111], v14, s[12:15], s28 offen offset:3072 sc1
  v_add_f32 v84, v16, v17
  v_mul_f32 v88, v16, v16
  v_add_f32 v84, v84, v18
  v_add_f32 v84, v84, v19
  v_add_f32 v84, v84, v32
  v_add_f32 v84, v84, v33
  v_add_f32 v84, v84, v34
  v_add_f32 v84, v84, v35
  v_fmac_f32 v88, v17, v17
  v_fmac_f32 v88, v18, v18
  v_fmac_f32 v88, v19, v19
  v_fmac_f32 v88, v32, v32
  v_fmac_f32 v88, v33, v33
  v_fmac_f32 v88, v34, v34
  v_fmac_f32 v88, v35, v35
  v_add_f32 v85, v20, v21
  v_mul_f32 v89, v20, v20
  v_add_f32 v85, v85, v22
  v_add_f32 v85, v85, v23
  v_add_f32 v85, v85, v36
  v_add_f32 v85, v85, v37
  v_add_f32 v85, v85, v38
  v_add_f32 v85, v85, v39
  v_fmac_f32 v89, v21, v21
  v_fmac_f32 v89, v22, v22
  v_fmac_f32 v89, v23, v23
  v_fmac_f32 v89, v36, v36
  v_fmac_f32 v89, v37, v37
  v_fmac_f32 v89, v38, v38
  v_fmac_f32 v89, v39, v39
  v_add_f32 v86, v24, v25
  v_mul_f32 v90, v24, v24
  v_add_f32 v86, v86, v26
  v_add_f32 v86, v86, v27
  v_add_f32 v86, v86, v40
  v_add_f32 v86, v86, v41
  v_add_f32 v86, v86, v42
  v_add_f32 v86, v86, v43
  v_fmac_f32 v90, v25, v25
  v_fmac_f32 v90, v26, v26
  v_fmac_f32 v90, v27, v27
  v_fmac_f32 v90, v40, v40
  v_fmac_f32 v90, v41, v41
  v_fmac_f32 v90, v42, v42
  v_fmac_f32 v90, v43, v43
  v_add_f32 v87, v28, v29
  v_mul_f32 v91, v28, v28
  v_add_f32 v87, v87, v30
  v_add_f32 v87, v87, v31
  v_add_f32 v87, v87, v44
  v_add_f32 v87, v87, v45
  v_add_f32 v87, v87, v46
  v_add_f32 v87, v87, v47
  v_fmac_f32 v91, v29, v29
  v_fmac_f32 v91, v30, v30
  v_fmac_f32 v91, v31, v31
  v_fmac_f32 v91, v44, v44
  v_fmac_f32 v91, v45, v45
  v_fmac_f32 v91, v46, v46
  v_fmac_f32 v91, v47, v47
  s_nop 1
  v_permlane32_swap_b32 v84, v86
  v_permlane32_swap_b32 v85, v87
  s_nop 1
  v_add_f32 v84, v84, v86
  v_add_f32 v85, v85, v87
  s_nop 1
  v_permlane16_swap_b32 v84, v85
  s_nop 1
  v_add_f32 v84, v84, v85
  s_nop 1
  v_permlane32_swap_b32 v88, v90
  v_permlane32_swap_b32 v89, v91
  s_nop 1
  v_add_f32 v88, v88, v90
  v_add_f32 v89, v89, v91
  s_nop 1
  v_permlane16_swap_b32 v88, v89
  s_nop 1
  v_add_f32 v88, v88, v89
  v_mov_b32 v85, v88
  s_lshl_b32 s28, s20, 4
  s_add_u32 s28, s28, s21
  s_lshl_b32 s28, s28, 1
  s_add_u32 s28, s28, s26
  s_lshl_b32 s28, s28, 10
  s_lshl_b32 s29, s27, 3
  s_add_u32 s28, s28, s29
  s_add_u32 s28, s28, 2097152
  buffer_store_dwordx2 v[84:85], v14, s[12:15], s28 offen sc1
  s_barrier
  s_waitcnt vmcnt(0)
  s_barrier
  v_and_b32 v1, 63, v0
  s_lshr_b32 s26, s3, 1
  s_and_b32 s27, s3, 1
  s_lshl_b32 s28, s26, 12
  s_add_u32 s28, s28, 0
  v_lshlrev_b32 v4, 4, v1
  v_add_u32 v4, s28, v4
  v_lshrrev_b32 v2, 2, v1
  v_bfe_u32 v3, v2, 2, 1
  v_mul_u32_u24 v2, 448, v2
  v_and_b32 v16, 3, v1
  v_lshlrev_b32 v16, 3, v16
  v_add_u32 v2, v2, v16
  v_add_u32 v2, 16384, v2
  s_cmp_eq_u32 s27, 0
  s_cselect_b32 s28, 0, 1
  s_cselect_b32 s29, 0, 192
  v_xor_b32 v16, s28, v3
  v_lshlrev_b32 v16, 5, v16
  v_add_u32 v16, s29, v16
  v_add_u32 v8, v16, v2
  s_cmp_eq_u32 s27, 0
  s_cselect_b32 s28, 1, 0
  s_cselect_b32 s29, 0, 256
  v_xor_b32 v16, s28, v3
  v_lshlrev_b32 v16, 5, v16
  v_add_u32 v16, s29, v16
  v_add_u32 v9, v16, v2
  v_mov_b32 v16, 0
  v_mov_b32 v17, 0
  v_mov_b32 v18, 0
  v_mov_b32 v19, 0
  v_mov_b32 v20, 0
  v_mov_b32 v21, 0
  v_mov_b32 v22, 0
  v_mov_b32 v23, 0
  v_mov_b32 v24, 0
  v_mov_b32 v25, 0
  v_mov_b32 v26, 0
  v_mov_b32 v27, 0
  v_mov_b32 v28, 0
  v_mov_b32 v29, 0
  v_mov_b32 v30, 0
  v_mov_b32 v31, 0
  v_mov_b32 v32, 0
  v_mov_b32 v33, 0
  v_mov_b32 v34, 0
  v_mov_b32 v35, 0
  v_mov_b32 v36, 0
  v_mov_b32 v37, 0
  v_mov_b32 v38, 0
  v_mov_b32 v39, 0
  v_mov_b32 v40, 0
  v_mov_b32 v41, 0
  v_mov_b32 v42, 0
  v_mov_b32 v43, 0
  v_mov_b32 v44, 0
  v_mov_b32 v45, 0
  v_mov_b32 v46, 0
  v_mov_b32 v47, 0
  v_mov_b32 v48, 0
  v_mov_b32 v49, 0
  v_mov_b32 v50, 0
  v_mov_b32 v51, 0
  v_mov_b32 v52, 0
  v_mov_b32 v53, 0
  v_mov_b32 v54, 0
  v_mov_b32 v55, 0
  v_mov_b32 v56, 0
  v_mov_b32 v57, 0
  v_mov_b32 v58, 0
  v_mov_b32 v59, 0
  v_mov_b32 v60, 0
  v_mov_b32 v61, 0
  v_mov_b32 v62, 0
  v_mov_b32 v63, 0
  v_mov_b32 v64, 0
  v_mov_b32 v65, 0
  v_mov_b32 v66, 0
  v_mov_b32 v67, 0
  v_mov_b32 v68, 0
  v_mov_b32 v69, 0
  v_mov_b32 v70, 0
  v_mov_b32 v71, 0
  v_mov_b32 v72, 0
  v_mov_b32 v73, 0
  v_mov_b32 v74, 0
  v_mov_b32 v75, 0
  v_mov_b32 v76, 0
  v_mov_b32 v77, 0
  v_mov_b32 v78, 0
  v_mov_b32 v79, 0
  v_mov_b32 v80, 0
  v_mov_b32 v81, 0
  v_mov_b32 v82, 0
  v_mov_b32 v83, 0
  v_mov_b32 v84, 0
  v_mov_b32 v85, 0
  v_mov_b32 v86, 0
  v_mov_b32 v87, 0
  v_mov_b32 v88, 0
  v_mov_b32 v89, 0
  v_mov_b32 v90, 0
  v_mov_b32 v91, 0
  v_mov_b32 v92, 0
  v_mov_b32 v93, 0
  v_mov_b32 v94, 0
  v_mov_b32 v95, 0
  v_mov_b32 v96, 0
  v_mov_b32 v97, 0
  v_mov_b32 v98, 0
  v_mov_b32 v99, 0
  v_mov_b32 v100, 0
  v_mov_b32 v101, 0
  v_mov_b32 v102, 0
  v_mov_b32 v103, 0
  v_mov_b32 v104, 0
  v_mov_b32 v105, 0
  v_mov_b32 v106, 0
  v_mov_b32 v107, 0
  v_mov_b32 v108, 0
  v_mov_b32 v109, 0
  v_mov_b32 v110, 0
  v_mov_b32 v111, 0
  v_mov_b32 v112, 0
  v_mov_b32 v113, 0
  v_mov_b32 v114, 0
  v_mov_b32 v115, 0
  v_mov_b32 v116, 0
  v_mov_b32 v117, 0
  v_mov_b32 v118, 0
  v_mov_b32 v119, 0
  v_mov_b32 v120, 0
  v_mov_b32 v121, 0
  v_mov_b32 v122, 0
  v_mov_b32 v123, 0
  v_mov_b32 v124, 0
  v_mov_b32 v125, 0
  v_mov_b32 v126, 0
  v_mov_b32 v127, 0
  s_barrier
  s_mov_b32 s23, 0
  v_add_u32 v6, s23, v4
  v_add_u32 v12, s23, v8
  v_add_u32 v13, s23, v9
  s_barrier
  ds_read_b64_tr_b16 a[16:17], v12 offset:0
  ds_read_b64_tr_b16 a[18:19], v12 offset:7168
  ds_read_b128 a[0:3], v6 offset:0
  ds_read_b128 a[4:7], v6 offset:1024
  ds_read_b128 a[8:11], v6 offset:2048
  ds_read_b128 a[12:15], v6 offset:3072
  ds_read_b64_tr_b16 a[20:21], v13 offset:0
  ds_read_b64_tr_b16 a[22:23], v13 offset:7168
  ds_read_b64_tr_b16 a[24:25], v12 offset:64
  ds_read_b64_tr_b16 a[26:27], v12 offset:7232
  ds_read_b64_tr_b16 a[28:29], v13 offset:64
  ds_read_b64_tr_b16 a[30:31], v13 offset:7232
  ds_read_b64_tr_b16 a[32:33], v12 offset:128
  ds_read_b64_tr_b16 a[34:35], v12 offset:7296
  ds_read_b64_tr_b16 a[36:37], v13 offset:128
  ds_read_b64_tr_b16 a[38:39], v13 offset:7296
  ds_read_b64_tr_b16 a[40:41], v12 offset:192
  ds_read_b64_tr_b16 a[42:43], v12 offset:7360
  s_mov_b32 s22, 16
  s_waitcnt lgkmcnt(0)
  .p2align 6
L_sequential_preLN__sliding_block__dense_activation_relu__prompt_kernel_g4_c_loop:
  v_mfma_f32_16x16x32_bf16 v[16:19], a[16:19], a[0:3], v[16:19]
  ds_read_b64_tr_b16 a[60:61], v12 offset:14336
  v_mfma_f32_16x16x32_bf16 v[20:23], a[16:19], a[4:7], v[20:23]
  ds_read_b64_tr_b16 a[62:63], v12 offset:21504
  v_mfma_f32_16x16x32_bf16 v[24:27], a[16:19], a[8:11], v[24:27]
  ds_read_b128 a[44:47], v6 offset:8192
  v_mfma_f32_16x16x32_bf16 v[28:31], a[16:19], a[12:15], v[28:31]
  ds_read_b128 a[48:51], v6 offset:9216
  v_mfma_f32_16x16x32_bf16 v[32:35], a[20:23], a[0:3], v[32:35]
  ds_read_b128 a[52:55], v6 offset:10240
  v_mfma_f32_16x16x32_bf16 v[36:39], a[20:23], a[4:7], v[36:39]
  ds_read_b128 a[56:59], v6 offset:11264
  v_mfma_f32_16x16x32_bf16 v[40:43], a[20:23], a[8:11], v[40:43]
  ds_read_b64_tr_b16 a[64:65], v13 offset:14336
  v_mfma_f32_16x16x32_bf16 v[44:47], a[20:23], a[12:15], v[44:47]
  ds_read_b64_tr_b16 a[66:67], v13 offset:21504
  v_mfma_f32_16x16x32_bf16 v[48:51], a[24:27], a[0:3], v[48:51]
  ds_read_b64_tr_b16 a[68:69], v12 offset:14400
  v_mfma_f32_16x16x32_bf16 v[52:55], a[24:27], a[4:7], v[52:55]
  ds_read_b64_tr_b16 a[70:71], v12 offset:21568
  v_mfma_f32_16x16x32_bf16 v[56:59], a[24:27], a[8:11], v[56:59]
  ds_read_b64_tr_b16 a[72:73], v13 offset:14400
  v_mfma_f32_16x16x32_bf16 v[60:63], a[24:27], a[12:15], v[60:63]
  ds_read_b64_tr_b16 a[74:75], v13 offset:21568
  v_mfma_f32_16x16x32_bf16 v[64:67], a[28:31], a[0:3], v[64:67]
  ds_read_b64_tr_b16 a[76:77], v12 offset:14464
  v_mfma_f32_16x16x32_bf16 v[68:71], a[28:31], a[4:7], v[68:71]
  ds_read_b64_tr_b16 a[78:79], v12 offset:21632
  v_mfma_f32_16x16x32_bf16 v[72:75], a[28:31], a[8:11], v[72:75]
  ds_read_b64_tr_b16 a[80:81], v13 offset:14464
  v_mfma_f32_16x16x32_bf16 v[76:79], a[28:31], a[12:15], v[76:79]
  ds_read_b64_tr_b16 a[82:83], v13 offset:21632
  v_mfma_f32_16x16x32_bf16 v[80:83], a[32:35], a[0:3], v[80:83]
  ds_read_b64_tr_b16 a[84:85], v12 offset:14528
  v_mfma_f32_16x16x32_bf16 v[84:87], a[32:35], a[4:7], v[84:87]
  ds_read_b64_tr_b16 a[86:87], v12 offset:21696
  v_mfma_f32_16x16x32_bf16 v[88:91], a[32:35], a[8:11], v[88:91]
  s_add_u32 s23, s23, 45056
  v_mfma_f32_16x16x32_bf16 v[92:95], a[32:35], a[12:15], v[92:95]
  s_cmp_eq_u32 s23, 135168
  v_mfma_f32_16x16x32_bf16 v[96:99], a[36:39], a[0:3], v[96:99]
  v_mfma_f32_16x16x32_bf16 v[100:103], a[36:39], a[4:7], v[100:103]
  s_cselect_b32 s23, 0, s23
  v_mfma_f32_16x16x32_bf16 v[104:107], a[36:39], a[8:11], v[104:107]
  v_mfma_f32_16x16x32_bf16 v[108:111], a[36:39], a[12:15], v[108:111]
  v_add_u32 v6, s23, v4
  v_mfma_f32_16x16x32_bf16 v[112:115], a[40:43], a[0:3], v[112:115]
  v_add_u32 v12, s23, v8
  v_mfma_f32_16x16x32_bf16 v[116:119], a[40:43], a[4:7], v[116:119]
  v_mfma_f32_16x16x32_bf16 v[120:123], a[40:43], a[8:11], v[120:123]
  v_add_u32 v13, s23, v9
  v_mfma_f32_16x16x32_bf16 v[124:127], a[40:43], a[12:15], v[124:127]
  s_waitcnt lgkmcnt(0)
  s_barrier
  v_mfma_f32_16x16x32_bf16 v[16:19], a[60:63], a[44:47], v[16:19]
  ds_read_b64_tr_b16 a[16:17], v12 offset:0
  v_mfma_f32_16x16x32_bf16 v[20:23], a[60:63], a[48:51], v[20:23]
  ds_read_b64_tr_b16 a[18:19], v12 offset:7168
  v_mfma_f32_16x16x32_bf16 v[24:27], a[60:63], a[52:55], v[24:27]
  ds_read_b128 a[0:3], v6 offset:0
  v_mfma_f32_16x16x32_bf16 v[28:31], a[60:63], a[56:59], v[28:31]
  ds_read_b128 a[4:7], v6 offset:1024
  v_mfma_f32_16x16x32_bf16 v[32:35], a[64:67], a[44:47], v[32:35]
  ds_read_b128 a[8:11], v6 offset:2048
  v_mfma_f32_16x16x32_bf16 v[36:39], a[64:67], a[48:51], v[36:39]
  ds_read_b128 a[12:15], v6 offset:3072
  v_mfma_f32_16x16x32_bf16 v[40:43], a[64:67], a[52:55], v[40:43]
  ds_read_b64_tr_b16 a[20:21], v13 offset:0
  v_mfma_f32_16x16x32_bf16 v[44:47], a[64:67], a[56:59], v[44:47]
  ds_read_b64_tr_b16 a[22:23], v13 offset:7168
  v_mfma_f32_16x16x32_bf16 v[48:51], a[68:71], a[44:47], v[48:51]
  ds_read_b64_tr_b16 a[24:25], v12 offset:64
  v_mfma_f32_16x16x32_bf16 v[52:55], a[68:71], a[48:51], v[52:55]
  ds_read_b64_tr_b16 a[26:27], v12 offset:7232
  v_mfma_f32_16x16x32_bf16 v[56:59], a[68:71], a[52:55], v[56:59]
  ds_read_b64_tr_b16 a[28:29], v13 offset:64
  v_mfma_f32_16x16x32_bf16 v[60:63], a[68:71], a[56:59], v[60:63]
  ds_read_b64_tr_b16 a[30:31], v13 offset:7232
  v_mfma_f32_16x16x32_bf16 v[64:67], a[72:75], a[44:47], v[64:67]
  ds_read_b64_tr_b16 a[32:33], v12 offset:128
  v_mfma_f32_16x16x32_bf16 v[68:71], a[72:75], a[48:51], v[68:71]
  ds_read_b64_tr_b16 a[34:35], v12 offset:7296
  v_mfma_f32_16x16x32_bf16 v[72:75], a[72:75], a[52:55], v[72:75]
  ds_read_b64_tr_b16 a[36:37], v13 offset:128
  v_mfma_f32_16x16x32_bf16 v[76:79], a[72:75], a[56:59], v[76:79]
  ds_read_b64_tr_b16 a[38:39], v13 offset:7296
  v_mfma_f32_16x16x32_bf16 v[80:83], a[76:79], a[44:47], v[80:83]
  ds_read_b64_tr_b16 a[40:41], v12 offset:192
  v_mfma_f32_16x16x32_bf16 v[84:87], a[76:79], a[48:51], v[84:87]
  ds_read_b64_tr_b16 a[42:43], v12 offset:7360
  v_mfma_f32_16x16x32_bf16 v[88:91], a[76:79], a[52:55], v[88:91]
  s_sub_u32 s22, s22, 1
  v_mfma_f32_16x16x32_bf16 v[92:95], a[76:79], a[56:59], v[92:95]
  v_mfma_f32_16x16x32_bf16 v[96:99], a[80:83], a[44:47], v[96:99]
  v_mfma_f32_16x16x32_bf16 v[100:103], a[80:83], a[48:51], v[100:103]
  v_mfma_f32_16x16x32_bf16 v[104:107], a[80:83], a[52:55], v[104:107]
  v_mfma_f32_16x16x32_bf16 v[108:111], a[80:83], a[56:59], v[108:111]
  s_cmp_lg_u32 s22, 0
  v_mfma_f32_16x16x32_bf16 v[112:115], a[84:87], a[44:47], v[112:115]
  v_mfma_f32_16x16x32_bf16 v[116:119], a[84:87], a[48:51], v[116:119]
  v_mfma_f32_16x16x32_bf16 v[120:123], a[84:87], a[52:55], v[120:123]
  v_mfma_f32_16x16x32_bf16 v[124:127], a[84:87], a[56:59], v[124:127]
  s_waitcnt lgkmcnt(0)
  s_cbranch_scc1 L_sequential_preLN__sliding_block__dense_activation_relu__prompt_kernel_g4_c_loop
  s_lshr_b32 s26, s3, 1
  s_and_b32 s27, s3, 1
  v_and_b32 v14, 15, v1
  v_lshrrev_b32 v15, 4, v1
  s_lshl_b32 s28, s26, 9
  s_add_u32 s28, s28, 155648
  v_lshl_add_u32 v10, v14, 3, s28
  ds_read_b32 v2, v10 offset:0
  ds_read_b32 v3, v10 offset:128
  ds_read_b32 v4, v10 offset:256
  ds_read_b32 v5, v10 offset:384
  s_mul_i32 s29, s27, 448
  s_add_u32 s29, s29, 156672
  v_lshl_add_u32 v11, v15, 4, s29
  v_lshlrev_b32 v14, 4, v1
  s_mul_i32 s28, s21, 917504
  s_lshl_b32 s29, s20, 13
  s_add_u32 s28, s28, s29
  s_lshl_b32 s29, s26, 12
  s_add_u32 s28, s28, s29
  s_add_u32 s28, s28, 25165824
  s_cmp_eq_u32 s27, 0
  s_cbranch_scc0 L_sequential_preLN__sliding_block__dense_activation_relu__prompt_kernel_epi_skip0
  ds_read_b128 v[6:9], v11 offset:384
  s_waitcnt lgkmcnt(0)
  v_fmac_f32 v112, v6, v2
  v_fmac_f32 v113, v7, v2
  v_fmac_f32 v114, v8, v2
  v_fmac_f32 v115, v9, v2
  v_cvt_pk_bf16_f32 v12, v112, v113
  v_cvt_pk_bf16_f32 v13, v114, v115
  v_pk_max_i16 v12, v12, 0
  v_pk_max_i16 v13, v13, 0
  s_add_u32 s29, s28, 393216
  v_mov_b32 v112, v12
  v_mov_b32 v113, v13
  buffer_store_dwordx2 v[112:113], v14, s[12:15], s29 offen offset:0 sc1
  v_fmac_f32 v116, v6, v3
  v_fmac_f32 v117, v7, v3
  v_fmac_f32 v118, v8, v3
  v_fmac_f32 v119, v9, v3
  v_cvt_pk_bf16_f32 v12, v116, v117
  v_cvt_pk_bf16_f32 v13, v118, v119
  v_pk_max_i16 v12, v12, 0
  v_pk_max_i16 v13, v13, 0
  s_add_u32 s29, s28, 394240
  v_mov_b32 v116, v12
  v_mov_b32 v117, v13
  buffer_store_dwordx2 v[116:117], v14, s[12:15], s29 offen offset:0 sc1
  v_fmac_f32 v120, v6, v4
  v_fmac_f32 v121, v7, v4
  v_fmac_f32 v122, v8, v4
  v_fmac_f32 v123, v9, v4
  v_cvt_pk_bf16_f32 v12, v120, v121
  v_cvt_pk_bf16_f32 v13, v122, v123
  v_pk_max_i16 v12, v12, 0
  v_pk_max_i16 v13, v13, 0
  s_add_u32 s29, s28, 395264
  v_mov_b32 v120, v12
  v_mov_b32 v121, v13
  buffer_store_dwordx2 v[120:121], v14, s[12:15], s29 offen offset:0 sc1
  v_fmac_f32 v124, v6, v5
  v_fmac_f32 v125, v7, v5
  v_fmac_f32 v126, v8, v5
  v_fmac_f32 v127, v9, v5
  v_cvt_pk_bf16_f32 v12, v124, v125
  v_cvt_pk_bf16_f32 v13, v126, v127
  v_pk_max_i16 v12, v12, 0
  v_pk_max_i16 v13, v13, 0
  s_add_u32 s29, s28, 396288
  v_mov_b32 v124, v12
  v_mov_b32 v125, v13
  buffer_store_dwordx2 v[124:125], v14, s[12:15], s29 offen offset:0 sc1
  s_nop 0
  ds_read_b128 v[6:9], v11 offset:0
  ds_read_b128 a[0:3], v11 offset:64
  s_waitcnt lgkmcnt(0)
  v_fmac_f32 v16, v6, v2
  v_fmac_f32 v17, v7, v2
  v_fmac_f32 v18, v8, v2
  v_fmac_f32 v19, v9, v2
  v_cvt_pk_bf16_f32 v16, v16, v17
  v_cvt_pk_bf16_f32 v17, v18, v19
  v_fmac_f32 v20, v6, v3
  v_fmac_f32 v21, v7, v3
  v_fmac_f32 v22, v8, v3
  v_fmac_f32 v23, v9, v3
  v_cvt_pk_bf16_f32 v20, v20, v21
  v_cvt_pk_bf16_f32 v21, v22, v23
  v_fmac_f32 v24, v6, v4
  v_fmac_f32 v25, v7, v4
  v_fmac_f32 v26, v8, v4
  v_fmac_f32 v27, v9, v4
  v_cvt_pk_bf16_f32 v24, v24, v25
  v_cvt_pk_bf16_f32 v25, v26, v27
  v_fmac_f32 v28, v6, v5
  v_fmac_f32 v29, v7, v5
  v_fmac_f32 v30, v8, v5
  v_fmac_f32 v31, v9, v5
  v_cvt_pk_bf16_f32 v28, v28, v29
  v_cvt_pk_bf16_f32 v29, v30, v31
  v_accvgpr_read_b32 v6, a0
  v_accvgpr_read_b32 v7, a1
  v_accvgpr_read_b32 v8, a2
  v_accvgpr_read_b32 v9, a3
  v_fmac_f32 v32, v6, v2
  v_fmac_f32 v33, v7, v2
  v_fmac_f32 v34, v8, v2
  v_fmac_f32 v35, v9, v2
  v_cvt_pk_bf16_f32 v18, v32, v33
  v_cvt_pk_bf16_f32 v19, v34, v35
  v_pk_max_i16 v16, v16, 0
  v_pk_max_i16 v17, v17, 0
  v_pk_max_i16 v18, v18, 0
  v_pk_max_i16 v19, v19, 0
  s_add_u32 s29, s28, 0
  buffer_store_dwordx4 v[16:19], v14, s[12:15], s29 offen sc1
  v_fmac_f32 v36, v6, v3
  v_fmac_f32 v37, v7, v3
  v_fmac_f32 v38, v8, v3
  v_fmac_f32 v39, v9, v3
  v_cvt_pk_bf16_f32 v22, v36, v37
  v_cvt_pk_bf16_f32 v23, v38, v39
  v_pk_max_i16 v20, v20, 0
  v_pk_max_i16 v21, v21, 0
  v_pk_max_i16 v22, v22, 0
  v_pk_max_i16 v23, v23, 0
  s_add_u32 s29, s28, 1024
  buffer_store_dwordx4 v[20:23], v14, s[12:15], s29 offen sc1
  v_fmac_f32 v40, v6, v4
  v_fmac_f32 v41, v7, v4
  v_fmac_f32 v42, v8, v4
  v_fmac_f32 v43, v9, v4
  v_cvt_pk_bf16_f32 v26, v40, v41
  v_cvt_pk_bf16_f32 v27, v42, v43
  v_pk_max_i16 v24, v24, 0
  v_pk_max_i16 v25, v25, 0
  v_pk_max_i16 v26, v26, 0
  v_pk_max_i16 v27, v27, 0
  s_add_u32 s29, s28, 2048
  buffer_store_dwordx4 v[24:27], v14, s[12:15], s29 offen sc1
  v_fmac_f32 v44, v6, v5
  v_fmac_f32 v45, v7, v5
  v_fmac_f32 v46, v8, v5
  v_fmac_f32 v47, v9, v5
  v_cvt_pk_bf16_f32 v30, v44, v45
  v_cvt_pk_bf16_f32 v31, v46, v47
  v_pk_max_i16 v28, v28, 0
  v_pk_max_i16 v29, v29, 0
  v_pk_max_i16 v30, v30, 0
  v_pk_max_i16 v31, v31, 0
  s_add_u32 s29, s28, 3072
  buffer_store_dwordx4 v[28:31], v14, s[12:15], s29 offen sc1
  ds_read_b128 v[6:9], v11 offset:128
  ds_read_b128 a[0:3], v11 offset:192
  s_waitcnt lgkmcnt(0)
  v_fmac_f32 v48, v6, v2
  v_fmac_f32 v49, v7, v2
  v_fmac_f32 v50, v8, v2
  v_fmac_f32 v51, v9, v2
  v_cvt_pk_bf16_f32 v48, v48, v49
  v_cvt_pk_bf16_f32 v49, v50, v51
  v_fmac_f32 v52, v6, v3
  v_fmac_f32 v53, v7, v3
  v_fmac_f32 v54, v8, v3
  v_fmac_f32 v55, v9, v3
  v_cvt_pk_bf16_f32 v52, v52, v53
  v_cvt_pk_bf16_f32 v53, v54, v55
  v_fmac_f32 v56, v6, v4
  v_fmac_f32 v57, v7, v4
  v_fmac_f32 v58, v8, v4
  v_fmac_f32 v59, v9, v4
  v_cvt_pk_bf16_f32 v56, v56, v57
  v_cvt_pk_bf16_f32 v57, v58, v59
  v_fmac_f32 v60, v6, v5
  v_fmac_f32 v61, v7, v5
  v_fmac_f32 v62, v8, v5
  v_fmac_f32 v63, v9, v5
  v_cvt_pk_bf16_f32 v60, v60, v61
  v_cvt_pk_bf16_f32 v61, v62, v63
  v_accvgpr_read_b32 v6, a0
  v_accvgpr_read_b32 v7, a1
  v_accvgpr_read_b32 v8, a2
  v_accvgpr_read_b32 v9, a3
  v_fmac_f32 v64, v6, v2
  v_fmac_f32 v65, v7, v2
  v_fmac_f32 v66, v8, v2
  v_fmac_f32 v67, v9, v2
  v_cvt_pk_bf16_f32 v50, v64, v65
  v_cvt_pk_bf16_f32 v51, v66, v67
  v_pk_max_i16 v48, v48, 0
  v_pk_max_i16 v49, v49, 0
  v_pk_max_i16 v50, v50, 0
  v_pk_max_i16 v51, v51, 0
  s_add_u32 s29, s28, 131072
  buffer_store_dwordx4 v[48:51], v14, s[12:15], s29 offen sc1
  v_fmac_f32 v68, v6, v3
  v_fmac_f32 v69, v7, v3
  v_fmac_f32 v70, v8, v3
  v_fmac_f32 v71, v9, v3
  v_cvt_pk_bf16_f32 v54, v68, v69
  v_cvt_pk_bf16_f32 v55, v70, v71
  v_pk_max_i16 v52, v52, 0
  v_pk_max_i16 v53, v53, 0
  v_pk_max_i16 v54, v54, 0
  v_pk_max_i16 v55, v55, 0
  s_add_u32 s29, s28, 132096
  buffer_store_dwordx4 v[52:55], v14, s[12:15], s29 offen sc1
  v_fmac_f32 v72, v6, v4
  v_fmac_f32 v73, v7, v4
  v_fmac_f32 v74, v8, v4
  v_fmac_f32 v75, v9, v4
  v_cvt_pk_bf16_f32 v58, v72, v73
  v_cvt_pk_bf16_f32 v59, v74, v75
  v_pk_max_i16 v56, v56, 0
  v_pk_max_i16 v57, v57, 0
  v_pk_max_i16 v58, v58, 0
  v_pk_max_i16 v59, v59, 0
  s_add_u32 s29, s28, 133120
  buffer_store_dwordx4 v[56:59], v14, s[12:15], s29 offen sc1
  v_fmac_f32 v76, v6, v5
  v_fmac_f32 v77, v7, v5
  v_fmac_f32 v78, v8, v5
  v_fmac_f32 v79, v9, v5
  v_cvt_pk_bf16_f32 v62, v76, v77
  v_cvt_pk_bf16_f32 v63, v78, v79
  v_pk_max_i16 v60, v60, 0
  v_pk_max_i16 v61, v61, 0
  v_pk_max_i16 v62, v62, 0
  v_pk_max_i16 v63, v63, 0
  s_add_u32 s29, s28, 134144
  buffer_store_dwordx4 v[60:63], v14, s[12:15], s29 offen sc1
  ds_read_b128 v[6:9], v11 offset:256
  ds_read_b128 a[0:3], v11 offset:320
  s_waitcnt lgkmcnt(0)
  v_fmac_f32 v80, v6, v2
  v_fmac_f32 v81, v7, v2
  v_fmac_f32 v82, v8, v2
  v_fmac_f32 v83, v9, v2
  v_cvt_pk_bf16_f32 v80, v80, v81
  v_cvt_pk_bf16_f32 v81, v82, v83
  v_fmac_f32 v84, v6, v3
  v_fmac_f32 v85, v7, v3
  v_fmac_f32 v86, v8, v3
  v_fmac_f32 v87, v9, v3
  v_cvt_pk_bf16_f32 v84, v84, v85
  v_cvt_pk_bf16_f32 v85, v86, v87
  v_fmac_f32 v88, v6, v4
  v_fmac_f32 v89, v7, v4
  v_fmac_f32 v90, v8, v4
  v_fmac_f32 v91, v9, v4
  v_cvt_pk_bf16_f32 v88, v88, v89
  v_cvt_pk_bf16_f32 v89, v90, v91
  v_fmac_f32 v92, v6, v5
  v_fmac_f32 v93, v7, v5
  v_fmac_f32 v94, v8, v5
  v_fmac_f32 v95, v9, v5
  v_cvt_pk_bf16_f32 v92, v92, v93
  v_cvt_pk_bf16_f32 v93, v94, v95
  v_accvgpr_read_b32 v6, a0
  v_accvgpr_read_b32 v7, a1
  v_accvgpr_read_b32 v8, a2
  v_accvgpr_read_b32 v9, a3
  v_fmac_f32 v96, v6, v2
  v_fmac_f32 v97, v7, v2
  v_fmac_f32 v98, v8, v2
  v_fmac_f32 v99, v9, v2
  v_cvt_pk_bf16_f32 v82, v96, v97
  v_cvt_pk_bf16_f32 v83, v98, v99
  v_pk_max_i16 v80, v80, 0
  v_pk_max_i16 v81, v81, 0
  v_pk_max_i16 v82, v82, 0
  v_pk_max_i16 v83, v83, 0
  s_add_u32 s29, s28, 262144
  buffer_store_dwordx4 v[80:83], v14, s[12:15], s29 offen sc1
  v_fmac_f32 v100, v6, v3
  v_fmac_f32 v101, v7, v3
  v_fmac_f32 v102, v8, v3
  v_fmac_f32 v103, v9, v3
  v_cvt_pk_bf16_f32 v86, v100, v101
  v_cvt_pk_bf16_f32 v87, v102, v103
  v_pk_max_i16 v84, v84, 0
  v_pk_max_i16 v85, v85, 0
  v_pk_max_i16 v86, v86, 0
  v_pk_max_i16 v87, v87, 0
  s_add_u32 s29, s28, 263168
  buffer_store_dwordx4 v[84:87], v14, s[12:15], s29 offen sc1
  v_fmac_f32 v104, v6, v4
  v_fmac_f32 v105, v7, v4
  v_fmac_f32 v106, v8, v4
  v_fmac_f32 v107, v9, v4
  v_cvt_pk_bf16_f32 v90, v104, v105
  v_cvt_pk_bf16_f32 v91, v106, v107
  v_pk_max_i16 v88, v88, 0
  v_pk_max_i16 v89, v89, 0
  v_pk_max_i16 v90, v90, 0
  v_pk_max_i16 v91, v91, 0
  s_add_u32 s29, s28, 264192
  buffer_store_dwordx4 v[88:91], v14, s[12:15], s29 offen sc1
  v_fmac_f32 v108, v6, v5
  v_fmac_f32 v109, v7, v5
  v_fmac_f32 v110, v8, v5
  v_fmac_f32 v111, v9, v5
  v_cvt_pk_bf16_f32 v94, v108, v109
  v_cvt_pk_bf16_f32 v95, v110, v111
  v_pk_max_i16 v92, v92, 0
  v_pk_max_i16 v93, v93, 0
  v_pk_max_i16 v94, v94, 0
  v_pk_max_i16 v95, v95, 0
  s_add_u32 s29, s28, 265216
  buffer_store_dwordx4 v[92:95], v14, s[12:15], s29 offen sc1
L_sequential_preLN__sliding_block__dense_activation_relu__prompt_kernel_epi_skip0:
  s_cmp_eq_u32 s27, 1
  s_cbranch_scc0 L_sequential_preLN__sliding_block__dense_activation_relu__prompt_kernel_epi_skip1
  ds_read_b128 v[6:9], v11 offset:0
  s_waitcnt lgkmcnt(0)
  v_fmac_f32 v16, v6, v2
  v_fmac_f32 v17, v7, v2
  v_fmac_f32 v18, v8, v2
  v_fmac_f32 v19, v9, v2
  v_cvt_pk_bf16_f32 v12, v16, v17
  v_cvt_pk_bf16_f32 v13, v18, v19
  v_pk_max_i16 v12, v12, 0
  v_pk_max_i16 v13, v13, 0
  s_add_u32 s29, s28, 393216
  v_mov_b32 v16, v12
  v_mov_b32 v17, v13
  buffer_store_dwordx2 v[16:17], v14, s[12:15], s29 offen offset:8 sc1
  v_fmac_f32 v20, v6, v3
  v_fmac_f32 v21, v7, v3
  v_fmac_f32 v22, v8, v3
  v_fmac_f32 v23, v9, v3
  v_cvt_pk_bf16_f32 v12, v20, v21
  v_cvt_pk_bf16_f32 v13, v22, v23
  v_pk_max_i16 v12, v12, 0
  v_pk_max_i16 v13, v13, 0
  s_add_u32 s29, s28, 394240
  v_mov_b32 v20, v12
  v_mov_b32 v21, v13
  buffer_store_dwordx2 v[20:21], v14, s[12:15], s29 offen offset:8 sc1
  v_fmac_f32 v24, v6, v4
  v_fmac_f32 v25, v7, v4
  v_fmac_f32 v26, v8, v4
  v_fmac_f32 v27, v9, v4
  v_cvt_pk_bf16_f32 v12, v24, v25
  v_cvt_pk_bf16_f32 v13, v26, v27
  v_pk_max_i16 v12, v12, 0
  v_pk_max_i16 v13, v13, 0
  s_add_u32 s29, s28, 395264
  v_mov_b32 v24, v12
  v_mov_b32 v25, v13
  buffer_store_dwordx2 v[24:25], v14, s[12:15], s29 offen offset:8 sc1
  v_fmac_f32 v28, v6, v5
  v_fmac_f32 v29, v7, v5
  v_fmac_f32 v30, v8, v5
  v_fmac_f32 v31, v9, v5
  v_cvt_pk_bf16_f32 v12, v28, v29
  v_cvt_pk_bf16_f32 v13, v30, v31
  v_pk_max_i16 v12, v12, 0
  v_pk_max_i16 v13, v13, 0
  s_add_u32 s29, s28, 396288
  v_mov_b32 v28, v12
  v_mov_b32 v29, v13
  buffer_store_dwordx2 v[28:29], v14, s[12:15], s29 offen offset:8 sc1
  s_nop 0
  ds_read_b128 v[6:9], v11 offset:64
  ds_read_b128 a[0:3], v11 offset:128
  s_waitcnt lgkmcnt(0)
  v_fmac_f32 v32, v6, v2
  v_fmac_f32 v33, v7, v2
  v_fmac_f32 v34, v8, v2
  v_fmac_f32 v35, v9, v2
  v_cvt_pk_bf16_f32 v32, v32, v33
  v_cvt_pk_bf16_f32 v33, v34, v35
  v_fmac_f32 v36, v6, v3
  v_fmac_f32 v37, v7, v3
  v_fmac_f32 v38, v8, v3
  v_fmac_f32 v39, v9, v3
  v_cvt_pk_bf16_f32 v36, v36, v37
  v_cvt_pk_bf16_f32 v37, v38, v39
  v_fmac_f32 v40, v6, v4
  v_fmac_f32 v41, v7, v4
  v_fmac_f32 v42, v8, v4
  v_fmac_f32 v43, v9, v4
  v_cvt_pk_bf16_f32 v40, v40, v41
  v_cvt_pk_bf16_f32 v41, v42, v43
  v_fmac_f32 v44, v6, v5
  v_fmac_f32 v45, v7, v5
  v_fmac_f32 v46, v8, v5
  v_fmac_f32 v47, v9, v5
  v_cvt_pk_bf16_f32 v44, v44, v45
  v_cvt_pk_bf16_f32 v45, v46, v47
  v_accvgpr_read_b32 v6, a0
  v_accvgpr_read_b32 v7, a1
  v_accvgpr_read_b32 v8, a2
  v_accvgpr_read_b32 v9, a3
  v_fmac_f32 v48, v6, v2
  v_fmac_f32 v49, v7, v2
  v_fmac_f32 v50, v8, v2
  v_fmac_f32 v51, v9, v2
  v_cvt_pk_bf16_f32 v34, v48, v49
  v_cvt_pk_bf16_f32 v35, v50, v51
  v_pk_max_i16 v32, v32, 0
  v_pk_max_i16 v33, v33, 0
  v_pk_max_i16 v34, v34, 0
  v_pk_max_i16 v35, v35, 0
  s_add_u32 s29, s28, 524288
  buffer_store_dwordx4 v[32:35], v14, s[12:15], s29 offen sc1
  v_fmac_f32 v52, v6, v3
  v_fmac_f32 v53, v7, v3
  v_fmac_f32 v54, v8, v3
  v_fmac_f32 v55, v9, v3
  v_cvt_pk_bf16_f32 v38, v52, v53
  v_cvt_pk_bf16_f32 v39, v54, v55
  v_pk_max_i16 v36, v36, 0
  v_pk_max_i16 v37, v37, 0
  v_pk_max_i16 v38, v38, 0
  v_pk_max_i16 v39, v39, 0
  s_add_u32 s29, s28, 525312
  buffer_store_dwordx4 v[36:39], v14, s[12:15], s29 offen sc1
  v_fmac_f32 v56, v6, v4
  v_fmac_f32 v57, v7, v4
  v_fmac_f32 v58, v8, v4
  v_fmac_f32 v59, v9, v4
  v_cvt_pk_bf16_f32 v42, v56, v57
  v_cvt_pk_bf16_f32 v43, v58, v59
  v_pk_max_i16 v40, v40, 0
  v_pk_max_i16 v41, v41, 0
  v_pk_max_i16 v42, v42, 0
  v_pk_max_i16 v43, v43, 0
  s_add_u32 s29, s28, 526336
  buffer_store_dwordx4 v[40:43], v14, s[12:15], s29 offen sc1
  v_fmac_f32 v60, v6, v5
  v_fmac_f32 v61, v7, v5
  v_fmac_f32 v62, v8, v5
  v_fmac_f32 v63, v9, v5
  v_cvt_pk_bf16_f32 v46, v60, v61
  v_cvt_pk_bf16_f32 v47, v62, v63
  v_pk_max_i16 v44, v44, 0
  v_pk_max_i16 v45, v45, 0
  v_pk_max_i16 v46, v46, 0
  v_pk_max_i16 v47, v47, 0
  s_add_u32 s29, s28, 527360
  buffer_store_dwordx4 v[44:47], v14, s[12:15], s29 offen sc1
  ds_read_b128 v[6:9], v11 offset:192
  ds_read_b128 a[0:3], v11 offset:256
  s_waitcnt lgkmcnt(0)
  v_fmac_f32 v64, v6, v2
  v_fmac_f32 v65, v7, v2
  v_fmac_f32 v66, v8, v2
  v_fmac_f32 v67, v9, v2
  v_cvt_pk_bf16_f32 v64, v64, v65
  v_cvt_pk_bf16_f32 v65, v66, v67
  v_fmac_f32 v68, v6, v3
  v_fmac_f32 v69, v7, v3
  v_fmac_f32 v70, v8, v3
  v_fmac_f32 v71, v9, v3
  v_cvt_pk_bf16_f32 v68, v68, v69
  v_cvt_pk_bf16_f32 v69, v70, v71
  v_fmac_f32 v72, v6, v4
  v_fmac_f32 v73, v7, v4
  v_fmac_f32 v74, v8, v4
  v_fmac_f32 v75, v9, v4
  v_cvt_pk_bf16_f32 v72, v72, v73
  v_cvt_pk_bf16_f32 v73, v74, v75
  v_fmac_f32 v76, v6, v5
  v_fmac_f32 v77, v7, v5
  v_fmac_f32 v78, v8, v5
  v_fmac_f32 v79, v9, v5
  v_cvt_pk_bf16_f32 v76, v76, v77
  v_cvt_pk_bf16_f32 v77, v78, v79
  v_accvgpr_read_b32 v6, a0
  v_accvgpr_read_b32 v7, a1
  v_accvgpr_read_b32 v8, a2
  v_accvgpr_read_b32 v9, a3
  v_fmac_f32 v80, v6, v2
  v_fmac_f32 v81, v7, v2
  v_fmac_f32 v82, v8, v2
  v_fmac_f32 v83, v9, v2
  v_cvt_pk_bf16_f32 v66, v80, v81
  v_cvt_pk_bf16_f32 v67, v82, v83
  v_pk_max_i16 v64, v64, 0
  v_pk_max_i16 v65, v65, 0
  v_pk_max_i16 v66, v66, 0
  v_pk_max_i16 v67, v67, 0
  s_add_u32 s29, s28, 655360
  buffer_store_dwordx4 v[64:67], v14, s[12:15], s29 offen sc1
  v_fmac_f32 v84, v6, v3
  v_fmac_f32 v85, v7, v3
  v_fmac_f32 v86, v8, v3
  v_fmac_f32 v87, v9, v3
  v_cvt_pk_bf16_f32 v70, v84, v85
  v_cvt_pk_bf16_f32 v71, v86, v87
  v_pk_max_i16 v68, v68, 0
  v_pk_max_i16 v69, v69, 0
  v_pk_max_i16 v70, v70, 0
  v_pk_max_i16 v71, v71, 0
  s_add_u32 s29, s28, 656384
  buffer_store_dwordx4 v[68:71], v14, s[12:15], s29 offen sc1
  v_fmac_f32 v88, v6, v4
  v_fmac_f32 v89, v7, v4
  v_fmac_f32 v90, v8, v4
  v_fmac_f32 v91, v9, v4
  v_cvt_pk_bf16_f32 v74, v88, v89
  v_cvt_pk_bf16_f32 v75, v90, v91
  v_pk_max_i16 v72, v72, 0
  v_pk_max_i16 v73, v73, 0
  v_pk_max_i16 v74, v74, 0
  v_pk_max_i16 v75, v75, 0
  s_add_u32 s29, s28, 657408
  buffer_store_dwordx4 v[72:75], v14, s[12:15], s29 offen sc1
  v_fmac_f32 v92, v6, v5
  v_fmac_f32 v93, v7, v5
  v_fmac_f32 v94, v8, v5
  v_fmac_f32 v95, v9, v5
  v_cvt_pk_bf16_f32 v78, v92, v93
  v_cvt_pk_bf16_f32 v79, v94, v95
  v_pk_max_i16 v76, v76, 0
  v_pk_max_i16 v77, v77, 0
  v_pk_max_i16 v78, v78, 0
  v_pk_max_i16 v79, v79, 0
  s_add_u32 s29, s28, 658432
  buffer_store_dwordx4 v[76:79], v14, s[12:15], s29 offen sc1
  ds_read_b128 v[6:9], v11 offset:320
  ds_read_b128 a[0:3], v11 offset:384
  s_waitcnt lgkmcnt(0)
  v_fmac_f32 v96, v6, v2
  v_fmac_f32 v97, v7, v2
  v_fmac_f32 v98, v8, v2
  v_fmac_f32 v99, v9, v2
  v_cvt_pk_bf16_f32 v96, v96, v97
  v_cvt_pk_bf16_f32 v97, v98, v99
  v_fmac_f32 v100, v6, v3
  v_fmac_f32 v101, v7, v3
  v_fmac_f32 v102, v8, v3
  v_fmac_f32 v103, v9, v3
  v_cvt_pk_bf16_f32 v100, v100, v101
  v_cvt_pk_bf16_f32 v101, v102, v103
  v_fmac_f32 v104, v6, v4
  v_fmac_f32 v105, v7, v4
  v_fmac_f32 v106, v8, v4
  v_fmac_f32 v107, v9, v4
  v_cvt_pk_bf16_f32 v104, v104, v105
  v_cvt_pk_bf16_f32 v105, v106, v107
  v_fmac_f32 v108, v6, v5
  v_fmac_f32 v109, v7, v5
  v_fmac_f32 v110, v8, v5
  v_fmac_f32 v111, v9, v5
  v_cvt_pk_bf16_f32 v108, v108, v109
  v_cvt_pk_bf16_f32 v109, v110, v111
  v_accvgpr_read_b32 v6, a0
  v_accvgpr_read_b32 v7, a1
  v_accvgpr_read_b32 v8, a2
  v_accvgpr_read_b32 v9, a3
  v_fmac_f32 v112, v6, v2
  v_fmac_f32 v113, v7, v2
  v_fmac_f32 v114, v8, v2
  v_fmac_f32 v115, v9, v2
  v_cvt_pk_bf16_f32 v98, v112, v113
  v_cvt_pk_bf16_f32 v99, v114, v115
  v_pk_max_i16 v96, v96, 0
  v_pk_max_i16 v97, v97, 0
  v_pk_max_i16 v98, v98, 0
  v_pk_max_i16 v99, v99, 0
  s_add_u32 s29, s28, 786432
  buffer_store_dwordx4 v[96:99], v14, s[12:15], s29 offen sc1
  v_fmac_f32 v116, v6, v3
  v_fmac_f32 v117, v7, v3
  v_fmac_f32 v118, v8, v3
  v_fmac_f32 v119, v9, v3
  v_cvt_pk_bf16_f32 v102, v116, v117
  v_cvt_pk_bf16_f32 v103, v118, v119
  v_pk_max_i16 v100, v100, 0
  v_pk_max_i16 v101, v101, 0
  v_pk_max_i16 v102, v102, 0
  v_pk_max_i16 v103, v103, 0
  s_add_u32 s29, s28, 787456
  buffer_store_dwordx4 v[100:103], v14, s[12:15], s29 offen sc1
  v_fmac_f32 v120, v6, v4
  v_fmac_f32 v121, v7, v4
  v_fmac_f32 v122, v8, v4
  v_fmac_f32 v123, v9, v4
  v_cvt_pk_bf16_f32 v106, v120, v121
  v_cvt_pk_bf16_f32 v107, v122, v123
  v_pk_max_i16 v104, v104, 0
  v_pk_max_i16 v105, v105, 0
  v_pk_max_i16 v106, v106, 0
  v_pk_max_i16 v107, v107, 0
  s_add_u32 s29, s28, 788480
  buffer_store_dwordx4 v[104:107], v14, s[12:15], s29 offen sc1
  v_fmac_f32 v124, v6, v5
  v_fmac_f32 v125, v7, v5
  v_fmac_f32 v126, v8, v5
  v_fmac_f32 v127, v9, v5
  v_cvt_pk_bf16_f32 v110, v124, v125
  v_cvt_pk_bf16_f32 v111, v126, v127
  v_pk_max_i16 v108, v108, 0
  v_pk_max_i16 v109, v109, 0
  v_pk_max_i16 v110, v110, 0
  v_pk_max_i16 v111, v111, 0
  s_add_u32 s29, s28, 789504
  buffer_store_dwordx4 v[108:111], v14, s[12:15], s29 offen sc1
L_sequential_preLN__sliding_block__dense_activation_relu__prompt_kernel_epi_skip1:
  s_barrier
  s_waitcnt vmcnt(0)
  s_barrier
  v_and_b32 v1, 63, v0
  s_lshr_b32 s26, s3, 1
  s_and_b32 s27, s3, 1
  s_lshl_b32 s28, s26, 12
  s_add_u32 s28, s28, 0
  v_lshlrev_b32 v4, 4, v1
  v_add_u32 v4, s28, v4
  v_lshrrev_b32 v2, 2, v1
  v_and_b32 v3, 7, v2
  v_mul_u32_u24 v2, 256, v2
  v_and_b32 v16, 3, v1
  v_lshlrev_b32 v16, 3, v16
  v_add_u32 v2, v2, v16
  v_add_u32 v2, 16384, v2
  s_cmp_eq_u32 s27, 0
  s_cselect_b32 s28, 0, 4
  s_cselect_b32 s29, 0, 0
  v_xor_b32 v16, s28, v3
  v_lshlrev_b32 v16, 5, v16
  v_add_u32 v16, s29, v16
  v_add_u32 v8, v16, v2
  s_cmp_eq_u32 s27, 0
  s_cselect_b32 s28, 1, 5
  s_cselect_b32 s29, 0, 0
  v_xor_b32 v16, s28, v3
  v_lshlrev_b32 v16, 5, v16
  v_add_u32 v16, s29, v16
  v_add_u32 v9, v16, v2
  s_cmp_eq_u32 s27, 0
  s_cselect_b32 s28, 2, 6
  s_cselect_b32 s29, 0, 0
  v_xor_b32 v16, s28, v3
  v_lshlrev_b32 v16, 5, v16
  v_add_u32 v16, s29, v16
  v_add_u32 v10, v16, v2
  s_cmp_eq_u32 s27, 0
  s_cselect_b32 s28, 3, 7
  s_cselect_b32 s29, 0, 0
  v_xor_b32 v16, s28, v3
  v_lshlrev_b32 v16, 5, v16
  v_add_u32 v16, s29, v16
  v_add_u32 v11, v16, v2
  v_mov_b32 v16, 0
  v_mov_b32 v17, 0
  v_mov_b32 v18, 0
  v_mov_b32 v19, 0
  v_mov_b32 v20, 0
  v_mov_b32 v21, 0
  v_mov_b32 v22, 0
  v_mov_b32 v23, 0
  v_mov_b32 v24, 0
  v_mov_b32 v25, 0
  v_mov_b32 v26, 0
  v_mov_b32 v27, 0
  v_mov_b32 v28, 0
  v_mov_b32 v29, 0
  v_mov_b32 v30, 0
  v_mov_b32 v31, 0
  v_mov_b32 v32, 0
  v_mov_b32 v33, 0
  v_mov_b32 v34, 0
  v_mov_b32 v35, 0
  v_mov_b32 v36, 0
  v_mov_b32 v37, 0
  v_mov_b32 v38, 0
  v_mov_b32 v39, 0
  v_mov_b32 v40, 0
  v_mov_b32 v41, 0
  v_mov_b32 v42, 0
  v_mov_b32 v43, 0
  v_mov_b32 v44, 0
  v_mov_b32 v45, 0
  v_mov_b32 v46, 0
  v_mov_b32 v47, 0
  v_mov_b32 v48, 0
  v_mov_b32 v49, 0
  v_mov_b32 v50, 0
  v_mov_b32 v51, 0
  v_mov_b32 v52, 0
  v_mov_b32 v53, 0
  v_mov_b32 v54, 0
  v_mov_b32 v55, 0
  v_mov_b32 v56, 0
  v_mov_b32 v57, 0
  v_mov_b32 v58, 0
  v_mov_b32 v59, 0
  v_mov_b32 v60, 0
  v_mov_b32 v61, 0
  v_mov_b32 v62, 0
  v_mov_b32 v63, 0
  v_mov_b32 v64, 0
  v_mov_b32 v65, 0
  v_mov_b32 v66, 0
  v_mov_b32 v67, 0
  v_mov_b32 v68, 0
  v_mov_b32 v69, 0
  v_mov_b32 v70, 0
  v_mov_b32 v71, 0
  v_mov_b32 v72, 0
  v_mov_b32 v73, 0
  v_mov_b32 v74, 0
  v_mov_b32 v75, 0
  v_mov_b32 v76, 0
  v_mov_b32 v77, 0
  v_mov_b32 v78, 0
  v_mov_b32 v79, 0
  v_lshlrev_b32 v2, 4, v1
  s_and_b32 s36, s21, 7
  s_lshr_b32 s37, s21, 3
  s_lshl_b32 s28, s36, 2
  s_lshl_b32 s29, s27, 1
  s_add_u32 s28, s28, s29
  s_lshl_b32 s28, s28, 17
  s_lshl_b32 s29, s20, 13
  s_add_u32 s28, s28, s29
  s_lshl_b32 s29, s26, 12
  s_add_u32 s28, s28, s29
  s_lshl_b32 s29, s37, 11
  s_add_u32 s28, s28, s29
  s_add_u32 s28, s28, 20971520
  buffer_load_dwordx4 v[80:83], v2, s[12:15], s28 offen offset:0 sc1
  buffer_load_dwordx4 v[84:87], v2, s[12:15], s28 offen offset:1024 sc1
  s_add_u32 s28, s28, 131072
  buffer_load_dwordx4 v[88:91], v2, s[12:15], s28 offen offset:0 sc1
  buffer_load_dwordx4 v[92:95], v2, s[12:15], s28 offen offset:1024 sc1
  s_add_u32 s28, s28, 131072
  s_barrier
  s_mov_b32 s23, 0
  v_add_u32 v6, s23, v4
  v_add_u32 v12, s23, v8
  v_add_u32 v13, s23, v9
  v_add_u32 v14, s23, v10
  v_add_u32 v15, s23, v11
  s_barrier
  ds_read_b64_tr_b16 a[16:17], v12 offset:0
  ds_read_b64_tr_b16 a[18:19], v12 offset:4096
  ds_read_b128 a[0:3], v6 offset:0
  ds_read_b128 a[4:7], v6 offset:1024
  ds_read_b128 a[8:11], v6 offset:2048
  ds_read_b128 a[12:15], v6 offset:3072
  ds_read_b64_tr_b16 a[20:21], v13 offset:0
  ds_read_b64_tr_b16 a[22:23], v13 offset:4096
  ds_read_b64_tr_b16 a[24:25], v14 offset:0
  ds_read_b64_tr_b16 a[26:27], v14 offset:4096
  ds_read_b64_tr_b16 a[28:29], v15 offset:0
  ds_read_b64_tr_b16 a[30:31], v15 offset:4096
  s_mov_b32 s22, 28
  s_waitcnt lgkmcnt(0)
  .p2align 6
L_sequential_preLN__sliding_block__dense_activation_relu__prompt_kernel_g5_c_loop:
  v_mfma_f32_16x16x32_bf16 v[16:19], a[16:19], a[0:3], v[16:19]
  ds_read_b64_tr_b16 a[48:49], v12 offset:8192
  ds_read_b64_tr_b16 a[50:51], v12 offset:12288
  v_mfma_f32_16x16x32_bf16 v[20:23], a[16:19], a[4:7], v[20:23]
  ds_read_b128 a[32:35], v6 offset:8192
  v_mfma_f32_16x16x32_bf16 v[24:27], a[16:19], a[8:11], v[24:27]
  ds_read_b128 a[36:39], v6 offset:9216
  v_mfma_f32_16x16x32_bf16 v[28:31], a[16:19], a[12:15], v[28:31]
  ds_read_b128 a[40:43], v6 offset:10240
  v_mfma_f32_16x16x32_bf16 v[32:35], a[20:23], a[0:3], v[32:35]
  ds_read_b128 a[44:47], v6 offset:11264
  v_mfma_f32_16x16x32_bf16 v[36:39], a[20:23], a[4:7], v[36:39]
  ds_read_b64_tr_b16 a[52:53], v13 offset:8192
  ds_read_b64_tr_b16 a[54:55], v13 offset:12288
  v_mfma_f32_16x16x32_bf16 v[40:43], a[20:23], a[8:11], v[40:43]
  ds_read_b64_tr_b16 a[56:57], v14 offset:8192
  v_mfma_f32_16x16x32_bf16 v[44:47], a[20:23], a[12:15], v[44:47]
  ds_read_b64_tr_b16 a[58:59], v14 offset:12288
  v_mfma_f32_16x16x32_bf16 v[48:51], a[24:27], a[0:3], v[48:51]
  ds_read_b64_tr_b16 a[60:61], v15 offset:8192
  v_mfma_f32_16x16x32_bf16 v[52:55], a[24:27], a[4:7], v[52:55]
  ds_read_b64_tr_b16 a[62:63], v15 offset:12288
  v_mfma_f32_16x16x32_bf16 v[56:59], a[24:27], a[8:11], v[56:59]
  s_add_u32 s23, s23, 32768
  s_cmp_eq_u32 s23, 131072
  v_mfma_f32_16x16x32_bf16 v[60:63], a[24:27], a[12:15], v[60:63]
  s_cselect_b32 s23, 0, s23
  v_mfma_f32_16x16x32_bf16 v[64:67], a[28:31], a[0:3], v[64:67]
  v_add_u32 v6, s23, v4
  v_mfma_f32_16x16x32_bf16 v[68:71], a[28:31], a[4:7], v[68:71]
  v_add_u32 v12, s23, v8
  v_add_u32 v13, s23, v9
  v_mfma_f32_16x16x32_bf16 v[72:75], a[28:31], a[8:11], v[72:75]
  v_add_u32 v14, s23, v10
  v_mfma_f32_16x16x32_bf16 v[76:79], a[28:31], a[12:15], v[76:79]
  v_add_u32 v15, s23, v11
  s_waitcnt lgkmcnt(0)
  s_barrier
  v_mfma_f32_16x16x32_bf16 v[16:19], a[48:51], a[32:35], v[16:19]
  ds_read_b64_tr_b16 a[16:17], v12 offset:0
  ds_read_b64_tr_b16 a[18:19], v12 offset:4096
  v_mfma_f32_16x16x32_bf16 v[20:23], a[48:51], a[36:39], v[20:23]
  ds_read_b128 a[0:3], v6 offset:0
  v_mfma_f32_16x16x32_bf16 v[24:27], a[48:51], a[40:43], v[24:27]
  ds_read_b128 a[4:7], v6 offset:1024
  v_mfma_f32_16x16x32_bf16 v[28:31], a[48:51], a[44:47], v[28:31]
  ds_read_b128 a[8:11], v6 offset:2048
  v_mfma_f32_16x16x32_bf16 v[32:35], a[52:55], a[32:35], v[32:35]
  ds_read_b128 a[12:15], v6 offset:3072
  v_mfma_f32_16x16x32_bf16 v[36:39], a[52:55], a[36:39], v[36:39]
  ds_read_b64_tr_b16 a[20:21], v13 offset:0
  ds_read_b64_tr_b16 a[22:23], v13 offset:4096
  v_mfma_f32_16x16x32_bf16 v[40:43], a[52:55], a[40:43], v[40:43]
  ds_read_b64_tr_b16 a[24:25], v14 offset:0
  v_mfma_f32_16x16x32_bf16 v[44:47], a[52:55], a[44:47], v[44:47]
  ds_read_b64_tr_b16 a[26:27], v14 offset:4096
  v_mfma_f32_16x16x32_bf16 v[48:51], a[56:59], a[32:35], v[48:51]
  ds_read_b64_tr_b16 a[28:29], v15 offset:0
  v_mfma_f32_16x16x32_bf16 v[52:55], a[56:59], a[36:39], v[52:55]
  ds_read_b64_tr_b16 a[30:31], v15 offset:4096
  v_mfma_f32_16x16x32_bf16 v[56:59], a[56:59], a[40:43], v[56:59]
  s_sub_u32 s22, s22, 1
  v_mfma_f32_16x16x32_bf16 v[60:63], a[56:59], a[44:47], v[60:63]
  v_mfma_f32_16x16x32_bf16 v[64:67], a[60:63], a[32:35], v[64:67]
  v_mfma_f32_16x16x32_bf16 v[68:71], a[60:63], a[36:39], v[68:71]
  s_cmp_lg_u32 s22, 0
  v_mfma_f32_16x16x32_bf16 v[72:75], a[60:63], a[40:43], v[72:75]
  v_mfma_f32_16x16x32_bf16 v[76:79], a[60:63], a[44:47], v[76:79]
  s_waitcnt lgkmcnt(0)
  s_cbranch_scc1 L_sequential_preLN__sliding_block__dense_activation_relu__prompt_kernel_g5_c_loop
  s_lshr_b32 s26, s3, 1
  s_and_b32 s27, s3, 1
  s_and_b32 s36, s21, 7
  s_lshr_b32 s37, s21, 3
  v_lshlrev_b32 v14, 4, v1
  s_lshl_b32 s28, s20, 4
  s_add_u32 s28, s28, s21
  s_lshl_b32 s38, s28, 7
  s_lshl_b32 s28, s28, 2
  s_add_u32 s28, s28, s3
  s_lshl_b32 s28, s28, 12
  s_add_u32 s28, s28, 41943040
  s_xor_b32 s29, s21, 8
  s_lshl_b32 s30, s20, 4
  s_add_u32 s29, s29, s30
  s_lshl_b32 s39, s29, 7
  s_lshl_b32 s29, s29, 2
  s_add_u32 s29, s29, s3
  s_lshl_b32 s29, s29, 12
  s_add_u32 s29, s29, 41943040
  s_lshl_b32 s30, s3, 2
  s_add_u32 s38, s38, s30
  s_add_u32 s38, s38, 3178496
  s_add_u32 s39, s39, s30
  s_add_u32 s39, s39, 3178496
  v_and_b32 v2, 15, v1
  s_lshl_b32 s30, s26, 9
  s_lshl_b32 s31, s37, 8
  s_add_u32 s30, s30, s31
  s_add_u32 s30, s30, 155652
  v_lshl_add_u32 v3, v2, 3, s30
  ds_read_b32 v4, v3
  ds_read_b32 v5, v3 offset:128
  v_lshrrev_b32 v3, 4, v1
  v_lshlrev_b32 v2, 11, v2
  v_lshl_add_u32 v15, v3, 4, v2
  s_lshl_b32 s42, s20, 18
  s_lshl_b32 s30, s26, 17
  s_add_u32 s42, s42, s30
  s_lshl_b32 s30, s37, 16
  s_add_u32 s42, s42, s30
  s_lshl_b32 s30, s36, 8
  s_add_u32 s42, s42, s30
  s_lshl_b32 s30, s27, 7
  s_add_u32 s42, s42, s30
  s_cmp_eq_u32 s37, 0
  s_cbranch_scc0 L_sequential_preLN__sliding_block__dense_activation_relu__prompt_kernel_x0
  v_cvt_pk_bf16_f32 v24, v24, v25
  v_cvt_pk_bf16_f32 v25, v26, v27
  v_cvt_pk_bf16_f32 v26, v40, v41
  v_cvt_pk_bf16_f32 v27, v42, v43
  buffer_store_dwordx4 v[24:27], v14, s[12:15], s28 offen offset:0 sc1
  v_cvt_pk_bf16_f32 v28, v28, v29
  v_cvt_pk_bf16_f32 v29, v30, v31
  v_cvt_pk_bf16_f32 v30, v44, v45
  v_cvt_pk_bf16_f32 v31, v46, v47
  buffer_store_dwordx4 v[28:31], v14, s[12:15], s28 offen offset:1024 sc1
  v_cvt_pk_bf16_f32 v56, v56, v57
  v_cvt_pk_bf16_f32 v57, v58, v59
  v_cvt_pk_bf16_f32 v58, v72, v73
  v_cvt_pk_bf16_f32 v59, v74, v75
  buffer_store_dwordx4 v[56:59], v14, s[12:15], s28 offen offset:2048 sc1
  v_cvt_pk_bf16_f32 v60, v60, v61
  v_cvt_pk_bf16_f32 v61, v62, v63
  v_cvt_pk_bf16_f32 v62, v76, v77
  v_cvt_pk_bf16_f32 v63, v78, v79
  buffer_store_dwordx4 v[60:63], v14, s[12:15], s28 offen offset:3072 sc1
  s_mov_b32 s31, 40000
L_sequential_preLN__sliding_block__dense_activation_relu__prompt_kernel_xt0:
  buffer_load_dwordx4 v[40:43], v14, s[12:15], s29 offen offset:0 sc1
  buffer_load_dwordx4 v[44:47], v14, s[12:15], s29 offen offset:1024 sc1
  buffer_load_dwordx4 v[72:75], v14, s[12:15], s29 offen offset:2048 sc1
  buffer_load_dwordx4 v[76:79], v14, s[12:15], s29 offen offset:3072 sc1
  s_waitcnt vmcnt(0)
  v_max3_u32 v8, v40, v41, v42
  v_max3_u32 v8, v8, v43, v44
  v_max3_u32 v8, v8, v45, v46
  v_max3_u32 v8, v8, v47, v72
  v_max3_u32 v8, v8, v73, v74
  v_max3_u32 v8, v8, v75, v76
  v_max3_u32 v8, v8, v77, v78
  v_max_u32 v8, v8, v79
  v_cmp_eq_u32 vcc, -1, v8
  s_nop 1
  s_cmp_eq_u64 vcc, 0
  s_cbranch_scc1 L_sequential_preLN__sliding_block__dense_activation_relu__prompt_kernel_xd0
  s_sub_u32 s31, s31, 1
  s_cmp_eq_u32 s31, 0
  s_cbranch_scc1 L_sequential_preLN__sliding_block__dense_activation_relu__prompt_kernel_xd0
  s_branch L_sequential_preLN__sliding_block__dense_activation_relu__prompt_kernel_xt0
L_sequential_preLN__sliding_block__dense_activation_relu__prompt_kernel_xd0:
  s_waitcnt lgkmcnt(0)
  v_lshlrev_b32 v6, 16, v40
  v_and_b32 v7, 0xffff0000, v40
  v_add_f32 v16, v16, v6
  v_add_f32 v17, v17, v7
  v_lshlrev_b32 v6, 16, v41
  v_and_b32 v7, 0xffff0000, v41
  v_add_f32 v18, v18, v6
  v_add_f32 v19, v19, v7
  v_lshlrev_b32 v6, 16, v80
  v_and_b32 v7, 0xffff0000, v80
  v_fmac_f32 v6, v16, v4
  v_fmac_f32 v7, v17, v4
  v_cvt_pk_bf16_f32 v80, v6, v7
  v_lshlrev_b32 v6, 16, v81
  v_and_b32 v7, 0xffff0000, v81
  v_fmac_f32 v6, v18, v4
  v_fmac_f32 v7, v19, v4
  v_cvt_pk_bf16_f32 v81, v6, v7
  v_lshlrev_b32 v6, 16, v42
  v_and_b32 v7, 0xffff0000, v42
  v_add_f32 v32, v32, v6
  v_add_f32 v33, v33, v7
  v_lshlrev_b32 v6, 16, v43
  v_and_b32 v7, 0xffff0000, v43
  v_add_f32 v34, v34, v6
  v_add_f32 v35, v35, v7
  v_lshlrev_b32 v6, 16, v82
  v_and_b32 v7, 0xffff0000, v82
  v_fmac_f32 v6, v32, v4
  v_fmac_f32 v7, v33, v4
  v_cvt_pk_bf16_f32 v82, v6, v7
  v_lshlrev_b32 v6, 16, v83
  v_and_b32 v7, 0xffff0000, v83
  v_fmac_f32 v6, v34, v4
  v_fmac_f32 v7, v35, v4
  v_cvt_pk_bf16_f32 v83, v6, v7
  s_nop 1
  v_permlane32_swap_b32 v80, v82
  v_permlane32_swap_b32 v81, v83
  s_nop 1
  v_permlane16_swap_b32 v80, v82
  v_permlane16_swap_b32 v81, v83
  s_nop 1
  s_add_u32 s30, s42, 0
  buffer_store_dwordx4 v[80:83], v15, s[56:59], s30 offen
  v_lshlrev_b32 v6, 16, v44
  v_and_b32 v7, 0xffff0000, v44
  v_add_f32 v20, v20, v6
  v_add_f32 v21, v21, v7
  v_lshlrev_b32 v6, 16, v45
  v_and_b32 v7, 0xffff0000, v45
  v_add_f32 v22, v22, v6
  v_add_f32 v23, v23, v7
  v_lshlrev_b32 v6, 16, v84
  v_and_b32 v7, 0xffff0000, v84
  v_fmac_f32 v6, v20, v5
  v_fmac_f32 v7, v21, v5
  v_cvt_pk_bf16_f32 v84, v6, v7
  v_lshlrev_b32 v6, 16, v85
  v_and_b32 v7, 0xffff0000, v85
  v_fmac_f32 v6, v22, v5
  v_fmac_f32 v7, v23, v5
  v_cvt_pk_bf16_f32 v85, v6, v7
  v_lshlrev_b32 v6, 16, v46
  v_and_b32 v7, 0xffff0000, v46
  v_add_f32 v36, v36, v6
  v_add_f32 v37, v37, v7
  v_lshlrev_b32 v6, 16, v47
  v_and_b32 v7, 0xffff0000, v47
  v_add_f32 v38, v38, v6
  v_add_f32 v39, v39, v7
  v_lshlrev_b32 v6, 16, v86
  v_and_b32 v7, 0xffff0000, v86
  v_fmac_f32 v6, v36, v5
  v_fmac_f32 v7, v37, v5
  v_cvt_pk_bf16_f32 v86, v6, v7
  v_lshlrev_b32 v6, 16, v87
  v_and_b32 v7, 0xffff0000, v87
  v_fmac_f32 v6, v38, v5
  v_fmac_f32 v7, v39, v5
  v_cvt_pk_bf16_f32 v87, v6, v7
  s_nop 1
  v_permlane32_swap_b32 v84, v86
  v_permlane32_swap_b32 v85, v87
  s_nop 1
  v_permlane16_swap_b32 v84, v86
  v_permlane16_swap_b32 v85, v87
  s_nop 1
  s_add_u32 s30, s42, 32768
  buffer_store_dwordx4 v[84:87], v15, s[56:59], s30 offen
  v_lshlrev_b32 v6, 16, v72
  v_and_b32 v7, 0xffff0000, v72
  v_add_f32 v48, v48, v6
  v_add_f32 v49, v49, v7
  v_lshlrev_b32 v6, 16, v73
  v_and_b32 v7, 0xffff0000, v73
  v_add_f32 v50, v50, v6
  v_add_f32 v51, v51, v7
  v_lshlrev_b32 v6, 16, v88
  v_and_b32 v7, 0xffff0000, v88
  v_fmac_f32 v6, v48, v4
  v_fmac_f32 v7, v49, v4
  v_cvt_pk_bf16_f32 v88, v6, v7
  v_lshlrev_b32 v6, 16, v89
  v_and_b32 v7, 0xffff0000, v89
  v_fmac_f32 v6, v50, v4
  v_fmac_f32 v7, v51, v4
  v_cvt_pk_bf16_f32 v89, v6, v7
  v_lshlrev_b32 v6, 16, v74
  v_and_b32 v7, 0xffff0000, v74
  v_add_f32 v64, v64, v6
  v_add_f32 v65, v65, v7
  v_lshlrev_b32 v6, 16, v75
  v_and_b32 v7, 0xffff0000, v75
  v_add_f32 v66, v66, v6
  v_add_f32 v67, v67, v7
  v_lshlrev_b32 v6, 16, v90
  v_and_b32 v7, 0xffff0000, v90
  v_fmac_f32 v6, v64, v4
  v_fmac_f32 v7, v65, v4
  v_cvt_pk_bf16_f32 v90, v6, v7
  v_lshlrev_b32 v6, 16, v91
  v_and_b32 v7, 0xffff0000, v91
  v_fmac_f32 v6, v66, v4
  v_fmac_f32 v7, v67, v4
  v_cvt_pk_bf16_f32 v91, v6, v7
  s_nop 1
  v_permlane32_swap_b32 v88, v90
  v_permlane32_swap_b32 v89, v91
  s_nop 1
  v_permlane16_swap_b32 v88, v90
  v_permlane16_swap_b32 v89, v91
  s_nop 1
  s_add_u32 s30, s42, 64
  buffer_store_dwordx4 v[88:91], v15, s[56:59], s30 offen
  v_lshlrev_b32 v6, 16, v76
  v_and_b32 v7, 0xffff0000, v76
  v_add_f32 v52, v52, v6
  v_add_f32 v53, v53, v7
  v_lshlrev_b32 v6, 16, v77
  v_and_b32 v7, 0xffff0000, v77
  v_add_f32 v54, v54, v6
  v_add_f32 v55, v55, v7
  v_lshlrev_b32 v6, 16, v92
  v_and_b32 v7, 0xffff0000, v92
  v_fmac_f32 v6, v52, v5
  v_fmac_f32 v7, v53, v5
  v_cvt_pk_bf16_f32 v92, v6, v7
  v_lshlrev_b32 v6, 16, v93
  v_and_b32 v7, 0xffff0000, v93
  v_fmac_f32 v6, v54, v5
  v_fmac_f32 v7, v55, v5
  v_cvt_pk_bf16_f32 v93, v6, v7
  v_lshlrev_b32 v6, 16, v78
  v_and_b32 v7, 0xffff0000, v78
  v_add_f32 v68, v68, v6
  v_add_f32 v69, v69, v7
  v_lshlrev_b32 v6, 16, v79
  v_and_b32 v7, 0xffff0000, v79
  v_add_f32 v70, v70, v6
  v_add_f32 v71, v71, v7
  v_lshlrev_b32 v6, 16, v94
  v_and_b32 v7, 0xffff0000, v94
  v_fmac_f32 v6, v68, v5
  v_fmac_f32 v7, v69, v5
  v_cvt_pk_bf16_f32 v94, v6, v7
  v_lshlrev_b32 v6, 16, v95
  v_and_b32 v7, 0xffff0000, v95
  v_fmac_f32 v6, v70, v5
  v_fmac_f32 v7, v71, v5
  v_cvt_pk_bf16_f32 v95, v6, v7
  s_nop 1
  v_permlane32_swap_b32 v92, v94
  v_permlane32_swap_b32 v93, v95
  s_nop 1
  v_permlane16_swap_b32 v92, v94
  v_permlane16_swap_b32 v93, v95
  s_nop 1
  s_add_u32 s30, s42, 32832
  buffer_store_dwordx4 v[92:95], v15, s[56:59], s30 offen
L_sequential_preLN__sliding_block__dense_activation_relu__prompt_kernel_x0:
  s_cmp_eq_u32 s37, 1
  s_cbranch_scc0 L_sequential_preLN__sliding_block__dense_activation_relu__prompt_kernel_x1
  v_cvt_pk_bf16_f32 v16, v16, v17
  v_cvt_pk_bf16_f32 v17, v18, v19
  v_cvt_pk_bf16_f32 v18, v32, v33
  v_cvt_pk_bf16_f32 v19, v34, v35
  buffer_store_dwordx4 v[16:19], v14, s[12:15], s28 offen offset:0 sc1
  v_cvt_pk_bf16_f32 v20, v20, v21
  v_cvt_pk_bf16_f32 v21, v22, v23
  v_cvt_pk_bf16_f32 v22, v36, v37
  v_cvt_pk_bf16_f32 v23, v38, v39
  buffer_store_dwordx4 v[20:23], v14, s[12:15], s28 offen offset:1024 sc1
  v_cvt_pk_bf16_f32 v48, v48, v49
  v_cvt_pk_bf16_f32 v49, v50, v51
  v_cvt_pk_bf16_f32 v50, v64, v65
  v_cvt_pk_bf16_f32 v51, v66, v67
  buffer_store_dwordx4 v[48:51], v14, s[12:15], s28 offen offset:2048 sc1
  v_cvt_pk_bf16_f32 v52, v52, v53
  v_cvt_pk_bf16_f32 v53, v54, v55
  v_cvt_pk_bf16_f32 v54, v68, v69
  v_cvt_pk_bf16_f32 v55, v70, v71
  buffer_store_dwordx4 v[52:55], v14, s[12:15], s28 offen offset:3072 sc1
  s_mov_b32 s31, 40000
L_sequential_preLN__sliding_block__dense_activation_relu__prompt_kernel_xt1:
  buffer_load_dwordx4 v[32:35], v14, s[12:15], s29 offen offset:0 sc1
  buffer_load_dwordx4 v[36:39], v14, s[12:15], s29 offen offset:1024 sc1
  buffer_load_dwordx4 v[64:67], v14, s[12:15], s29 offen offset:2048 sc1
  buffer_load_dwordx4 v[68:71], v14, s[12:15], s29 offen offset:3072 sc1
  s_waitcnt vmcnt(0)
  v_max3_u32 v8, v32, v33, v34
  v_max3_u32 v8, v8, v35, v36
  v_max3_u32 v8, v8, v37, v38
  v_max3_u32 v8, v8, v39, v64
  v_max3_u32 v8, v8, v65, v66
  v_max3_u32 v8, v8, v67, v68
  v_max3_u32 v8, v8, v69, v70
  v_max_u32 v8, v8, v71
  v_cmp_eq_u32 vcc, -1, v8
  s_nop 1
  s_cmp_eq_u64 vcc, 0
  s_cbranch_scc1 L_sequential_preLN__sliding_block__dense_activation_relu__prompt_kernel_xd1
  s_sub_u32 s31, s31, 1
  s_cmp_eq_u32 s31, 0
  s_cbranch_scc1 L_sequential_preLN__sliding_block__dense_activation_relu__prompt_kernel_xd1
  s_branch L_sequential_preLN__sliding_block__dense_activation_relu__prompt_kernel_xt1
L_sequential_preLN__sliding_block__dense_activation_relu__prompt_kernel_xd1:
  s_waitcnt lgkmcnt(0)
  v_lshlrev_b32 v6, 16, v32
  v_and_b32 v7, 0xffff0000, v32
  v_add_f32 v24, v24, v6
  v_add_f32 v25, v25, v7
  v_lshlrev_b32 v6, 16, v33
  v_and_b32 v7, 0xffff0000, v33
  v_add_f32 v26, v26, v6
  v_add_f32 v27, v27, v7
  v_lshlrev_b32 v6, 16, v80
  v_and_b32 v7, 0xffff0000, v80
  v_fmac_f32 v6, v24, v4
  v_fmac_f32 v7, v25, v4
  v_cvt_pk_bf16_f32 v80, v6, v7
  v_lshlrev_b32 v6, 16, v81
  v_and_b32 v7, 0xffff0000, v81
  v_fmac_f32 v6, v26, v4
  v_fmac_f32 v7, v27, v4
  v_cvt_pk_bf16_f32 v81, v6, v7
  v_lshlrev_b32 v6, 16, v34
  v_and_b32 v7, 0xffff0000, v34
  v_add_f32 v40, v40, v6
  v_add_f32 v41, v41, v7
  v_lshlrev_b32 v6, 16, v35
  v_and_b32 v7, 0xffff0000, v35
  v_add_f32 v42, v42, v6
  v_add_f32 v43, v43, v7
  v_lshlrev_b32 v6, 16, v82
  v_and_b32 v7, 0xffff0000, v82
  v_fmac_f32 v6, v40, v4
  v_fmac_f32 v7, v41, v4
  v_cvt_pk_bf16_f32 v82, v6, v7
  v_lshlrev_b32 v6, 16, v83
  v_and_b32 v7, 0xffff0000, v83
  v_fmac_f32 v6, v42, v4
  v_fmac_f32 v7, v43, v4
  v_cvt_pk_bf16_f32 v83, v6, v7
  s_nop 1
  v_permlane32_swap_b32 v80, v82
  v_permlane32_swap_b32 v81, v83
  s_nop 1
  v_permlane16_swap_b32 v80, v82
  v_permlane16_swap_b32 v81, v83
  s_nop 1
  s_add_u32 s30, s42, 0
  buffer_store_dwordx4 v[80:83], v15, s[56:59], s30 offen
  v_lshlrev_b32 v6, 16, v36
  v_and_b32 v7, 0xffff0000, v36
  v_add_f32 v28, v28, v6
  v_add_f32 v29, v29, v7
  v_lshlrev_b32 v6, 16, v37
  v_and_b32 v7, 0xffff0000, v37
  v_add_f32 v30, v30, v6
  v_add_f32 v31, v31, v7
  v_lshlrev_b32 v6, 16, v84
  v_and_b32 v7, 0xffff0000, v84
  v_fmac_f32 v6, v28, v5
  v_fmac_f32 v7, v29, v5
  v_cvt_pk_bf16_f32 v84, v6, v7
  v_lshlrev_b32 v6, 16, v85
  v_and_b32 v7, 0xffff0000, v85
  v_fmac_f32 v6, v30, v5
  v_fmac_f32 v7, v31, v5
  v_cvt_pk_bf16_f32 v85, v6, v7
  v_lshlrev_b32 v6, 16, v38
  v_and_b32 v7, 0xffff0000, v38
  v_add_f32 v44, v44, v6
  v_add_f32 v45, v45, v7
  v_lshlrev_b32 v6, 16, v39
  v_and_b32 v7, 0xffff0000, v39
  v_add_f32 v46, v46, v6
  v_add_f32 v47, v47, v7
  v_lshlrev_b32 v6, 16, v86
  v_and_b32 v7, 0xffff0000, v86
  v_fmac_f32 v6, v44, v5
  v_fmac_f32 v7, v45, v5
  v_cvt_pk_bf16_f32 v86, v6, v7
  v_lshlrev_b32 v6, 16, v87
  v_and_b32 v7, 0xffff0000, v87
  v_fmac_f32 v6, v46, v5
  v_fmac_f32 v7, v47, v5
  v_cvt_pk_bf16_f32 v87, v6, v7
  s_nop 1
  v_permlane32_swap_b32 v84, v86
  v_permlane32_swap_b32 v85, v87
  s_nop 1
  v_permlane16_swap_b32 v84, v86
  v_permlane16_swap_b32 v85, v87
  s_nop 1
  s_add_u32 s30, s42, 32768
  buffer_store_dwordx4 v[84:87], v15, s[56:59], s30 offen
  v_lshlrev_b32 v6, 16, v64
  v_and_b32 v7, 0xffff0000, v64
  v_add_f32 v56, v56, v6
  v_add_f32 v57, v57, v7
  v_lshlrev_b32 v6, 16, v65
  v_and_b32 v7, 0xffff0000, v65
  v_add_f32 v58, v58, v6
  v_add_f32 v59, v59, v7
  v_lshlrev_b32 v6, 16, v88
  v_and_b32 v7, 0xffff0000, v88
  v_fmac_f32 v6, v56, v4
  v_fmac_f32 v7, v57, v4
  v_cvt_pk_bf16_f32 v88, v6, v7
  v_lshlrev_b32 v6, 16, v89
  v_and_b32 v7, 0xffff0000, v89
  v_fmac_f32 v6, v58, v4
  v_fmac_f32 v7, v59, v4
  v_cvt_pk_bf16_f32 v89, v6, v7
  v_lshlrev_b32 v6, 16, v66
  v_and_b32 v7, 0xffff0000, v66
  v_add_f32 v72, v72, v6
  v_add_f32 v73, v73, v7
  v_lshlrev_b32 v6, 16, v67
  v_and_b32 v7, 0xffff0000, v67
  v_add_f32 v74, v74, v6
  v_add_f32 v75, v75, v7
  v_lshlrev_b32 v6, 16, v90
  v_and_b32 v7, 0xffff0000, v90
  v_fmac_f32 v6, v72, v4
  v_fmac_f32 v7, v73, v4
  v_cvt_pk_bf16_f32 v90, v6, v7
  v_lshlrev_b32 v6, 16, v91
  v_and_b32 v7, 0xffff0000, v91
  v_fmac_f32 v6, v74, v4
  v_fmac_f32 v7, v75, v4
  v_cvt_pk_bf16_f32 v91, v6, v7
  s_nop 1
  v_permlane32_swap_b32 v88, v90
  v_permlane32_swap_b32 v89, v91
  s_nop 1
  v_permlane16_swap_b32 v88, v90
  v_permlane16_swap_b32 v89, v91
  s_nop 1
  s_add_u32 s30, s42, 64
  buffer_store_dwordx4 v[88:91], v15, s[56:59], s30 offen
  v_lshlrev_b32 v6, 16, v68
  v_and_b32 v7, 0xffff0000, v68
  v_add_f32 v60, v60, v6
  v_add_f32 v61, v61, v7
  v_lshlrev_b32 v6, 16, v69
  v_and_b32 v7, 0xffff0000, v69
  v_add_f32 v62, v62, v6
  v_add_f32 v63, v63, v7
  v_lshlrev_b32 v6, 16, v92
  v_and_b32 v7, 0xffff0000, v92
  v_fmac_f32 v6, v60, v5
  v_fmac_f32 v7, v61, v5
  v_cvt_pk_bf16_f32 v92, v6, v7
  v_lshlrev_b32 v6, 16, v93
  v_and_b32 v7, 0xffff0000, v93
  v_fmac_f32 v6, v62, v5
  v_fmac_f32 v7, v63, v5
  v_cvt_pk_bf16_f32 v93, v6, v7
  v_lshlrev_b32 v6, 16, v70
  v_and_b32 v7, 0xffff0000, v70
  v_add_f32 v76, v76, v6
  v_add_f32 v77, v77, v7
  v_lshlrev_b32 v6, 16, v71
  v_and_b32 v7, 0xffff0000, v71
  v_add_f32 v78, v78, v6
  v_add_f32 v79, v79, v7
  v_lshlrev_b32 v6, 16, v94
  v_and_b32 v7, 0xffff0000, v94
  v_fmac_f32 v6, v76, v5
  v_fmac_f32 v7, v77, v5
  v_cvt_pk_bf16_f32 v94, v6, v7
  v_lshlrev_b32 v6, 16, v95
  v_and_b32 v7, 0xffff0000, v95
  v_fmac_f32 v6, v78, v5
  v_fmac_f32 v7, v79, v5
  v_cvt_pk_bf16_f32 v95, v6, v7
  s_nop 1
  v_permlane32_swap_b32 v92, v94
  v_permlane32_swap_b32 v93, v95
  s_nop 1
  v_permlane16_swap_b32 v92, v94
  v_permlane16_swap_b32 v93, v95
  s_nop 1
  s_add_u32 s30, s42, 32832
  buffer_store_dwordx4 v[92:95], v15, s[56:59], s30 offen
L_sequential_preLN__sliding_block__dense_activation_relu__prompt_kernel_x1:
  s_waitcnt vmcnt(0)
  s_endpgm
L_sequential_preLN__sliding_block__dense_activation_relu__prompt_kernel_L3:
  s_setprio 3
  s_sub_u32 s26, s3, 4
  s_lshl_b32 s24, s20, 13
  s_add_u32 s24, s24, 16777216
  s_mul_i32 s27, s26, 131072
  s_add_u32 s24, s24, s27
  s_mul_i32 s44, s26, 8192
  s_add_u32 s44, s44, 0
  s_lshl_b32 s25, s21, 7
  s_mul_i32 s27, s26, 65536
  s_add_u32 s25, s25, s27
  s_mul_i32 s45, s26, 4096
  s_add_u32 s45, s45, 32768
  s_mov_b32 s23, 0
  s_mov_b32 s32, s24
  s_mov_b32 s33, s25
  s_sub_u32 s42, s3, 4
  s_lshr_b32 s42, s42, 1
  s_lshl_b32 s29, s20, 7
  s_add_u32 s29, s29, 3211264
  v_mov_b32 v109, s29
  s_mov_b32 s43, 0
  v_mov_b32 v110, 0
  v_mov_b32 v111, 0
  v_mov_b32 v112, 0
  v_mov_b32 v116, 0
  v_mov_b32 v117, 0
  s_lshr_b32 s22, s21, 1
  s_add_u32 s22, s22, 0
  s_and_b32 s22, s22, 7
  s_mul_i32 s22, s22, 262144
  s_add_u32 s25, s33, s22
  s_mov_b32 s23, 0
  s_add_u32 m0, s23, s45
  s_mov_b32 s30, s25
  buffer_load_dwordx4 v97, s[16:19], s30 offen lds
  s_add_u32 m0, m0, 1024
  s_add_u32 s30, s30, 16384
  buffer_load_dwordx4 v97, s[16:19], s30 offen lds
  s_add_u32 m0, m0, 1024
  s_add_u32 s30, s30, 16384
  buffer_load_dwordx4 v97, s[16:19], s30 offen lds
  s_add_u32 m0, m0, 1024
  s_add_u32 s30, s30, 16384
  buffer_load_dwordx4 v97, s[16:19], s30 offen lds
  s_lshr_b32 s22, s21, 1
  s_add_u32 s22, s22, 1
  s_and_b32 s22, s22, 7
  s_mul_i32 s22, s22, 262144
  s_add_u32 s25, s33, s22
  s_mov_b32 s23, 49152
  s_add_u32 m0, s23, s45
  s_mov_b32 s30, s25
  buffer_load_dwordx4 v97, s[16:19], s30 offen lds
  s_add_u32 m0, m0, 1024
  s_add_u32 s30, s30, 16384
  buffer_load_dwordx4 v97, s[16:19], s30 offen lds
  s_add_u32 m0, m0, 1024
  s_add_u32 s30, s30, 16384
  buffer_load_dwordx4 v97, s[16:19], s30 offen lds
  s_add_u32 m0, m0, 1024
  s_add_u32 s30, s30, 16384
  buffer_load_dwordx4 v97, s[16:19], s30 offen lds
  s_waitcnt vmcnt(8)
  s_barrier
  s_cmp_eq_u32 s3, 4
  s_cbranch_scc0 L_sequential_preLN__sliding_block__dense_activation_relu__prompt_kernel_w4_g3s
  s_lshl_b32 s28, s20, 7
  s_add_u32 s28, s28, 3211264
  s_mov_b32 s29, s21
  s_lshl_b32 s29, 1, s29
  v_mov_b32 v2, 0
  v_mov_b32 v3, s29
  s_mov_b64 exec, 1
  buffer_atomic_or v3, v2, s[12:15], s28 offen sc1
  s_mov_b64 exec, -1
L_sequential_preLN__sliding_block__dense_activation_relu__prompt_kernel_w4_g3s:
  s_cmp_eq_u32 s3, 7
  s_cbranch_scc0 L_sequential_preLN__sliding_block__dense_activation_relu__prompt_kernel_wpf3
  s_lshl_b32 s46, s20, 4
  s_add_u32 s46, s46, s21
  s_lshr_b32 s36, s46, 7
  s_mul_i32 s36, s36, 1792
  s_and_b32 s37, s46, 127
  s_lshl_b32 s37, s37, 2
  s_add_u32 s36, s36, s37
  v_lshrrev_b32 v2, 4, v1
  v_add_u32 v2, s36, v2
  v_lshlrev_b32 v2, 11, v2
  v_and_b32 v3, 15, v1
  v_lshl_add_u32 v120, v3, 7, v2
  s_mov_b32 s47, 0
  buffer_load_dword a88, v120, s[52:55], s47 offen
  s_mov_b32 s47, 1048576
  buffer_load_dword a88, v120, s[52:55], s47 offen
L_sequential_preLN__sliding_block__dense_activation_relu__prompt_kernel_wpf3:
  s_mov_b32 s40, 0x00010001
  s_mov_b32 s41, 0x00010001
  s_cmp_ge_u32 s3, 6
  s_cbranch_scc1 L_sequential_preLN__sliding_block__dense_activation_relu__prompt_kernel_cs1b
  s_sub_u32 s36, s3, 4
  s_lshl_b32 s36, s36, 2
  v_lshrrev_b32 v2, 2, v1
  v_bfe_u32 v3, v2, 2, 1
  v_mul_u32_u24 v2, 448, v2
  v_and_b32 v16, 3, v1
  v_lshlrev_b32 v16, 3, v16
  v_add_u32 v2, v2, v16
  v_add_u32 v2, 114688, v2
  v_mov_b32 v56, 0x3f803f80
  v_mov_b32 v57, 0x3f803f80
  v_mov_b32 v58, 0x3f803f80
  v_mov_b32 v59, 0x3f803f80
  s_add_u32 s37, s36, 0
  s_and_b32 s38, s37, 1
  s_andn2_b32 s39, s37, 1
  s_lshl_b32 s39, s39, 5
  v_xor_b32 v16, s38, v3
  v_lshlrev_b32 v16, 5, v16
  v_add_u32 v16, s39, v16
  v_add_u32 v20, v16, v2
  ds_read_b64_tr_b16 v[60:61], v20 offset:0
  ds_read_b64_tr_b16 v[62:63], v20 offset:7168
  ds_read_b64_tr_b16 v[64:65], v20 offset:14336
  ds_read_b64_tr_b16 v[66:67], v20 offset:21504
  s_add_u32 s37, s36, 1
  s_and_b32 s38, s37, 1
  s_andn2_b32 s39, s37, 1
  s_lshl_b32 s39, s39, 5
  v_xor_b32 v16, s38, v3
  v_lshlrev_b32 v16, 5, v16
  v_add_u32 v16, s39, v16
  v_add_u32 v21, v16, v2
  ds_read_b64_tr_b16 v[68:69], v21 offset:0
  ds_read_b64_tr_b16 v[70:71], v21 offset:7168
  ds_read_b64_tr_b16 v[72:73], v21 offset:14336
  ds_read_b64_tr_b16 v[74:75], v21 offset:21504
  s_add_u32 s37, s36, 2
  s_and_b32 s38, s37, 1
  s_andn2_b32 s39, s37, 1
  s_lshl_b32 s39, s39, 5
  v_xor_b32 v16, s38, v3
  v_lshlrev_b32 v16, 5, v16
  v_add_u32 v16, s39, v16
  v_add_u32 v22, v16, v2
  ds_read_b64_tr_b16 v[76:77], v22 offset:0
  ds_read_b64_tr_b16 v[78:79], v22 offset:7168
  ds_read_b64_tr_b16 v[80:81], v22 offset:14336
  ds_read_b64_tr_b16 v[82:83], v22 offset:21504
  s_add_u32 s37, s36, 3
  s_and_b32 s38, s37, 1
  s_andn2_b32 s39, s37, 1
  s_lshl_b32 s39, s39, 5
  v_xor_b32 v16, s38, v3
  v_lshlrev_b32 v16, 5, v16
  v_add_u32 v16, s39, v16
  v_add_u32 v23, v16, v2
  ds_read_b64_tr_b16 v[84:85], v23 offset:0
  ds_read_b64_tr_b16 v[86:87], v23 offset:7168
  ds_read_b64_tr_b16 v[88:89], v23 offset:14336
  ds_read_b64_tr_b16 v[90:91], v23 offset:21504
  s_waitcnt lgkmcnt(0)
  v_mfma_f32_16x16x32_bf16 v[24:27], v[60:63], v[56:59], 0
  v_mfma_f32_16x16x32_bf16 v[28:31], v[68:71], v[56:59], 0
  v_mfma_f32_16x16x32_bf16 v[32:35], v[76:79], v[56:59], 0
  v_mfma_f32_16x16x32_bf16 v[36:39], v[84:87], v[56:59], 0
  v_mfma_f32_16x16x32_bf16 v[24:27], v[64:67], v[56:59], v[24:27]
  v_mfma_f32_16x16x32_bf16 v[28:31], v[72:75], v[56:59], v[28:31]
  v_mfma_f32_16x16x32_bf16 v[32:35], v[80:83], v[56:59], v[32:35]
  v_mfma_f32_16x16x32_bf16 v[36:39], v[88:91], v[56:59], v[36:39]
  s_lshl_b32 s28, s20, 4
  s_add_u32 s28, s28, s21
  s_mul_i32 s28, s28, 896
  s_add_u32 s28, s28, 1376256
  s_lshl_b32 s37, s36, 6
  s_add_u32 s28, s28, s37
  v_lshrrev_b32 v2, 4, v1
  v_lshlrev_b32 v2, 4, v2
  s_nop 7
  s_mov_b64 exec, s[40:41]
  buffer_store_dwordx4 v[24:27], v2, s[12:15], s28 offen offset:0 sc1
  buffer_store_dwordx4 v[28:31], v2, s[12:15], s28 offen offset:64 sc1
  buffer_store_dwordx4 v[32:35], v2, s[12:15], s28 offen offset:128 sc1
  buffer_store_dwordx4 v[36:39], v2, s[12:15], s28 offen offset:192 sc1
  s_mov_b64 exec, -1
  s_branch L_sequential_preLN__sliding_block__dense_activation_relu__prompt_kernel_cs1j
L_sequential_preLN__sliding_block__dense_activation_relu__prompt_kernel_cs1b:
  s_sub_u32 s36, s3, 6
  s_mul_i32 s36, s36, 3
  s_add_u32 s36, s36, 8
  v_lshrrev_b32 v2, 2, v1
  v_bfe_u32 v3, v2, 2, 1
  v_mul_u32_u24 v2, 448, v2
  v_and_b32 v16, 3, v1
  v_lshlrev_b32 v16, 3, v16
  v_add_u32 v2, v2, v16
  v_add_u32 v2, 114688, v2
  v_mov_b32 v56, 0x3f803f80
  v_mov_b32 v57, 0x3f803f80
  v_mov_b32 v58, 0x3f803f80
  v_mov_b32 v59, 0x3f803f80
  s_add_u32 s37, s36, 0
  s_and_b32 s38, s37, 1
  s_andn2_b32 s39, s37, 1
  s_lshl_b32 s39, s39, 5
  v_xor_b32 v16, s38, v3
  v_lshlrev_b32 v16, 5, v16
  v_add_u32 v16, s39, v16
  v_add_u32 v20, v16, v2
  ds_read_b64_tr_b16 v[60:61], v20 offset:0
  ds_read_b64_tr_b16 v[62:63], v20 offset:7168
  ds_read_b64_tr_b16 v[64:65], v20 offset:14336
  ds_read_b64_tr_b16 v[66:67], v20 offset:21504
  s_add_u32 s37, s36, 1
  s_and_b32 s38, s37, 1
  s_andn2_b32 s39, s37, 1
  s_lshl_b32 s39, s39, 5
  v_xor_b32 v16, s38, v3
  v_lshlrev_b32 v16, 5, v16
  v_add_u32 v16, s39, v16
  v_add_u32 v21, v16, v2
  ds_read_b64_tr_b16 v[68:69], v21 offset:0
  ds_read_b64_tr_b16 v[70:71], v21 offset:7168
  ds_read_b64_tr_b16 v[72:73], v21 offset:14336
  ds_read_b64_tr_b16 v[74:75], v21 offset:21504
  s_add_u32 s37, s36, 2
  s_and_b32 s38, s37, 1
  s_andn2_b32 s39, s37, 1
  s_lshl_b32 s39, s39, 5
  v_xor_b32 v16, s38, v3
  v_lshlrev_b32 v16, 5, v16
  v_add_u32 v16, s39, v16
  v_add_u32 v22, v16, v2
  ds_read_b64_tr_b16 v[76:77], v22 offset:0
  ds_read_b64_tr_b16 v[78:79], v22 offset:7168
  ds_read_b64_tr_b16 v[80:81], v22 offset:14336
  ds_read_b64_tr_b16 v[82:83], v22 offset:21504
  s_waitcnt lgkmcnt(0)
  v_mfma_f32_16x16x32_bf16 v[24:27], v[60:63], v[56:59], 0
  v_mfma_f32_16x16x32_bf16 v[28:31], v[68:71], v[56:59], 0
  v_mfma_f32_16x16x32_bf16 v[32:35], v[76:79], v[56:59], 0
  v_mfma_f32_16x16x32_bf16 v[24:27], v[64:67], v[56:59], v[24:27]
  v_mfma_f32_16x16x32_bf16 v[28:31], v[72:75], v[56:59], v[28:31]
  v_mfma_f32_16x16x32_bf16 v[32:35], v[80:83], v[56:59], v[32:35]
  s_lshl_b32 s28, s20, 4
  s_add_u32 s28, s28, s21
  s_mul_i32 s28, s28, 896
  s_add_u32 s28, s28, 1376256
  s_lshl_b32 s37, s36, 6
  s_add_u32 s28, s28, s37
  v_lshrrev_b32 v2, 4, v1
  v_lshlrev_b32 v2, 4, v2
  s_nop 7
  s_mov_b64 exec, s[40:41]
  buffer_store_dwordx4 v[24:27], v2, s[12:15], s28 offen offset:0 sc1
  buffer_store_dwordx4 v[28:31], v2, s[12:15], s28 offen offset:64 sc1
  buffer_store_dwordx4 v[32:35], v2, s[12:15], s28 offen offset:128 sc1
  s_mov_b64 exec, -1
L_sequential_preLN__sliding_block__dense_activation_relu__prompt_kernel_cs1j:
  s_waitcnt vmcnt(0)
  s_cmp_eq_u32 s3, 4
  s_cbranch_scc0 L_sequential_preLN__sliding_block__dense_activation_relu__prompt_kernel_w4_eg3p0
  s_lshr_b32 s22, s21, 1
  s_add_u32 s22, s22, 0
  s_and_b32 s22, s22, 7
  s_lshl_b32 s22, s22, 1
  s_lshl_b32 s36, 3, s22
  s_and_b32 s37, s43, s36
  s_cmp_eq_u32 s37, s36
  s_cbranch_scc1 L_sequential_preLN__sliding_block__dense_activation_relu__prompt_kernel_w4_eg3p0
  s_mov_b32 s31, 40000
L_sequential_preLN__sliding_block__dense_activation_relu__prompt_kernel_en_g3p0:
  buffer_load_dword v110, v109, s[12:15], 0 offen sc1
  s_waitcnt vmcnt(0)
  v_readfirstlane_b32 s43, v110
  s_nop 3
  s_and_b32 s37, s43, s36
  s_cmp_eq_u32 s37, s36
  s_cbranch_scc1 L_sequential_preLN__sliding_block__dense_activation_relu__prompt_kernel_w4_eg3p0
  s_sub_u32 s31, s31, 1
  s_cmp_eq_u32 s31, 0
  s_cbranch_scc1 L_sequential_preLN__sliding_block__dense_activation_relu__prompt_kernel_w4_eg3p0
  s_nop 0
  s_branch L_sequential_preLN__sliding_block__dense_activation_relu__prompt_kernel_en_g3p0
L_sequential_preLN__sliding_block__dense_activation_relu__prompt_kernel_w4_eg3p0:
  s_cmp_eq_u32 s3, 4
  s_cbranch_scc0 L_sequential_preLN__sliding_block__dense_activation_relu__prompt_kernel_w4_eg3p1
  s_lshr_b32 s22, s21, 1
  s_add_u32 s22, s22, 1
  s_and_b32 s22, s22, 7
  s_lshl_b32 s22, s22, 1
  s_lshl_b32 s36, 3, s22
  s_and_b32 s37, s43, s36
  s_cmp_eq_u32 s37, s36
  s_cbranch_scc1 L_sequential_preLN__sliding_block__dense_activation_relu__prompt_kernel_w4_eg3p1
  s_mov_b32 s31, 40000
L_sequential_preLN__sliding_block__dense_activation_relu__prompt_kernel_en_g3p1:
  buffer_load_dword v110, v109, s[12:15], 0 offen sc1
  s_waitcnt vmcnt(0)
  v_readfirstlane_b32 s43, v110
  s_nop 3
  s_and_b32 s37, s43, s36
  s_cmp_eq_u32 s37, s36
  s_cbranch_scc1 L_sequential_preLN__sliding_block__dense_activation_relu__prompt_kernel_w4_eg3p1
  s_sub_u32 s31, s31, 1
  s_cmp_eq_u32 s31, 0
  s_cbranch_scc1 L_sequential_preLN__sliding_block__dense_activation_relu__prompt_kernel_w4_eg3p1
  s_nop 0
  s_branch L_sequential_preLN__sliding_block__dense_activation_relu__prompt_kernel_en_g3p1
L_sequential_preLN__sliding_block__dense_activation_relu__prompt_kernel_w4_eg3p1:
  s_barrier
  s_cmp_eq_u32 s3, 4
  s_cbranch_scc0 L_sequential_preLN__sliding_block__dense_activation_relu__prompt_kernel_w4_cs
  s_lshl_b32 s28, s21, 7
  s_add_u32 s28, s28, 3219456
  v_mov_b32 v2, 0
  v_mov_b32 v3, 1
  s_mov_b64 exec, 1
  buffer_atomic_add v3, v2, s[12:15], s28 offen sc1
  s_mov_b64 exec, -1
L_sequential_preLN__sliding_block__dense_activation_relu__prompt_kernel_w4_cs:
  s_lshr_b32 s22, s21, 1
  s_add_u32 s22, s22, 0
  s_and_b32 s22, s22, 7
  s_mul_i32 s22, s22, 524288
  s_add_u32 s24, s32, s22
  s_mov_b32 s23, 0
  s_add_u32 m0, s23, s44
  s_nop 0
  buffer_load_dwordx4 v96, s[12:15], s24 offen offset:0 sc1 lds
  buffer_load_dwordx4 v96, s[12:15], s24 offen offset:1024 sc1 lds
  buffer_load_dwordx4 v96, s[12:15], s24 offen offset:2048 sc1 lds
  buffer_load_dwordx4 v96, s[12:15], s24 offen offset:3072 sc1 lds
  s_add_u32 m0, m0, 4096
  s_add_u32 s30, s24, 4096
  buffer_load_dwordx4 v96, s[12:15], s30 offen offset:0 sc1 lds
  buffer_load_dwordx4 v96, s[12:15], s30 offen offset:1024 sc1 lds
  buffer_load_dwordx4 v96, s[12:15], s30 offen offset:2048 sc1 lds
  buffer_load_dwordx4 v96, s[12:15], s30 offen offset:3072 sc1 lds
  s_lshr_b32 s22, s21, 1
  s_add_u32 s22, s22, 1
  s_and_b32 s22, s22, 7
  s_mul_i32 s22, s22, 524288
  s_add_u32 s24, s32, s22
  s_mov_b32 s23, 49152
  s_add_u32 m0, s23, s44
  s_nop 0
  buffer_load_dwordx4 v96, s[12:15], s24 offen offset:0 sc1 lds
  buffer_load_dwordx4 v96, s[12:15], s24 offen offset:1024 sc1 lds
  buffer_load_dwordx4 v96, s[12:15], s24 offen offset:2048 sc1 lds
  buffer_load_dwordx4 v96, s[12:15], s24 offen offset:3072 sc1 lds
  s_add_u32 m0, m0, 4096
  s_add_u32 s30, s24, 4096
  buffer_load_dwordx4 v96, s[12:15], s30 offen offset:0 sc1 lds
  buffer_load_dwordx4 v96, s[12:15], s30 offen offset:1024 sc1 lds
  buffer_load_dwordx4 v96, s[12:15], s30 offen offset:2048 sc1 lds
  buffer_load_dwordx4 v96, s[12:15], s30 offen offset:3072 sc1 lds
  s_waitcnt vmcnt(8)
  s_cmp_eq_u32 s3, 4
  s_cbranch_scc0 L_sequential_preLN__sliding_block__dense_activation_relu__prompt_kernel_w4_eg3p2
  s_lshr_b32 s22, s21, 1
  s_add_u32 s22, s22, 2
  s_and_b32 s22, s22, 7
  s_lshl_b32 s22, s22, 1
  s_lshl_b32 s36, 3, s22
  s_and_b32 s37, s43, s36
  s_cmp_eq_u32 s37, s36
  s_cbranch_scc1 L_sequential_preLN__sliding_block__dense_activation_relu__prompt_kernel_w4_eg3p2
  s_mov_b32 s31, 40000
L_sequential_preLN__sliding_block__dense_activation_relu__prompt_kernel_en_g3p2:
  buffer_load_dword v110, v109, s[12:15], 0 offen sc1
  s_waitcnt vmcnt(0)
  v_readfirstlane_b32 s43, v110
  s_nop 3
  s_and_b32 s37, s43, s36
  s_cmp_eq_u32 s37, s36
  s_cbranch_scc1 L_sequential_preLN__sliding_block__dense_activation_relu__prompt_kernel_w4_eg3p2
  s_sub_u32 s31, s31, 1
  s_cmp_eq_u32 s31, 0
  s_cbranch_scc1 L_sequential_preLN__sliding_block__dense_activation_relu__prompt_kernel_w4_eg3p2
  s_nop 0
  s_branch L_sequential_preLN__sliding_block__dense_activation_relu__prompt_kernel_en_g3p2
L_sequential_preLN__sliding_block__dense_activation_relu__prompt_kernel_w4_eg3p2:
  s_barrier
  s_lshr_b32 s22, s21, 1
  s_add_u32 s22, s22, 2
  s_and_b32 s22, s22, 7
  s_mul_i32 s22, s22, 262144
  s_add_u32 s25, s33, s22
  s_mov_b32 s23, 98304
  s_add_u32 m0, s23, s45
  s_mov_b32 s30, s25
  buffer_load_dwordx4 v97, s[16:19], s30 offen lds
  s_add_u32 m0, m0, 1024
  s_add_u32 s30, s30, 16384
  buffer_load_dwordx4 v97, s[16:19], s30 offen lds
  s_add_u32 m0, m0, 1024
  s_add_u32 s30, s30, 16384
  buffer_load_dwordx4 v97, s[16:19], s30 offen lds
  s_add_u32 m0, m0, 1024
  s_add_u32 s30, s30, 16384
  buffer_load_dwordx4 v97, s[16:19], s30 offen lds
  s_lshr_b32 s22, s21, 1
  s_add_u32 s22, s22, 2
  s_and_b32 s22, s22, 7
  s_mul_i32 s22, s22, 524288
  s_add_u32 s24, s32, s22
  s_mov_b32 s23, 98304
  s_add_u32 m0, s23, s44
  s_nop 0
  buffer_load_dwordx4 v96, s[12:15], s24 offen offset:0 sc1 lds
  buffer_load_dwordx4 v96, s[12:15], s24 offen offset:1024 sc1 lds
  buffer_load_dwordx4 v96, s[12:15], s24 offen offset:2048 sc1 lds
  buffer_load_dwordx4 v96, s[12:15], s24 offen offset:3072 sc1 lds
  s_add_u32 m0, m0, 4096
  s_add_u32 s30, s24, 4096
  buffer_load_dwordx4 v96, s[12:15], s30 offen offset:0 sc1 lds
  buffer_load_dwordx4 v96, s[12:15], s30 offen offset:1024 sc1 lds
  buffer_load_dwordx4 v96, s[12:15], s30 offen offset:2048 sc1 lds
  buffer_load_dwordx4 v96, s[12:15], s30 offen offset:3072 sc1 lds
  s_cmp_eq_u32 s3, 4
  s_cbranch_scc0 L_sequential_preLN__sliding_block__dense_activation_relu__prompt_kernel_w4_eg3p3
  s_lshr_b32 s22, s21, 1
  s_add_u32 s22, s22, 3
  s_and_b32 s22, s22, 7
  s_lshl_b32 s22, s22, 1
  s_lshl_b32 s36, 3, s22
  s_and_b32 s37, s43, s36
  s_cmp_eq_u32 s37, s36
  s_cbranch_scc1 L_sequential_preLN__sliding_block__dense_activation_relu__prompt_kernel_w4_eg3p3
  s_mov_b32 s31, 40000
L_sequential_preLN__sliding_block__dense_activation_relu__prompt_kernel_en_g3p3:
  buffer_load_dword v110, v109, s[12:15], 0 offen sc1
  s_waitcnt vmcnt(0)
  v_readfirstlane_b32 s43, v110
  s_nop 3
  s_and_b32 s37, s43, s36
  s_cmp_eq_u32 s37, s36
  s_cbranch_scc1 L_sequential_preLN__sliding_block__dense_activation_relu__prompt_kernel_w4_eg3p3
  s_sub_u32 s31, s31, 1
  s_cmp_eq_u32 s31, 0
  s_cbranch_scc1 L_sequential_preLN__sliding_block__dense_activation_relu__prompt_kernel_w4_eg3p3
  s_nop 0
  s_branch L_sequential_preLN__sliding_block__dense_activation_relu__prompt_kernel_en_g3p3
L_sequential_preLN__sliding_block__dense_activation_relu__prompt_kernel_w4_eg3p3:
  s_waitcnt vmcnt(12)
  s_barrier
  s_cmp_eq_u32 s3, 4
  s_cbranch_scc0 L_sequential_preLN__sliding_block__dense_activation_relu__prompt_kernel_w4_g3r0
  buffer_load_dword v111, v109, s[12:15], 0 offen sc1
L_sequential_preLN__sliding_block__dense_activation_relu__prompt_kernel_w4_g3r0:
  s_lshr_b32 s22, s21, 1
  s_add_u32 s22, s22, 3
  s_and_b32 s22, s22, 7
  s_mul_i32 s22, s22, 524288
  s_add_u32 s24, s32, s22
  s_mov_b32 s23, 0
  s_add_u32 m0, s23, s44
  s_nop 0
  buffer_load_dwordx4 v96, s[12:15], s24 offen offset:0 sc1 lds
  buffer_load_dwordx4 v96, s[12:15], s24 offen offset:1024 sc1 lds
  buffer_load_dwordx4 v96, s[12:15], s24 offen offset:2048 sc1 lds
  buffer_load_dwordx4 v96, s[12:15], s24 offen offset:3072 sc1 lds
  s_add_u32 m0, m0, 4096
  s_add_u32 s30, s24, 4096
  buffer_load_dwordx4 v96, s[12:15], s30 offen offset:0 sc1 lds
  buffer_load_dwordx4 v96, s[12:15], s30 offen offset:1024 sc1 lds
  buffer_load_dwordx4 v96, s[12:15], s30 offen offset:2048 sc1 lds
  buffer_load_dwordx4 v96, s[12:15], s30 offen offset:3072 sc1 lds
  s_lshr_b32 s22, s21, 1
  s_add_u32 s22, s22, 3
  s_and_b32 s22, s22, 7
  s_mul_i32 s22, s22, 262144
  s_add_u32 s25, s33, s22
  s_mov_b32 s23, 0
  s_add_u32 m0, s23, s45
  s_mov_b32 s30, s25
  buffer_load_dwordx4 v97, s[16:19], s30 offen lds
  s_add_u32 m0, m0, 1024
  s_add_u32 s30, s30, 16384
  buffer_load_dwordx4 v97, s[16:19], s30 offen lds
  s_add_u32 m0, m0, 1024
  s_add_u32 s30, s30, 16384
  buffer_load_dwordx4 v97, s[16:19], s30 offen lds
  s_add_u32 m0, m0, 1024
  s_add_u32 s30, s30, 16384
  buffer_load_dwordx4 v97, s[16:19], s30 offen lds
  s_cmp_eq_u32 s3, 4
  s_cbranch_scc0 L_sequential_preLN__sliding_block__dense_activation_relu__prompt_kernel_w4_eg3p4
  s_lshr_b32 s22, s21, 1
  s_add_u32 s22, s22, 4
  s_and_b32 s22, s22, 7
  s_lshl_b32 s22, s22, 1
  s_lshl_b32 s36, 3, s22
  s_and_b32 s37, s43, s36
  s_cmp_eq_u32 s37, s36
  s_cbranch_scc1 L_sequential_preLN__sliding_block__dense_activation_relu__prompt_kernel_w4_eg3p4
  s_mov_b32 s31, 40000
L_sequential_preLN__sliding_block__dense_activation_relu__prompt_kernel_en_g3p4:
  buffer_load_dword v110, v109, s[12:15], 0 offen sc1
  s_waitcnt vmcnt(0)
  v_readfirstlane_b32 s43, v110
  s_nop 3
  s_and_b32 s37, s43, s36
  s_cmp_eq_u32 s37, s36
  s_cbranch_scc1 L_sequential_preLN__sliding_block__dense_activation_relu__prompt_kernel_w4_eg3p4
  s_sub_u32 s31, s31, 1
  s_cmp_eq_u32 s31, 0
  s_cbranch_scc1 L_sequential_preLN__sliding_block__dense_activation_relu__prompt_kernel_w4_eg3p4
  s_nop 0
  s_branch L_sequential_preLN__sliding_block__dense_activation_relu__prompt_kernel_en_g3p4
L_sequential_preLN__sliding_block__dense_activation_relu__prompt_kernel_w4_eg3p4:
  s_waitcnt vmcnt(12)
  s_barrier
  s_cmp_eq_u32 s3, 4
  s_cbranch_scc0 L_sequential_preLN__sliding_block__dense_activation_relu__prompt_kernel_w4_g3r1
  buffer_load_dword v112, v109, s[12:15], 0 offen sc1
L_sequential_preLN__sliding_block__dense_activation_relu__prompt_kernel_w4_g3r1:
  s_lshr_b32 s22, s21, 1
  s_add_u32 s22, s22, 4
  s_and_b32 s22, s22, 7
  s_mul_i32 s22, s22, 524288
  s_add_u32 s24, s32, s22
  s_mov_b32 s23, 49152
  s_add_u32 m0, s23, s44
  s_nop 0
  buffer_load_dwordx4 v96, s[12:15], s24 offen offset:0 sc1 lds
  buffer_load_dwordx4 v96, s[12:15], s24 offen offset:1024 sc1 lds
  buffer_load_dwordx4 v96, s[12:15], s24 offen offset:2048 sc1 lds
  buffer_load_dwordx4 v96, s[12:15], s24 offen offset:3072 sc1 lds
  s_add_u32 m0, m0, 4096
  s_add_u32 s30, s24, 4096
  buffer_load_dwordx4 v96, s[12:15], s30 offen offset:0 sc1 lds
  buffer_load_dwordx4 v96, s[12:15], s30 offen offset:1024 sc1 lds
  buffer_load_dwordx4 v96, s[12:15], s30 offen offset:2048 sc1 lds
  buffer_load_dwordx4 v96, s[12:15], s30 offen offset:3072 sc1 lds
  s_lshr_b32 s22, s21, 1
  s_add_u32 s22, s22, 4
  s_and_b32 s22, s22, 7
  s_mul_i32 s22, s22, 262144
  s_add_u32 s25, s33, s22
  s_mov_b32 s23, 49152
  s_add_u32 m0, s23, s45
  s_mov_b32 s30, s25
  buffer_load_dwordx4 v97, s[16:19], s30 offen lds
  s_add_u32 m0, m0, 1024
  s_add_u32 s30, s30, 16384
  buffer_load_dwordx4 v97, s[16:19], s30 offen lds
  s_add_u32 m0, m0, 1024
  s_add_u32 s30, s30, 16384
  buffer_load_dwordx4 v97, s[16:19], s30 offen lds
  s_add_u32 m0, m0, 1024
  s_add_u32 s30, s30, 16384
  buffer_load_dwordx4 v97, s[16:19], s30 offen lds
  s_cmp_eq_u32 s3, 4
  s_cbranch_scc0 L_sequential_preLN__sliding_block__dense_activation_relu__prompt_kernel_w4_eg3p5
  s_lshr_b32 s22, s21, 1
  s_add_u32 s22, s22, 5
  s_and_b32 s22, s22, 7
  s_lshl_b32 s22, s22, 1
  s_lshl_b32 s36, 3, s22
  s_and_b32 s37, s43, s36
  s_cmp_eq_u32 s37, s36
  s_cbranch_scc1 L_sequential_preLN__sliding_block__dense_activation_relu__prompt_kernel_w4_eg3p5
  s_mov_b32 s31, 40000
L_sequential_preLN__sliding_block__dense_activation_relu__prompt_kernel_en_g3p5:
  buffer_load_dword v110, v109, s[12:15], 0 offen sc1
  s_waitcnt vmcnt(0)
  v_readfirstlane_b32 s43, v110
  s_nop 3
  s_and_b32 s37, s43, s36
  s_cmp_eq_u32 s37, s36
  s_cbranch_scc1 L_sequential_preLN__sliding_block__dense_activation_relu__prompt_kernel_w4_eg3p5
  s_sub_u32 s31, s31, 1
  s_cmp_eq_u32 s31, 0
  s_cbranch_scc1 L_sequential_preLN__sliding_block__dense_activation_relu__prompt_kernel_w4_eg3p5
  s_nop 0
  s_branch L_sequential_preLN__sliding_block__dense_activation_relu__prompt_kernel_en_g3p5
L_sequential_preLN__sliding_block__dense_activation_relu__prompt_kernel_w4_eg3p5:
  s_waitcnt vmcnt(12)
  s_barrier
  s_lshr_b32 s22, s21, 1
  s_add_u32 s22, s22, 5
  s_and_b32 s22, s22, 7
  s_mul_i32 s22, s22, 524288
  s_add_u32 s24, s32, s22
  s_mov_b32 s23, 98304
  s_add_u32 m0, s23, s44
  s_nop 0
  buffer_load_dwordx4 v96, s[12:15], s24 offen offset:0 sc1 lds
  buffer_load_dwordx4 v96, s[12:15], s24 offen offset:1024 sc1 lds
  buffer_load_dwordx4 v96, s[12:15], s24 offen offset:2048 sc1 lds
  buffer_load_dwordx4 v96, s[12:15], s24 offen offset:3072 sc1 lds
  s_add_u32 m0, m0, 4096
  s_add_u32 s30, s24, 4096
  buffer_load_dwordx4 v96, s[12:15], s30 offen offset:0 sc1 lds
  buffer_load_dwordx4 v96, s[12:15], s30 offen offset:1024 sc1 lds
  buffer_load_dwordx4 v96, s[12:15], s30 offen offset:2048 sc1 lds
  buffer_load_dwordx4 v96, s[12:15], s30 offen offset:3072 sc1 lds
  s_lshr_b32 s22, s21, 1
  s_add_u32 s22, s22, 5
  s_and_b32 s22, s22, 7
  s_mul_i32 s22, s22, 262144
  s_add_u32 s25, s33, s22
  s_mov_b32 s23, 98304
  s_add_u32 m0, s23, s45
  s_mov_b32 s30, s25
  buffer_load_dwordx4 v97, s[16:19], s30 offen lds
  s_add_u32 m0, m0, 1024
  s_add_u32 s30, s30, 16384
  buffer_load_dwordx4 v97, s[16:19], s30 offen lds
  s_add_u32 m0, m0, 1024
  s_add_u32 s30, s30, 16384
  buffer_load_dwordx4 v97, s[16:19], s30 offen lds
  s_add_u32 m0, m0, 1024
  s_add_u32 s30, s30, 16384
  buffer_load_dwordx4 v97, s[16:19], s30 offen lds
  s_cmp_eq_u32 s3, 4
  s_cbranch_scc0 L_sequential_preLN__sliding_block__dense_activation_relu__prompt_kernel_w4_g3m3
  v_readfirstlane_b32 s37, v111
  s_nop 3
  s_or_b32 s43, s43, s37
L_sequential_preLN__sliding_block__dense_activation_relu__prompt_kernel_w4_g3m3:
  s_cmp_eq_u32 s3, 4
  s_cbranch_scc0 L_sequential_preLN__sliding_block__dense_activation_relu__prompt_kernel_w4_eg3p6
  s_lshr_b32 s22, s21, 1
  s_add_u32 s22, s22, 6
  s_and_b32 s22, s22, 7
  s_lshl_b32 s22, s22, 1
  s_lshl_b32 s36, 3, s22
  s_and_b32 s37, s43, s36
  s_cmp_eq_u32 s37, s36
  s_cbranch_scc1 L_sequential_preLN__sliding_block__dense_activation_relu__prompt_kernel_w4_eg3p6
  s_mov_b32 s31, 40000
L_sequential_preLN__sliding_block__dense_activation_relu__prompt_kernel_en_g3p6:
  buffer_load_dword v110, v109, s[12:15], 0 offen sc1
  s_waitcnt vmcnt(0)
  v_readfirstlane_b32 s43, v110
  s_nop 3
  s_and_b32 s37, s43, s36
  s_cmp_eq_u32 s37, s36
  s_cbranch_scc1 L_sequential_preLN__sliding_block__dense_activation_relu__prompt_kernel_w4_eg3p6
  s_sub_u32 s31, s31, 1
  s_cmp_eq_u32 s31, 0
  s_cbranch_scc1 L_sequential_preLN__sliding_block__dense_activation_relu__prompt_kernel_w4_eg3p6
  s_nop 0
  s_branch L_sequential_preLN__sliding_block__dense_activation_relu__prompt_kernel_en_g3p6
L_sequential_preLN__sliding_block__dense_activation_relu__prompt_kernel_w4_eg3p6:
  s_waitcnt vmcnt(12)
  s_barrier
  s_lshr_b32 s22, s21, 1
  s_add_u32 s22, s22, 6
  s_and_b32 s22, s22, 7
  s_mul_i32 s22, s22, 524288
  s_add_u32 s24, s32, s22
  s_mov_b32 s23, 0
  s_add_u32 m0, s23, s44
  s_nop 0
  buffer_load_dwordx4 v96, s[12:15], s24 offen offset:0 sc1 lds
  buffer_load_dwordx4 v96, s[12:15], s24 offen offset:1024 sc1 lds
  buffer_load_dwordx4 v96, s[12:15], s24 offen offset:2048 sc1 lds
  buffer_load_dwordx4 v96, s[12:15], s24 offen offset:3072 sc1 lds
  s_add_u32 m0, m0, 4096
  s_add_u32 s30, s24, 4096
  buffer_load_dwordx4 v96, s[12:15], s30 offen offset:0 sc1 lds
  buffer_load_dwordx4 v96, s[12:15], s30 offen offset:1024 sc1 lds
  buffer_load_dwordx4 v96, s[12:15], s30 offen offset:2048 sc1 lds
  buffer_load_dwordx4 v96, s[12:15], s30 offen offset:3072 sc1 lds
  s_lshr_b32 s22, s21, 1
  s_add_u32 s22, s22, 6
  s_and_b32 s22, s22, 7
  s_mul_i32 s22, s22, 262144
  s_add_u32 s25, s33, s22
  s_mov_b32 s23, 0
  s_add_u32 m0, s23, s45
  s_mov_b32 s30, s25
  buffer_load_dwordx4 v97, s[16:19], s30 offen lds
  s_add_u32 m0, m0, 1024
  s_add_u32 s30, s30, 16384
  buffer_load_dwordx4 v97, s[16:19], s30 offen lds
  s_add_u32 m0, m0, 1024
  s_add_u32 s30, s30, 16384
  buffer_load_dwordx4 v97, s[16:19], s30 offen lds
  s_add_u32 m0, m0, 1024
  s_add_u32 s30, s30, 16384
  buffer_load_dwordx4 v97, s[16:19], s30 offen lds
  s_cmp_eq_u32 s3, 4
  s_cbranch_scc0 L_sequential_preLN__sliding_block__dense_activation_relu__prompt_kernel_w4_g3m4
  v_readfirstlane_b32 s37, v112
  s_nop 3
  s_or_b32 s43, s43, s37
L_sequential_preLN__sliding_block__dense_activation_relu__prompt_kernel_w4_g3m4:
  s_cmp_eq_u32 s3, 4
  s_cbranch_scc0 L_sequential_preLN__sliding_block__dense_activation_relu__prompt_kernel_w4_eg3p7
  s_lshr_b32 s22, s21, 1
  s_add_u32 s22, s22, 7
  s_and_b32 s22, s22, 7
  s_lshl_b32 s22, s22, 1
  s_lshl_b32 s36, 3, s22
  s_and_b32 s37, s43, s36
  s_cmp_eq_u32 s37, s36
  s_cbranch_scc1 L_sequential_preLN__sliding_block__dense_activation_relu__prompt_kernel_w4_eg3p7
  s_mov_b32 s31, 40000
L_sequential_preLN__sliding_block__dense_activation_relu__prompt_kernel_en_g3p7:
  buffer_load_dword v110, v109, s[12:15], 0 offen sc1
  s_waitcnt vmcnt(0)
  v_readfirstlane_b32 s43, v110
  s_nop 3
  s_and_b32 s37, s43, s36
  s_cmp_eq_u32 s37, s36
  s_cbranch_scc1 L_sequential_preLN__sliding_block__dense_activation_relu__prompt_kernel_w4_eg3p7
  s_sub_u32 s31, s31, 1
  s_cmp_eq_u32 s31, 0
  s_cbranch_scc1 L_sequential_preLN__sliding_block__dense_activation_relu__prompt_kernel_w4_eg3p7
  s_nop 0
  s_branch L_sequential_preLN__sliding_block__dense_activation_relu__prompt_kernel_en_g3p7
L_sequential_preLN__sliding_block__dense_activation_relu__prompt_kernel_w4_eg3p7:
  s_waitcnt vmcnt(12)
  s_barrier
  s_lshr_b32 s22, s21, 1
  s_add_u32 s22, s22, 7
  s_and_b32 s22, s22, 7
  s_mul_i32 s22, s22, 524288
  s_add_u32 s24, s32, s22
  s_mov_b32 s23, 49152
  s_add_u32 m0, s23, s44
  s_nop 0
  buffer_load_dwordx4 v96, s[12:15], s24 offen offset:0 sc1 lds
  buffer_load_dwordx4 v96, s[12:15], s24 offen offset:1024 sc1 lds
  buffer_load_dwordx4 v96, s[12:15], s24 offen offset:2048 sc1 lds
  buffer_load_dwordx4 v96, s[12:15], s24 offen offset:3072 sc1 lds
  s_add_u32 m0, m0, 4096
  s_add_u32 s30, s24, 4096
  buffer_load_dwordx4 v96, s[12:15], s30 offen offset:0 sc1 lds
  buffer_load_dwordx4 v96, s[12:15], s30 offen offset:1024 sc1 lds
  buffer_load_dwordx4 v96, s[12:15], s30 offen offset:2048 sc1 lds
  buffer_load_dwordx4 v96, s[12:15], s30 offen offset:3072 sc1 lds
  s_lshr_b32 s22, s21, 1
  s_add_u32 s22, s22, 7
  s_and_b32 s22, s22, 7
  s_mul_i32 s22, s22, 262144
  s_add_u32 s25, s33, s22
  s_mov_b32 s23, 49152
  s_add_u32 m0, s23, s45
  s_mov_b32 s30, s25
  buffer_load_dwordx4 v97, s[16:19], s30 offen lds
  s_add_u32 m0, m0, 1024
  s_add_u32 s30, s30, 16384
  buffer_load_dwordx4 v97, s[16:19], s30 offen lds
  s_add_u32 m0, m0, 1024
  s_add_u32 s30, s30, 16384
  buffer_load_dwordx4 v97, s[16:19], s30 offen lds
  s_add_u32 m0, m0, 1024
  s_add_u32 s30, s30, 16384
  buffer_load_dwordx4 v97, s[16:19], s30 offen lds
  s_waitcnt vmcnt(12)
  s_barrier
  s_waitcnt vmcnt(0)
  s_barrier
  s_barrier
  v_mov_b32 v113, 0
  v_mov_b32 v114, 0
  v_mov_b32 v115, 0
  s_sub_u32 s26, s3, 4
  s_lshl_b32 s24, s20, 13
  s_add_u32 s24, s24, 20971520
  s_lshr_b32 s27, s26, 1
  s_mul_i32 s27, s27, 131072
  s_add_u32 s24, s24, s27
  s_and_b32 s27, s26, 1
  s_lshl_b32 s27, s27, 12
  s_add_u32 s24, s24, s27
  s_mul_i32 s44, s26, 4096
  s_add_u32 s44, s44, 0
  s_mul_i32 s25, s21, 448
  s_mul_i32 s27, s26, 114688
  s_add_u32 s25, s25, s27
  s_mul_i32 s45, s26, 7168
  s_add_u32 s45, s45, 16384
  s_mov_b32 s23, 0
  s_mov_b32 s32, s24
  s_mov_b32 s33, s25
  s_sub_u32 s42, s3, 4
  s_lshr_b32 s42, s42, 1
  s_lshl_b32 s29, s20, 7
  s_add_u32 s29, s29, 3213312
  v_mov_b32 v109, s29
  s_mov_b32 s43, 0
  v_mov_b32 v110, 0
  v_mov_b32 v111, 0
  v_mov_b32 v112, 0
  v_mov_b32 v116, 0
  v_mov_b32 v117, 0
  s_barrier
  s_add_u32 s22, s21, 0
  s_and_b32 s22, s22, 15
  s_mul_i32 s22, s22, 458752
  s_add_u32 s25, s33, s22
  s_mov_b32 s23, 0
  s_add_u32 m0, s23, s45
  s_mov_b32 s30, s25
  buffer_load_dwordx4 v98, s[48:51], s30 offen lds
  s_add_u32 m0, m0, 1024
  s_nop 0
  buffer_load_dwordx4 v99, s[48:51], s30 offen lds
  s_add_u32 m0, m0, 1024
  s_nop 0
  buffer_load_dwordx4 v100, s[48:51], s30 offen lds
  s_add_u32 m0, m0, 1024
  s_nop 0
  buffer_load_dwordx4 v101, s[48:51], s30 offen lds
  s_add_u32 m0, m0, 1024
  s_nop 0
  buffer_load_dwordx4 v102, s[48:51], s30 offen lds
  s_add_u32 m0, m0, 1024
  s_nop 0
  buffer_load_dwordx4 v103, s[48:51], s30 offen lds
  s_add_u32 m0, m0, 1024
  s_nop 0
  buffer_load_dwordx4 v104, s[48:51], s30 offen lds
  s_add_u32 s22, s21, 1
  s_and_b32 s22, s22, 15
  s_mul_i32 s22, s22, 458752
  s_add_u32 s25, s33, s22
  s_mov_b32 s23, 45056
  s_add_u32 m0, s23, s45
  s_mov_b32 s30, s25
  buffer_load_dwordx4 v98, s[48:51], s30 offen lds
  s_add_u32 m0, m0, 1024
  s_nop 0
  buffer_load_dwordx4 v99, s[48:51], s30 offen lds
  s_add_u32 m0, m0, 1024
  s_nop 0
  buffer_load_dwordx4 v100, s[48:51], s30 offen lds
  s_add_u32 m0, m0, 1024
  s_nop 0
  buffer_load_dwordx4 v101, s[48:51], s30 offen lds
  s_add_u32 m0, m0, 1024
  s_nop 0
  buffer_load_dwordx4 v102, s[48:51], s30 offen lds
  s_add_u32 m0, m0, 1024
  s_nop 0
  buffer_load_dwordx4 v103, s[48:51], s30 offen lds
  s_add_u32 m0, m0, 1024
  s_nop 0
  buffer_load_dwordx4 v104, s[48:51], s30 offen lds
  s_barrier
  s_add_u32 s22, s21, 0
  s_and_b32 s22, s22, 15
  s_mul_i32 s22, s22, 262144
  s_add_u32 s24, s32, s22
  s_mov_b32 s23, 0
  s_add_u32 m0, s23, s44
  s_nop 0
  buffer_load_dwordx4 v96, s[12:15], s24 offen offset:0 sc1 lds
  buffer_load_dwordx4 v96, s[12:15], s24 offen offset:1024 sc1 lds
  buffer_load_dwordx4 v96, s[12:15], s24 offen offset:2048 sc1 lds
  buffer_load_dwordx4 v96, s[12:15], s24 offen offset:3072 sc1 lds
  s_cmp_eq_u32 s3, 4
  s_cbranch_scc0 L_sequential_preLN__sliding_block__dense_activation_relu__prompt_kernel_w4_g4s
  s_lshl_b32 s28, s20, 7
  s_add_u32 s28, s28, 3213312
  s_mov_b32 s29, s21
  s_lshl_b32 s29, 1, s29
  v_mov_b32 v2, 0
  v_mov_b32 v3, s29
  s_mov_b64 exec, 1
  buffer_atomic_or v3, v2, s[12:15], s28 offen sc1
  s_mov_b64 exec, -1
L_sequential_preLN__sliding_block__dense_activation_relu__prompt_kernel_w4_g4s:
  s_cmp_eq_u32 s3, 7
  s_cbranch_scc0 L_sequential_preLN__sliding_block__dense_activation_relu__prompt_kernel_wpf6
  s_lshl_b32 s46, s20, 4
  s_add_u32 s46, s46, s21
  s_lshr_b32 s36, s46, 7
  s_mul_i32 s36, s36, 1792
  s_and_b32 s37, s46, 127
  s_lshl_b32 s37, s37, 2
  s_add_u32 s36, s36, s37
  v_lshrrev_b32 v2, 4, v1
  v_add_u32 v2, s36, v2
  v_lshlrev_b32 v2, 11, v2
  v_and_b32 v3, 15, v1
  v_lshl_add_u32 v120, v3, 7, v2
  s_mov_b32 s47, 2097152
  buffer_load_dword a88, v120, s[52:55], s47 offen
  s_and_b32 s47, s46, 127
  s_cmp_lt_u32 s47, 64
  s_cbranch_scc0 L_sequential_preLN__sliding_block__dense_activation_relu__prompt_kernel_wpf8
  s_mov_b32 s47, 3145728
  buffer_load_dword a88, v120, s[52:55], s47 offen
L_sequential_preLN__sliding_block__dense_activation_relu__prompt_kernel_wpf8:
L_sequential_preLN__sliding_block__dense_activation_relu__prompt_kernel_wpf6:
  s_add_u32 s22, s21, 2
  s_and_b32 s22, s22, 15
  s_mul_i32 s22, s22, 458752
  s_add_u32 s25, s33, s22
  s_mov_b32 s23, 90112
  s_add_u32 m0, s23, s45
  s_mov_b32 s30, s25
  buffer_load_dwordx4 v98, s[48:51], s30 offen lds
  s_add_u32 m0, m0, 1024
  s_nop 0
  buffer_load_dwordx4 v99, s[48:51], s30 offen lds
  s_add_u32 m0, m0, 1024
  s_nop 0
  buffer_load_dwordx4 v100, s[48:51], s30 offen lds
  s_add_u32 m0, m0, 1024
  s_nop 0
  buffer_load_dwordx4 v101, s[48:51], s30 offen lds
  s_add_u32 m0, m0, 1024
  s_nop 0
  buffer_load_dwordx4 v102, s[48:51], s30 offen lds
  s_add_u32 m0, m0, 1024
  s_nop 0
  buffer_load_dwordx4 v103, s[48:51], s30 offen lds
  s_add_u32 m0, m0, 1024
  s_nop 0
  buffer_load_dwordx4 v104, s[48:51], s30 offen lds
  s_cmp_eq_u32 s3, 4
  s_cbranch_scc0 L_sequential_preLN__sliding_block__dense_activation_relu__prompt_kernel_w4_eg4p1
  s_add_u32 s22, s21, 1
  s_and_b32 s22, s22, 15
  s_lshl_b32 s36, 1, s22
  s_and_b32 s37, s43, s36
  s_cmp_eq_u32 s37, s36
  s_cbranch_scc1 L_sequential_preLN__sliding_block__dense_activation_relu__prompt_kernel_w4_eg4p1
  s_mov_b32 s31, 40000
L_sequential_preLN__sliding_block__dense_activation_relu__prompt_kernel_en_g4p1:
  buffer_load_dword v110, v109, s[12:15], 0 offen sc1
  s_waitcnt vmcnt(0)
  v_readfirstlane_b32 s43, v110
  s_nop 3
  s_and_b32 s37, s43, s36
  s_cmp_eq_u32 s37, s36
  s_cbranch_scc1 L_sequential_preLN__sliding_block__dense_activation_relu__prompt_kernel_w4_eg4p1
  s_sub_u32 s31, s31, 1
  s_cmp_eq_u32 s31, 0
  s_cbranch_scc1 L_sequential_preLN__sliding_block__dense_activation_relu__prompt_kernel_w4_eg4p1
  s_nop 0
  s_branch L_sequential_preLN__sliding_block__dense_activation_relu__prompt_kernel_en_g4p1
L_sequential_preLN__sliding_block__dense_activation_relu__prompt_kernel_w4_eg4p1:
  s_barrier
  s_add_u32 s22, s21, 1
  s_and_b32 s22, s22, 15
  s_mul_i32 s22, s22, 262144
  s_add_u32 s24, s32, s22
  s_mov_b32 s23, 45056
  s_add_u32 m0, s23, s44
  s_nop 0
  buffer_load_dwordx4 v96, s[12:15], s24 offen offset:0 sc1 lds
  buffer_load_dwordx4 v96, s[12:15], s24 offen offset:1024 sc1 lds
  buffer_load_dwordx4 v96, s[12:15], s24 offen offset:2048 sc1 lds
  buffer_load_dwordx4 v96, s[12:15], s24 offen offset:3072 sc1 lds
  s_waitcnt vmcnt(11)
  s_cmp_eq_u32 s3, 4
  s_cbranch_scc0 L_sequential_preLN__sliding_block__dense_activation_relu__prompt_kernel_w4_eg4p2
  s_add_u32 s22, s21, 2
  s_and_b32 s22, s22, 15
  s_lshl_b32 s36, 1, s22
  s_and_b32 s37, s43, s36
  s_cmp_eq_u32 s37, s36
  s_cbranch_scc1 L_sequential_preLN__sliding_block__dense_activation_relu__prompt_kernel_w4_eg4p2
  s_mov_b32 s31, 40000
L_sequential_preLN__sliding_block__dense_activation_relu__prompt_kernel_en_g4p2:
  buffer_load_dword v110, v109, s[12:15], 0 offen sc1
  s_waitcnt vmcnt(0)
  v_readfirstlane_b32 s43, v110
  s_nop 3
  s_and_b32 s37, s43, s36
  s_cmp_eq_u32 s37, s36
  s_cbranch_scc1 L_sequential_preLN__sliding_block__dense_activation_relu__prompt_kernel_w4_eg4p2
  s_sub_u32 s31, s31, 1
  s_cmp_eq_u32 s31, 0
  s_cbranch_scc1 L_sequential_preLN__sliding_block__dense_activation_relu__prompt_kernel_w4_eg4p2
  s_nop 0
  s_branch L_sequential_preLN__sliding_block__dense_activation_relu__prompt_kernel_en_g4p2
L_sequential_preLN__sliding_block__dense_activation_relu__prompt_kernel_w4_eg4p2:
  s_barrier
  s_add_u32 s22, s21, 2
  s_and_b32 s22, s22, 15
  s_mul_i32 s22, s22, 262144
  s_add_u32 s24, s32, s22
  s_mov_b32 s23, 90112
  s_add_u32 m0, s23, s44
  s_nop 0
  buffer_load_dwordx4 v96, s[12:15], s24 offen offset:0 sc1 lds
  buffer_load_dwordx4 v96, s[12:15], s24 offen offset:1024 sc1 lds
  buffer_load_dwordx4 v96, s[12:15], s24 offen offset:2048 sc1 lds
  buffer_load_dwordx4 v96, s[12:15], s24 offen offset:3072 sc1 lds
  s_cmp_eq_u32 s3, 4
  s_cbranch_scc0 L_sequential_preLN__sliding_block__dense_activation_relu__prompt_kernel_w4_eg4p3
  s_add_u32 s22, s21, 3
  s_and_b32 s22, s22, 15
  s_lshl_b32 s36, 1, s22
  s_and_b32 s37, s43, s36
  s_cmp_eq_u32 s37, s36
  s_cbranch_scc1 L_sequential_preLN__sliding_block__dense_activation_relu__prompt_kernel_w4_eg4p3
  s_mov_b32 s31, 40000
L_sequential_preLN__sliding_block__dense_activation_relu__prompt_kernel_en_g4p3:
  buffer_load_dword v110, v109, s[12:15], 0 offen sc1
  s_waitcnt vmcnt(0)
  v_readfirstlane_b32 s43, v110
  s_nop 3
  s_and_b32 s37, s43, s36
  s_cmp_eq_u32 s37, s36
  s_cbranch_scc1 L_sequential_preLN__sliding_block__dense_activation_relu__prompt_kernel_w4_eg4p3
  s_sub_u32 s31, s31, 1
  s_cmp_eq_u32 s31, 0
  s_cbranch_scc1 L_sequential_preLN__sliding_block__dense_activation_relu__prompt_kernel_w4_eg4p3
  s_nop 0
  s_branch L_sequential_preLN__sliding_block__dense_activation_relu__prompt_kernel_en_g4p3
L_sequential_preLN__sliding_block__dense_activation_relu__prompt_kernel_w4_eg4p3:
  s_waitcnt vmcnt(4)
  s_barrier
  s_cmp_eq_u32 s3, 4
  s_cbranch_scc0 L_sequential_preLN__sliding_block__dense_activation_relu__prompt_kernel_w4_g4r0
  buffer_load_dword v111, v109, s[12:15], 0 offen sc1
L_sequential_preLN__sliding_block__dense_activation_relu__prompt_kernel_w4_g4r0:
  s_add_u32 s22, s21, 3
  s_and_b32 s22, s22, 15
  s_mul_i32 s22, s22, 262144
  s_add_u32 s24, s32, s22
  s_mov_b32 s23, 0
  s_add_u32 m0, s23, s44
  s_nop 0
  buffer_load_dwordx4 v96, s[12:15], s24 offen offset:0 sc1 lds
  buffer_load_dwordx4 v96, s[12:15], s24 offen offset:1024 sc1 lds
  buffer_load_dwordx4 v96, s[12:15], s24 offen offset:2048 sc1 lds
  buffer_load_dwordx4 v96, s[12:15], s24 offen offset:3072 sc1 lds
  s_add_u32 s22, s21, 3
  s_and_b32 s22, s22, 15
  s_mul_i32 s22, s22, 458752
  s_add_u32 s25, s33, s22
  s_mov_b32 s23, 0
  s_add_u32 m0, s23, s45
  s_mov_b32 s30, s25
  buffer_load_dwordx4 v98, s[48:51], s30 offen lds
  s_add_u32 m0, m0, 1024
  s_nop 0
  buffer_load_dwordx4 v99, s[48:51], s30 offen lds
  s_add_u32 m0, m0, 1024
  s_nop 0
  buffer_load_dwordx4 v100, s[48:51], s30 offen lds
  s_add_u32 m0, m0, 1024
  s_nop 0
  buffer_load_dwordx4 v101, s[48:51], s30 offen lds
  s_add_u32 m0, m0, 1024
  s_nop 0
  buffer_load_dwordx4 v102, s[48:51], s30 offen lds
  s_add_u32 m0, m0, 1024
  s_nop 0
  buffer_load_dwordx4 v103, s[48:51], s30 offen lds
  s_add_u32 m0, m0, 1024
  s_nop 0
  buffer_load_dwordx4 v104, s[48:51], s30 offen lds
  s_cmp_eq_u32 s3, 4
  s_cbranch_scc0 L_sequential_preLN__sliding_block__dense_activation_relu__prompt_kernel_w4_eg4p4
  s_add_u32 s22, s21, 4
  s_and_b32 s22, s22, 15
  s_lshl_b32 s36, 1, s22
  s_and_b32 s37, s43, s36
  s_cmp_eq_u32 s37, s36
  s_cbranch_scc1 L_sequential_preLN__sliding_block__dense_activation_relu__prompt_kernel_w4_eg4p4
  s_mov_b32 s31, 40000
L_sequential_preLN__sliding_block__dense_activation_relu__prompt_kernel_en_g4p4:
  buffer_load_dword v110, v109, s[12:15], 0 offen sc1
  s_waitcnt vmcnt(0)
  v_readfirstlane_b32 s43, v110
  s_nop 3
  s_and_b32 s37, s43, s36
  s_cmp_eq_u32 s37, s36
  s_cbranch_scc1 L_sequential_preLN__sliding_block__dense_activation_relu__prompt_kernel_w4_eg4p4
  s_sub_u32 s31, s31, 1
  s_cmp_eq_u32 s31, 0
  s_cbranch_scc1 L_sequential_preLN__sliding_block__dense_activation_relu__prompt_kernel_w4_eg4p4
  s_nop 0
  s_branch L_sequential_preLN__sliding_block__dense_activation_relu__prompt_kernel_en_g4p4
L_sequential_preLN__sliding_block__dense_activation_relu__prompt_kernel_w4_eg4p4:
  s_waitcnt vmcnt(11)
  s_barrier
  s_cmp_eq_u32 s3, 4
  s_cbranch_scc0 L_sequential_preLN__sliding_block__dense_activation_relu__prompt_kernel_w4_g4r1
  buffer_load_dword v112, v109, s[12:15], 0 offen sc1
L_sequential_preLN__sliding_block__dense_activation_relu__prompt_kernel_w4_g4r1:
  s_add_u32 s22, s21, 4
  s_and_b32 s22, s22, 15
  s_mul_i32 s22, s22, 262144
  s_add_u32 s24, s32, s22
  s_mov_b32 s23, 45056
  s_add_u32 m0, s23, s44
  s_nop 0
  buffer_load_dwordx4 v96, s[12:15], s24 offen offset:0 sc1 lds
  buffer_load_dwordx4 v96, s[12:15], s24 offen offset:1024 sc1 lds
  buffer_load_dwordx4 v96, s[12:15], s24 offen offset:2048 sc1 lds
  buffer_load_dwordx4 v96, s[12:15], s24 offen offset:3072 sc1 lds
  s_add_u32 s22, s21, 4
  s_and_b32 s22, s22, 15
  s_mul_i32 s22, s22, 458752
  s_add_u32 s25, s33, s22
  s_mov_b32 s23, 45056
  s_add_u32 m0, s23, s45
  s_mov_b32 s30, s25
  buffer_load_dwordx4 v98, s[48:51], s30 offen lds
  s_add_u32 m0, m0, 1024
  s_nop 0
  buffer_load_dwordx4 v99, s[48:51], s30 offen lds
  s_add_u32 m0, m0, 1024
  s_nop 0
  buffer_load_dwordx4 v100, s[48:51], s30 offen lds
  s_add_u32 m0, m0, 1024
  s_nop 0
  buffer_load_dwordx4 v101, s[48:51], s30 offen lds
  s_add_u32 m0, m0, 1024
  s_nop 0
  buffer_load_dwordx4 v102, s[48:51], s30 offen lds
  s_add_u32 m0, m0, 1024
  s_nop 0
  buffer_load_dwordx4 v103, s[48:51], s30 offen lds
  s_add_u32 m0, m0, 1024
  s_nop 0
  buffer_load_dwordx4 v104, s[48:51], s30 offen lds
  s_cmp_eq_u32 s3, 4
  s_cbranch_scc0 L_sequential_preLN__sliding_block__dense_activation_relu__prompt_kernel_w4_eg4p5
  s_add_u32 s22, s21, 5
  s_and_b32 s22, s22, 15
  s_lshl_b32 s36, 1, s22
  s_and_b32 s37, s43, s36
  s_cmp_eq_u32 s37, s36
  s_cbranch_scc1 L_sequential_preLN__sliding_block__dense_activation_relu__prompt_kernel_w4_eg4p5
  s_mov_b32 s31, 40000
L_sequential_preLN__sliding_block__dense_activation_relu__prompt_kernel_en_g4p5:
  buffer_load_dword v110, v109, s[12:15], 0 offen sc1
  s_waitcnt vmcnt(0)
  v_readfirstlane_b32 s43, v110
  s_nop 3
  s_and_b32 s37, s43, s36
  s_cmp_eq_u32 s37, s36
  s_cbranch_scc1 L_sequential_preLN__sliding_block__dense_activation_relu__prompt_kernel_w4_eg4p5
  s_sub_u32 s31, s31, 1
  s_cmp_eq_u32 s31, 0
  s_cbranch_scc1 L_sequential_preLN__sliding_block__dense_activation_relu__prompt_kernel_w4_eg4p5
  s_nop 0
  s_branch L_sequential_preLN__sliding_block__dense_activation_relu__prompt_kernel_en_g4p5
L_sequential_preLN__sliding_block__dense_activation_relu__prompt_kernel_w4_eg4p5:
  s_waitcnt vmcnt(11)
  s_barrier
  s_cmp_eq_u32 s3, 4
  s_cbranch_scc0 L_sequential_preLN__sliding_block__dense_activation_relu__prompt_kernel_w4_g4r2
  buffer_load_dword v116, v109, s[12:15], 0 offen sc1
L_sequential_preLN__sliding_block__dense_activation_relu__prompt_kernel_w4_g4r2:
  s_add_u32 s22, s21, 5
  s_and_b32 s22, s22, 15
  s_mul_i32 s22, s22, 262144
  s_add_u32 s24, s32, s22
  s_mov_b32 s23, 90112
  s_add_u32 m0, s23, s44
  s_nop 0
  buffer_load_dwordx4 v96, s[12:15], s24 offen offset:0 sc1 lds
  buffer_load_dwordx4 v96, s[12:15], s24 offen offset:1024 sc1 lds
  buffer_load_dwordx4 v96, s[12:15], s24 offen offset:2048 sc1 lds
  buffer_load_dwordx4 v96, s[12:15], s24 offen offset:3072 sc1 lds
  s_add_u32 s22, s21, 5
  s_and_b32 s22, s22, 15
  s_mul_i32 s22, s22, 458752
  s_add_u32 s25, s33, s22
  s_mov_b32 s23, 90112
  s_add_u32 m0, s23, s45
  s_mov_b32 s30, s25
  buffer_load_dwordx4 v98, s[48:51], s30 offen lds
  s_add_u32 m0, m0, 1024
  s_nop 0
  buffer_load_dwordx4 v99, s[48:51], s30 offen lds
  s_add_u32 m0, m0, 1024
  s_nop 0
  buffer_load_dwordx4 v100, s[48:51], s30 offen lds
  s_add_u32 m0, m0, 1024
  s_nop 0
  buffer_load_dwordx4 v101, s[48:51], s30 offen lds
  s_add_u32 m0, m0, 1024
  s_nop 0
  buffer_load_dwordx4 v102, s[48:51], s30 offen lds
  s_add_u32 m0, m0, 1024
  s_nop 0
  buffer_load_dwordx4 v103, s[48:51], s30 offen lds
  s_add_u32 m0, m0, 1024
  s_nop 0
  buffer_load_dwordx4 v104, s[48:51], s30 offen lds
  s_cmp_eq_u32 s3, 4
  s_cbranch_scc0 L_sequential_preLN__sliding_block__dense_activation_relu__prompt_kernel_w4_g4m3
  v_readfirstlane_b32 s37, v111
  s_nop 3
  s_or_b32 s43, s43, s37
L_sequential_preLN__sliding_block__dense_activation_relu__prompt_kernel_w4_g4m3:
  s_cmp_eq_u32 s3, 4
  s_cbranch_scc0 L_sequential_preLN__sliding_block__dense_activation_relu__prompt_kernel_w4_eg4p6
  s_add_u32 s22, s21, 6
  s_and_b32 s22, s22, 15
  s_lshl_b32 s36, 1, s22
  s_and_b32 s37, s43, s36
  s_cmp_eq_u32 s37, s36
  s_cbranch_scc1 L_sequential_preLN__sliding_block__dense_activation_relu__prompt_kernel_w4_eg4p6
  s_mov_b32 s31, 40000
L_sequential_preLN__sliding_block__dense_activation_relu__prompt_kernel_en_g4p6:
  buffer_load_dword v110, v109, s[12:15], 0 offen sc1
  s_waitcnt vmcnt(0)
  v_readfirstlane_b32 s43, v110
  s_nop 3
  s_and_b32 s37, s43, s36
  s_cmp_eq_u32 s37, s36
  s_cbranch_scc1 L_sequential_preLN__sliding_block__dense_activation_relu__prompt_kernel_w4_eg4p6
  s_sub_u32 s31, s31, 1
  s_cmp_eq_u32 s31, 0
  s_cbranch_scc1 L_sequential_preLN__sliding_block__dense_activation_relu__prompt_kernel_w4_eg4p6
  s_nop 0
  s_branch L_sequential_preLN__sliding_block__dense_activation_relu__prompt_kernel_en_g4p6
L_sequential_preLN__sliding_block__dense_activation_relu__prompt_kernel_w4_eg4p6:
  s_waitcnt vmcnt(11)
  s_barrier
  s_cmp_eq_u32 s3, 4
  s_cbranch_scc0 L_sequential_preLN__sliding_block__dense_activation_relu__prompt_kernel_w4_g4r3
  buffer_load_dword v111, v109, s[12:15], 0 offen sc1
L_sequential_preLN__sliding_block__dense_activation_relu__prompt_kernel_w4_g4r3:
  s_add_u32 s22, s21, 6
  s_and_b32 s22, s22, 15
  s_mul_i32 s22, s22, 262144
  s_add_u32 s24, s32, s22
  s_mov_b32 s23, 0
  s_add_u32 m0, s23, s44
  s_nop 0
  buffer_load_dwordx4 v96, s[12:15], s24 offen offset:0 sc1 lds
  buffer_load_dwordx4 v96, s[12:15], s24 offen offset:1024 sc1 lds
  buffer_load_dwordx4 v96, s[12:15], s24 offen offset:2048 sc1 lds
  buffer_load_dwordx4 v96, s[12:15], s24 offen offset:3072 sc1 lds
  s_add_u32 s22, s21, 6
  s_and_b32 s22, s22, 15
  s_mul_i32 s22, s22, 458752
  s_add_u32 s25, s33, s22
  s_mov_b32 s23, 0
  s_add_u32 m0, s23, s45
  s_mov_b32 s30, s25
  buffer_load_dwordx4 v98, s[48:51], s30 offen lds
  s_add_u32 m0, m0, 1024
  s_nop 0
  buffer_load_dwordx4 v99, s[48:51], s30 offen lds
  s_add_u32 m0, m0, 1024
  s_nop 0
  buffer_load_dwordx4 v100, s[48:51], s30 offen lds
  s_add_u32 m0, m0, 1024
  s_nop 0
  buffer_load_dwordx4 v101, s[48:51], s30 offen lds
  s_add_u32 m0, m0, 1024
  s_nop 0
  buffer_load_dwordx4 v102, s[48:51], s30 offen lds
  s_add_u32 m0, m0, 1024
  s_nop 0
  buffer_load_dwordx4 v103, s[48:51], s30 offen lds
  s_add_u32 m0, m0, 1024
  s_nop 0
  buffer_load_dwordx4 v104, s[48:51], s30 offen lds
  s_cmp_eq_u32 s3, 4
  s_cbranch_scc0 L_sequential_preLN__sliding_block__dense_activation_relu__prompt_kernel_w4_g4m4
  v_readfirstlane_b32 s37, v112
  s_nop 3
  s_or_b32 s43, s43, s37
L_sequential_preLN__sliding_block__dense_activation_relu__prompt_kernel_w4_g4m4:
  s_cmp_eq_u32 s3, 4
  s_cbranch_scc0 L_sequential_preLN__sliding_block__dense_activation_relu__prompt_kernel_w4_eg4p7
  s_add_u32 s22, s21, 7
  s_and_b32 s22, s22, 15
  s_lshl_b32 s36, 1, s22
  s_and_b32 s37, s43, s36
  s_cmp_eq_u32 s37, s36
  s_cbranch_scc1 L_sequential_preLN__sliding_block__dense_activation_relu__prompt_kernel_w4_eg4p7
  s_mov_b32 s31, 40000
L_sequential_preLN__sliding_block__dense_activation_relu__prompt_kernel_en_g4p7:
  buffer_load_dword v110, v109, s[12:15], 0 offen sc1
  s_waitcnt vmcnt(0)
  v_readfirstlane_b32 s43, v110
  s_nop 3
  s_and_b32 s37, s43, s36
  s_cmp_eq_u32 s37, s36
  s_cbranch_scc1 L_sequential_preLN__sliding_block__dense_activation_relu__prompt_kernel_w4_eg4p7
  s_sub_u32 s31, s31, 1
  s_cmp_eq_u32 s31, 0
  s_cbranch_scc1 L_sequential_preLN__sliding_block__dense_activation_relu__prompt_kernel_w4_eg4p7
  s_nop 0
  s_branch L_sequential_preLN__sliding_block__dense_activation_relu__prompt_kernel_en_g4p7
L_sequential_preLN__sliding_block__dense_activation_relu__prompt_kernel_w4_eg4p7:
  s_waitcnt vmcnt(11)
  s_barrier
  s_cmp_eq_u32 s3, 4
  s_cbranch_scc0 L_sequential_preLN__sliding_block__dense_activation_relu__prompt_kernel_w4_g4r4
  buffer_load_dword v112, v109, s[12:15], 0 offen sc1
L_sequential_preLN__sliding_block__dense_activation_relu__prompt_kernel_w4_g4r4:
  s_add_u32 s22, s21, 7
  s_and_b32 s22, s22, 15
  s_mul_i32 s22, s22, 262144
  s_add_u32 s24, s32, s22
  s_mov_b32 s23, 45056
  s_add_u32 m0, s23, s44
  s_nop 0
  buffer_load_dwordx4 v96, s[12:15], s24 offen offset:0 sc1 lds
  buffer_load_dwordx4 v96, s[12:15], s24 offen offset:1024 sc1 lds
  buffer_load_dwordx4 v96, s[12:15], s24 offen offset:2048 sc1 lds
  buffer_load_dwordx4 v96, s[12:15], s24 offen offset:3072 sc1 lds
  s_add_u32 s22, s21, 7
  s_and_b32 s22, s22, 15
  s_mul_i32 s22, s22, 458752
  s_add_u32 s25, s33, s22
  s_mov_b32 s23, 45056
  s_add_u32 m0, s23, s45
  s_mov_b32 s30, s25
  buffer_load_dwordx4 v98, s[48:51], s30 offen lds
  s_add_u32 m0, m0, 1024
  s_nop 0
  buffer_load_dwordx4 v99, s[48:51], s30 offen lds
  s_add_u32 m0, m0, 1024
  s_nop 0
  buffer_load_dwordx4 v100, s[48:51], s30 offen lds
  s_add_u32 m0, m0, 1024
  s_nop 0
  buffer_load_dwordx4 v101, s[48:51], s30 offen lds
  s_add_u32 m0, m0, 1024
  s_nop 0
  buffer_load_dwordx4 v102, s[48:51], s30 offen lds
  s_add_u32 m0, m0, 1024
  s_nop 0
  buffer_load_dwordx4 v103, s[48:51], s30 offen lds
  s_add_u32 m0, m0, 1024
  s_nop 0
  buffer_load_dwordx4 v104, s[48:51], s30 offen lds
  s_cmp_eq_u32 s3, 4
  s_cbranch_scc0 L_sequential_preLN__sliding_block__dense_activation_relu__prompt_kernel_w4_g4m5
  v_readfirstlane_b32 s37, v116
  s_nop 3
  s_or_b32 s43, s43, s37
L_sequential_preLN__sliding_block__dense_activation_relu__prompt_kernel_w4_g4m5:
  s_cmp_eq_u32 s3, 4
  s_cbranch_scc0 L_sequential_preLN__sliding_block__dense_activation_relu__prompt_kernel_w4_eg4p8
  s_add_u32 s22, s21, 8
  s_and_b32 s22, s22, 15
  s_lshl_b32 s36, 1, s22
  s_and_b32 s37, s43, s36
  s_cmp_eq_u32 s37, s36
  s_cbranch_scc1 L_sequential_preLN__sliding_block__dense_activation_relu__prompt_kernel_w4_eg4p8
  s_mov_b32 s31, 40000
L_sequential_preLN__sliding_block__dense_activation_relu__prompt_kernel_en_g4p8:
  buffer_load_dword v110, v109, s[12:15], 0 offen sc1
  s_waitcnt vmcnt(0)
  v_readfirstlane_b32 s43, v110
  s_nop 3
  s_and_b32 s37, s43, s36
  s_cmp_eq_u32 s37, s36
  s_cbranch_scc1 L_sequential_preLN__sliding_block__dense_activation_relu__prompt_kernel_w4_eg4p8
  s_sub_u32 s31, s31, 1
  s_cmp_eq_u32 s31, 0
  s_cbranch_scc1 L_sequential_preLN__sliding_block__dense_activation_relu__prompt_kernel_w4_eg4p8
  s_nop 0
  s_branch L_sequential_preLN__sliding_block__dense_activation_relu__prompt_kernel_en_g4p8
L_sequential_preLN__sliding_block__dense_activation_relu__prompt_kernel_w4_eg4p8:
  s_waitcnt vmcnt(11)
  s_barrier
  s_cmp_eq_u32 s3, 4
  s_cbranch_scc0 L_sequential_preLN__sliding_block__dense_activation_relu__prompt_kernel_w4_g4r5
  buffer_load_dword v116, v109, s[12:15], 0 offen sc1
L_sequential_preLN__sliding_block__dense_activation_relu__prompt_kernel_w4_g4r5:
  s_add_u32 s22, s21, 8
  s_and_b32 s22, s22, 15
  s_mul_i32 s22, s22, 262144
  s_add_u32 s24, s32, s22
  s_mov_b32 s23, 90112
  s_add_u32 m0, s23, s44
  s_nop 0
  buffer_load_dwordx4 v96, s[12:15], s24 offen offset:0 sc1 lds
  buffer_load_dwordx4 v96, s[12:15], s24 offen offset:1024 sc1 lds
  buffer_load_dwordx4 v96, s[12:15], s24 offen offset:2048 sc1 lds
  buffer_load_dwordx4 v96, s[12:15], s24 offen offset:3072 sc1 lds
  s_add_u32 s22, s21, 8
  s_and_b32 s22, s22, 15
  s_mul_i32 s22, s22, 458752
  s_add_u32 s25, s33, s22
  s_mov_b32 s23, 90112
  s_add_u32 m0, s23, s45
  s_mov_b32 s30, s25
  buffer_load_dwordx4 v98, s[48:51], s30 offen lds
  s_add_u32 m0, m0, 1024
  s_nop 0
  buffer_load_dwordx4 v99, s[48:51], s30 offen lds
  s_add_u32 m0, m0, 1024
  s_nop 0
  buffer_load_dwordx4 v100, s[48:51], s30 offen lds
  s_add_u32 m0, m0, 1024
  s_nop 0
  buffer_load_dwordx4 v101, s[48:51], s30 offen lds
  s_add_u32 m0, m0, 1024
  s_nop 0
  buffer_load_dwordx4 v102, s[48:51], s30 offen lds
  s_add_u32 m0, m0, 1024
  s_nop 0
  buffer_load_dwordx4 v103, s[48:51], s30 offen lds
  s_add_u32 m0, m0, 1024
  s_nop 0
  buffer_load_dwordx4 v104, s[48:51], s30 offen lds
  s_cmp_eq_u32 s3, 4
  s_cbranch_scc0 L_sequential_preLN__sliding_block__dense_activation_relu__prompt_kernel_w4_csl
  s_lshl_b32 s29, s21, 7
  s_add_u32 s29, s29, 3219456
  v_mov_b32 v113, s29
  v_mov_b32 v114, 16
  buffer_load_dword v115, v113, s[12:15], 0 offen sc1
L_sequential_preLN__sliding_block__dense_activation_relu__prompt_kernel_w4_csl:
  s_cmp_eq_u32 s3, 4
  s_cbranch_scc0 L_sequential_preLN__sliding_block__dense_activation_relu__prompt_kernel_w4_g4m6
  v_readfirstlane_b32 s37, v111
  s_nop 3
  s_or_b32 s43, s43, s37
L_sequential_preLN__sliding_block__dense_activation_relu__prompt_kernel_w4_g4m6:
  s_cmp_eq_u32 s3, 4
  s_cbranch_scc0 L_sequential_preLN__sliding_block__dense_activation_relu__prompt_kernel_w4_eg4p9
  s_add_u32 s22, s21, 9
  s_and_b32 s22, s22, 15
  s_lshl_b32 s36, 1, s22
  s_and_b32 s37, s43, s36
  s_cmp_eq_u32 s37, s36
  s_cbranch_scc1 L_sequential_preLN__sliding_block__dense_activation_relu__prompt_kernel_w4_eg4p9
  s_mov_b32 s31, 40000
L_sequential_preLN__sliding_block__dense_activation_relu__prompt_kernel_en_g4p9:
  buffer_load_dword v110, v109, s[12:15], 0 offen sc1
  s_waitcnt vmcnt(0)
  v_readfirstlane_b32 s43, v110
  s_nop 3
  s_and_b32 s37, s43, s36
  s_cmp_eq_u32 s37, s36
  s_cbranch_scc1 L_sequential_preLN__sliding_block__dense_activation_relu__prompt_kernel_w4_eg4p9
  s_sub_u32 s31, s31, 1
  s_cmp_eq_u32 s31, 0
  s_cbranch_scc1 L_sequential_preLN__sliding_block__dense_activation_relu__prompt_kernel_w4_eg4p9
  s_nop 0
  s_branch L_sequential_preLN__sliding_block__dense_activation_relu__prompt_kernel_en_g4p9
L_sequential_preLN__sliding_block__dense_activation_relu__prompt_kernel_w4_eg4p9:
  s_waitcnt vmcnt(11)
  s_barrier
  s_cmp_eq_u32 s3, 4
  s_cbranch_scc0 L_sequential_preLN__sliding_block__dense_activation_relu__prompt_kernel_w4_g4r6
  buffer_load_dword v111, v109, s[12:15], 0 offen sc1
L_sequential_preLN__sliding_block__dense_activation_relu__prompt_kernel_w4_g4r6:
  s_add_u32 s22, s21, 9
  s_and_b32 s22, s22, 15
  s_mul_i32 s22, s22, 262144
  s_add_u32 s24, s32, s22
  s_mov_b32 s23, 0
  s_add_u32 m0, s23, s44
  s_nop 0
  buffer_load_dwordx4 v96, s[12:15], s24 offen offset:0 sc1 lds
  buffer_load_dwordx4 v96, s[12:15], s24 offen offset:1024 sc1 lds
  buffer_load_dwordx4 v96, s[12:15], s24 offen offset:2048 sc1 lds
  buffer_load_dwordx4 v96, s[12:15], s24 offen offset:3072 sc1 lds
  s_add_u32 s22, s21, 9
  s_and_b32 s22, s22, 15
  s_mul_i32 s22, s22, 458752
  s_add_u32 s25, s33, s22
  s_mov_b32 s23, 0
  s_add_u32 m0, s23, s45
  s_mov_b32 s30, s25
  buffer_load_dwordx4 v98, s[48:51], s30 offen lds
  s_add_u32 m0, m0, 1024
  s_nop 0
  buffer_load_dwordx4 v99, s[48:51], s30 offen lds
  s_add_u32 m0, m0, 1024
  s_nop 0
  buffer_load_dwordx4 v100, s[48:51], s30 offen lds
  s_add_u32 m0, m0, 1024
  s_nop 0
  buffer_load_dwordx4 v101, s[48:51], s30 offen lds
  s_add_u32 m0, m0, 1024
  s_nop 0
  buffer_load_dwordx4 v102, s[48:51], s30 offen lds
  s_add_u32 m0, m0, 1024
  s_nop 0
  buffer_load_dwordx4 v103, s[48:51], s30 offen lds
  s_add_u32 m0, m0, 1024
  s_nop 0
  buffer_load_dwordx4 v104, s[48:51], s30 offen lds
  s_cmp_eq_u32 s3, 4
  s_cbranch_scc0 L_sequential_preLN__sliding_block__dense_activation_relu__prompt_kernel_w4_g4m7
  v_readfirstlane_b32 s37, v112
  s_nop 3
  s_or_b32 s43, s43, s37
L_sequential_preLN__sliding_block__dense_activation_relu__prompt_kernel_w4_g4m7:
  s_cmp_eq_u32 s3, 4
  s_cbranch_scc0 L_sequential_preLN__sliding_block__dense_activation_relu__prompt_kernel_w4_eg4p10
  s_add_u32 s22, s21, 10
  s_and_b32 s22, s22, 15
  s_lshl_b32 s36, 1, s22
  s_and_b32 s37, s43, s36
  s_cmp_eq_u32 s37, s36
  s_cbranch_scc1 L_sequential_preLN__sliding_block__dense_activation_relu__prompt_kernel_w4_eg4p10
  s_mov_b32 s31, 40000
L_sequential_preLN__sliding_block__dense_activation_relu__prompt_kernel_en_g4p10:
  buffer_load_dword v110, v109, s[12:15], 0 offen sc1
  s_waitcnt vmcnt(0)
  v_readfirstlane_b32 s43, v110
  s_nop 3
  s_and_b32 s37, s43, s36
  s_cmp_eq_u32 s37, s36
  s_cbranch_scc1 L_sequential_preLN__sliding_block__dense_activation_relu__prompt_kernel_w4_eg4p10
  s_sub_u32 s31, s31, 1
  s_cmp_eq_u32 s31, 0
  s_cbranch_scc1 L_sequential_preLN__sliding_block__dense_activation_relu__prompt_kernel_w4_eg4p10
  s_nop 0
  s_branch L_sequential_preLN__sliding_block__dense_activation_relu__prompt_kernel_en_g4p10
L_sequential_preLN__sliding_block__dense_activation_relu__prompt_kernel_w4_eg4p10:
  s_waitcnt vmcnt(11)
  s_barrier
  s_cmp_eq_u32 s3, 4
  s_cbranch_scc0 L_sequential_preLN__sliding_block__dense_activation_relu__prompt_kernel_w4_g4r7
  buffer_load_dword v112, v109, s[12:15], 0 offen sc1
L_sequential_preLN__sliding_block__dense_activation_relu__prompt_kernel_w4_g4r7:
  s_add_u32 s22, s21, 10
  s_and_b32 s22, s22, 15
  s_mul_i32 s22, s22, 262144
  s_add_u32 s24, s32, s22
  s_mov_b32 s23, 45056
  s_add_u32 m0, s23, s44
  s_nop 0
  buffer_load_dwordx4 v96, s[12:15], s24 offen offset:0 sc1 lds
  buffer_load_dwordx4 v96, s[12:15], s24 offen offset:1024 sc1 lds
  buffer_load_dwordx4 v96, s[12:15], s24 offen offset:2048 sc1 lds
  buffer_load_dwordx4 v96, s[12:15], s24 offen offset:3072 sc1 lds
  s_add_u32 s22, s21, 10
  s_and_b32 s22, s22, 15
  s_mul_i32 s22, s22, 458752
  s_add_u32 s25, s33, s22
  s_mov_b32 s23, 45056
  s_add_u32 m0, s23, s45
  s_mov_b32 s30, s25
  buffer_load_dwordx4 v98, s[48:51], s30 offen lds
  s_add_u32 m0, m0, 1024
  s_nop 0
  buffer_load_dwordx4 v99, s[48:51], s30 offen lds
  s_add_u32 m0, m0, 1024
  s_nop 0
  buffer_load_dwordx4 v100, s[48:51], s30 offen lds
  s_add_u32 m0, m0, 1024
  s_nop 0
  buffer_load_dwordx4 v101, s[48:51], s30 offen lds
  s_add_u32 m0, m0, 1024
  s_nop 0
  buffer_load_dwordx4 v102, s[48:51], s30 offen lds
  s_add_u32 m0, m0, 1024
  s_nop 0
  buffer_load_dwordx4 v103, s[48:51], s30 offen lds
  s_add_u32 m0, m0, 1024
  s_nop 0
  buffer_load_dwordx4 v104, s[48:51], s30 offen lds
  s_cmp_eq_u32 s3, 4
  s_cbranch_scc0 L_sequential_preLN__sliding_block__dense_activation_relu__prompt_kernel_w4_g4m8
  v_readfirstlane_b32 s37, v116
  s_nop 3
  s_or_b32 s43, s43, s37
L_sequential_preLN__sliding_block__dense_activation_relu__prompt_kernel_w4_g4m8:
  s_cmp_eq_u32 s3, 4
  s_cbranch_scc0 L_sequential_preLN__sliding_block__dense_activation_relu__prompt_kernel_w4_eg4p11
  s_add_u32 s22, s21, 11
  s_and_b32 s22, s22, 15
  s_lshl_b32 s36, 1, s22
  s_and_b32 s37, s43, s36
  s_cmp_eq_u32 s37, s36
  s_cbranch_scc1 L_sequential_preLN__sliding_block__dense_activation_relu__prompt_kernel_w4_eg4p11
  s_mov_b32 s31, 40000
L_sequential_preLN__sliding_block__dense_activation_relu__prompt_kernel_en_g4p11:
  buffer_load_dword v110, v109, s[12:15], 0 offen sc1
  s_waitcnt vmcnt(0)
  v_readfirstlane_b32 s43, v110
  s_nop 3
  s_and_b32 s37, s43, s36
  s_cmp_eq_u32 s37, s36
  s_cbranch_scc1 L_sequential_preLN__sliding_block__dense_activation_relu__prompt_kernel_w4_eg4p11
  s_sub_u32 s31, s31, 1
  s_cmp_eq_u32 s31, 0
  s_cbranch_scc1 L_sequential_preLN__sliding_block__dense_activation_relu__prompt_kernel_w4_eg4p11
  s_nop 0
  s_branch L_sequential_preLN__sliding_block__dense_activation_relu__prompt_kernel_en_g4p11
L_sequential_preLN__sliding_block__dense_activation_relu__prompt_kernel_w4_eg4p11:
  s_waitcnt vmcnt(11)
  s_cmp_eq_u32 s3, 4
  s_cbranch_scc0 L_sequential_preLN__sliding_block__dense_activation_relu__prompt_kernel_w4_csc
  v_cmp_ge_u32 vcc, v115, v114
  s_nop 1
  s_cmp_eq_u64 vcc, exec
  s_cbranch_scc1 L_sequential_preLN__sliding_block__dense_activation_relu__prompt_kernel_w4_csc
  s_mov_b32 s31, 40000
L_sequential_preLN__sliding_block__dense_activation_relu__prompt_kernel_poll_cs1:
  buffer_load_dword v115, v113, s[12:15], 0 offen sc1
  s_waitcnt vmcnt(0)
  v_cmp_ge_u32 vcc, v115, v114
  s_nop 1
  s_cmp_eq_u64 vcc, exec
  s_cbranch_scc1 L_sequential_preLN__sliding_block__dense_activation_relu__prompt_kernel_pdone_cs1
  s_sub_u32 s31, s31, 1
  s_cmp_eq_u32 s31, 0
  s_cbranch_scc1 L_sequential_preLN__sliding_block__dense_activation_relu__prompt_kernel_pdone_cs1
  s_nop 0
  s_branch L_sequential_preLN__sliding_block__dense_activation_relu__prompt_kernel_poll_cs1
L_sequential_preLN__sliding_block__dense_activation_relu__prompt_kernel_pdone_cs1:
L_sequential_preLN__sliding_block__dense_activation_relu__prompt_kernel_w4_csc:
  s_cmp_eq_u32 s3, 4
  s_cbranch_scc0 L_sequential_preLN__sliding_block__dense_activation_relu__prompt_kernel_w4_eg4all
  s_mov_b32 s36, 0xffff
  s_and_b32 s37, s43, s36
  s_cmp_eq_u32 s37, s36
  s_cbranch_scc1 L_sequential_preLN__sliding_block__dense_activation_relu__prompt_kernel_w4_eg4all
  s_mov_b32 s31, 40000
L_sequential_preLN__sliding_block__dense_activation_relu__prompt_kernel_en_g4all:
  buffer_load_dword v110, v109, s[12:15], 0 offen sc1
  s_waitcnt vmcnt(0)
  v_readfirstlane_b32 s43, v110
  s_nop 3
  s_and_b32 s37, s43, s36
  s_cmp_eq_u32 s37, s36
  s_cbranch_scc1 L_sequential_preLN__sliding_block__dense_activation_relu__prompt_kernel_w4_eg4all
  s_sub_u32 s31, s31, 1
  s_cmp_eq_u32 s31, 0
  s_cbranch_scc1 L_sequential_preLN__sliding_block__dense_activation_relu__prompt_kernel_w4_eg4all
  s_nop 0
  s_branch L_sequential_preLN__sliding_block__dense_activation_relu__prompt_kernel_en_g4all
L_sequential_preLN__sliding_block__dense_activation_relu__prompt_kernel_w4_eg4all:
  s_barrier
  s_cmp_eq_u32 s3, 4
  s_cbranch_scc0 L_sequential_preLN__sliding_block__dense_activation_relu__prompt_kernel_w4_g4r8
  buffer_load_dword v116, v109, s[12:15], 0 offen sc1
L_sequential_preLN__sliding_block__dense_activation_relu__prompt_kernel_w4_g4r8:
  s_add_u32 s22, s21, 11
  s_and_b32 s22, s22, 15
  s_mul_i32 s22, s22, 262144
  s_add_u32 s24, s32, s22
  s_mov_b32 s23, 90112
  s_add_u32 m0, s23, s44
  s_nop 0
  buffer_load_dwordx4 v96, s[12:15], s24 offen offset:0 sc1 lds
  buffer_load_dwordx4 v96, s[12:15], s24 offen offset:1024 sc1 lds
  buffer_load_dwordx4 v96, s[12:15], s24 offen offset:2048 sc1 lds
  buffer_load_dwordx4 v96, s[12:15], s24 offen offset:3072 sc1 lds
  s_add_u32 s22, s21, 11
  s_and_b32 s22, s22, 15
  s_mul_i32 s22, s22, 458752
  s_add_u32 s25, s33, s22
  s_mov_b32 s23, 90112
  s_add_u32 m0, s23, s45
  s_mov_b32 s30, s25
  buffer_load_dwordx4 v98, s[48:51], s30 offen lds
  s_add_u32 m0, m0, 1024
  s_nop 0
  buffer_load_dwordx4 v99, s[48:51], s30 offen lds
  s_add_u32 m0, m0, 1024
  s_nop 0
  buffer_load_dwordx4 v100, s[48:51], s30 offen lds
  s_add_u32 m0, m0, 1024
  s_nop 0
  buffer_load_dwordx4 v101, s[48:51], s30 offen lds
  s_add_u32 m0, m0, 1024
  s_nop 0
  buffer_load_dwordx4 v102, s[48:51], s30 offen lds
  s_add_u32 m0, m0, 1024
  s_nop 0
  buffer_load_dwordx4 v103, s[48:51], s30 offen lds
  s_add_u32 m0, m0, 1024
  s_nop 0
  buffer_load_dwordx4 v104, s[48:51], s30 offen lds
  s_sub_u32 s26, s3, 4
  v_lshrrev_b32 v2, 5, v1
  v_lshlrev_b32 v2, 11, v2
  v_and_b32 v3, 31, v1
  v_lshl_add_u32 v18, v3, 4, v2
  s_lshl_b32 s30, s20, 15
  s_lshl_b32 s27, s26, 9
  s_add_u32 s30, s30, s27
  s_add_u32 s30, s30, 2097152
  buffer_load_dwordx4 v[20:23], v18, s[12:15], s30 offen sc1
  s_add_u32 s30, s30, 4096
  buffer_load_dwordx4 v[24:27], v18, s[12:15], s30 offen sc1
  s_add_u32 s30, s30, 4096
  buffer_load_dwordx4 v[28:31], v18, s[12:15], s30 offen sc1
  s_add_u32 s30, s30, 4096
  buffer_load_dwordx4 v[32:35], v18, s[12:15], s30 offen sc1
  s_add_u32 s30, s30, 4096
  buffer_load_dwordx4 v[36:39], v18, s[12:15], s30 offen sc1
  s_add_u32 s30, s30, 4096
  buffer_load_dwordx4 v[40:43], v18, s[12:15], s30 offen sc1
  s_add_u32 s30, s30, 4096
  buffer_load_dwordx4 v[44:47], v18, s[12:15], s30 offen sc1
  s_add_u32 s30, s30, 4096
  buffer_load_dwordx4 v[48:51], v18, s[12:15], s30 offen sc1
  s_add_u32 s30, s30, 4096
  v_lshrrev_b32 v2, 4, v1
  v_mul_u32_u24 v2, 14336, v2
  v_and_b32 v3, 15, v1
  v_lshl_add_u32 v17, v3, 4, v2
  s_mul_i32 s30, s21, 896
  s_sub_u32 s26, s3, 4
  s_mul_i32 s27, s26, 224
  s_add_u32 s30, s30, s27
  s_add_u32 s30, s30, 1376256
  buffer_load_dwordx4 v[60:63], v17, s[12:15], s30 offen sc1
  s_add_u32 s30, s30, 57344
  buffer_load_dwordx4 v[64:67], v17, s[12:15], s30 offen sc1
  s_add_u32 s30, s30, 57344
  buffer_load_dwordx4 v[68:71], v17, s[12:15], s30 offen sc1
  s_add_u32 s30, s30, 57344
  buffer_load_dwordx4 v[72:75], v17, s[12:15], s30 offen sc1
  s_add_u32 s30, s30, 57344
  s_cmp_eq_u32 s3, 4
  s_cbranch_scc0 L_sequential_preLN__sliding_block__dense_activation_relu__prompt_kernel_w4_g4m9
  v_readfirstlane_b32 s37, v111
  s_nop 3
  s_or_b32 s43, s43, s37
L_sequential_preLN__sliding_block__dense_activation_relu__prompt_kernel_w4_g4m9:
  s_cmp_eq_u32 s3, 4
  s_cbranch_scc0 L_sequential_preLN__sliding_block__dense_activation_relu__prompt_kernel_w4_eg4p12
  s_add_u32 s22, s21, 12
  s_and_b32 s22, s22, 15
  s_lshl_b32 s36, 1, s22
  s_and_b32 s37, s43, s36
  s_cmp_eq_u32 s37, s36
  s_cbranch_scc1 L_sequential_preLN__sliding_block__dense_activation_relu__prompt_kernel_w4_eg4p12
  s_mov_b32 s31, 40000
L_sequential_preLN__sliding_block__dense_activation_relu__prompt_kernel_en_g4p12:
  buffer_load_dword v110, v109, s[12:15], 0 offen sc1
  s_waitcnt vmcnt(0)
  v_readfirstlane_b32 s43, v110
  s_nop 3
  s_and_b32 s37, s43, s36
  s_cmp_eq_u32 s37, s36
  s_cbranch_scc1 L_sequential_preLN__sliding_block__dense_activation_relu__prompt_kernel_w4_eg4p12
  s_sub_u32 s31, s31, 1
  s_cmp_eq_u32 s31, 0
  s_cbranch_scc1 L_sequential_preLN__sliding_block__dense_activation_relu__prompt_kernel_w4_eg4p12
  s_nop 0
  s_branch L_sequential_preLN__sliding_block__dense_activation_relu__prompt_kernel_en_g4p12
L_sequential_preLN__sliding_block__dense_activation_relu__prompt_kernel_w4_eg4p12:
  s_waitcnt vmcnt(23)
  s_barrier
  s_cmp_eq_u32 s3, 4
  s_cbranch_scc0 L_sequential_preLN__sliding_block__dense_activation_relu__prompt_kernel_w4_g4r9
  buffer_load_dword v111, v109, s[12:15], 0 offen sc1
L_sequential_preLN__sliding_block__dense_activation_relu__prompt_kernel_w4_g4r9:
  s_add_u32 s22, s21, 12
  s_and_b32 s22, s22, 15
  s_mul_i32 s22, s22, 262144
  s_add_u32 s24, s32, s22
  s_mov_b32 s23, 0
  s_add_u32 m0, s23, s44
  s_nop 0
  buffer_load_dwordx4 v96, s[12:15], s24 offen offset:0 sc1 lds
  buffer_load_dwordx4 v96, s[12:15], s24 offen offset:1024 sc1 lds
  buffer_load_dwordx4 v96, s[12:15], s24 offen offset:2048 sc1 lds
  buffer_load_dwordx4 v96, s[12:15], s24 offen offset:3072 sc1 lds
  s_add_u32 s22, s21, 12
  s_and_b32 s22, s22, 15
  s_mul_i32 s22, s22, 458752
  s_add_u32 s25, s33, s22
  s_mov_b32 s23, 0
  s_add_u32 m0, s23, s45
  s_mov_b32 s30, s25
  buffer_load_dwordx4 v98, s[48:51], s30 offen lds
  s_add_u32 m0, m0, 1024
  s_nop 0
  buffer_load_dwordx4 v99, s[48:51], s30 offen lds
  s_add_u32 m0, m0, 1024
  s_nop 0
  buffer_load_dwordx4 v100, s[48:51], s30 offen lds
  s_add_u32 m0, m0, 1024
  s_nop 0
  buffer_load_dwordx4 v101, s[48:51], s30 offen lds
  s_add_u32 m0, m0, 1024
  s_nop 0
  buffer_load_dwordx4 v102, s[48:51], s30 offen lds
  s_add_u32 m0, m0, 1024
  s_nop 0
  buffer_load_dwordx4 v103, s[48:51], s30 offen lds
  s_add_u32 m0, m0, 1024
  s_nop 0
  buffer_load_dwordx4 v104, s[48:51], s30 offen lds
  s_cmp_eq_u32 s3, 4
  s_cbranch_scc0 L_sequential_preLN__sliding_block__dense_activation_relu__prompt_kernel_w4_g4m10
  v_readfirstlane_b32 s37, v112
  s_nop 3
  s_or_b32 s43, s43, s37
L_sequential_preLN__sliding_block__dense_activation_relu__prompt_kernel_w4_g4m10:
  s_cmp_eq_u32 s3, 4
  s_cbranch_scc0 L_sequential_preLN__sliding_block__dense_activation_relu__prompt_kernel_w4_eg4p13
  s_add_u32 s22, s21, 13
  s_and_b32 s22, s22, 15
  s_lshl_b32 s36, 1, s22
  s_and_b32 s37, s43, s36
  s_cmp_eq_u32 s37, s36
  s_cbranch_scc1 L_sequential_preLN__sliding_block__dense_activation_relu__prompt_kernel_w4_eg4p13
  s_mov_b32 s31, 40000
L_sequential_preLN__sliding_block__dense_activation_relu__prompt_kernel_en_g4p13:
  buffer_load_dword v110, v109, s[12:15], 0 offen sc1
  s_waitcnt vmcnt(0)
  v_readfirstlane_b32 s43, v110
  s_nop 3
  s_and_b32 s37, s43, s36
  s_cmp_eq_u32 s37, s36
  s_cbranch_scc1 L_sequential_preLN__sliding_block__dense_activation_relu__prompt_kernel_w4_eg4p13
  s_sub_u32 s31, s31, 1
  s_cmp_eq_u32 s31, 0
  s_cbranch_scc1 L_sequential_preLN__sliding_block__dense_activation_relu__prompt_kernel_w4_eg4p13
  s_nop 0
  s_branch L_sequential_preLN__sliding_block__dense_activation_relu__prompt_kernel_en_g4p13
L_sequential_preLN__sliding_block__dense_activation_relu__prompt_kernel_w4_eg4p13:
  s_waitcnt vmcnt(23)
  s_barrier
  s_waitcnt vmcnt(11)
  s_add_u32 s22, s21, 13
  s_and_b32 s22, s22, 15
  s_mul_i32 s22, s22, 262144
  s_add_u32 s24, s32, s22
  s_mov_b32 s23, 45056
  s_add_u32 m0, s23, s44
  s_nop 0
  buffer_load_dwordx4 v96, s[12:15], s24 offen offset:0 sc1 lds
  v_add_f32 v52, v20, v24
  v_add_f32 v53, v21, v25
  v_add_f32 v54, v22, v26
  buffer_load_dwordx4 v96, s[12:15], s24 offen offset:1024 sc1 lds
  v_add_f32 v55, v23, v27
  v_add_f32 v52, v52, v28
  v_add_f32 v53, v53, v29
  buffer_load_dwordx4 v96, s[12:15], s24 offen offset:2048 sc1 lds
  v_add_f32 v54, v54, v30
  v_add_f32 v55, v55, v31
  v_add_f32 v52, v52, v32
  buffer_load_dwordx4 v96, s[12:15], s24 offen offset:3072 sc1 lds
  v_add_f32 v53, v53, v33
  v_add_f32 v54, v54, v34
  v_add_f32 v55, v55, v35
  s_add_u32 s22, s21, 13
  s_and_b32 s22, s22, 15
  s_mul_i32 s22, s22, 458752
  s_add_u32 s25, s33, s22
  s_mov_b32 s23, 45056
  s_add_u32 m0, s23, s45
  s_mov_b32 s30, s25
  buffer_load_dwordx4 v98, s[48:51], s30 offen lds
  v_add_f32 v52, v52, v36
  v_add_f32 v53, v53, v37
  v_add_f32 v54, v54, v38
  s_add_u32 m0, m0, 1024
  s_nop 0
  buffer_load_dwordx4 v99, s[48:51], s30 offen lds
  v_add_f32 v55, v55, v39
  v_add_f32 v52, v52, v40
  v_add_f32 v53, v53, v41
  s_add_u32 m0, m0, 1024
  s_nop 0
  buffer_load_dwordx4 v100, s[48:51], s30 offen lds
  v_add_f32 v54, v54, v42
  v_add_f32 v55, v55, v43
  v_add_f32 v52, v52, v44
  s_add_u32 m0, m0, 1024
  s_nop 0
  buffer_load_dwordx4 v101, s[48:51], s30 offen lds
  v_add_f32 v53, v53, v45
  v_add_f32 v54, v54, v46
  v_add_f32 v55, v55, v47
  s_add_u32 m0, m0, 1024
  s_nop 0
  buffer_load_dwordx4 v102, s[48:51], s30 offen lds
  v_add_f32 v52, v52, v48
  v_add_f32 v53, v53, v49
  v_add_f32 v54, v54, v50
  s_add_u32 m0, m0, 1024
  s_nop 0
  buffer_load_dwordx4 v103, s[48:51], s30 offen lds
  v_add_f32 v55, v55, v51
  v_add_f32 v52, v52, v54
  v_add_f32 v53, v53, v55
  s_add_u32 m0, m0, 1024
  s_nop 0
  buffer_load_dwordx4 v104, s[48:51], s30 offen lds
  s_cmp_eq_u32 s3, 4
  s_cbranch_scc0 L_sequential_preLN__sliding_block__dense_activation_relu__prompt_kernel_w4_g4m11
  v_readfirstlane_b32 s37, v116
  s_nop 3
  s_or_b32 s43, s43, s37
L_sequential_preLN__sliding_block__dense_activation_relu__prompt_kernel_w4_g4m11:
  s_cmp_eq_u32 s3, 4
  s_cbranch_scc0 L_sequential_preLN__sliding_block__dense_activation_relu__prompt_kernel_w4_eg4p14
  s_add_u32 s22, s21, 14
  s_and_b32 s22, s22, 15
  s_lshl_b32 s36, 1, s22
  s_and_b32 s37, s43, s36
  s_cmp_eq_u32 s37, s36
  s_cbranch_scc1 L_sequential_preLN__sliding_block__dense_activation_relu__prompt_kernel_w4_eg4p14
  s_mov_b32 s31, 40000
L_sequential_preLN__sliding_block__dense_activation_relu__prompt_kernel_en_g4p14:
  buffer_load_dword v110, v109, s[12:15], 0 offen sc1
  s_waitcnt vmcnt(0)
  v_readfirstlane_b32 s43, v110
  s_nop 3
  s_and_b32 s37, s43, s36
  s_cmp_eq_u32 s37, s36
  s_cbranch_scc1 L_sequential_preLN__sliding_block__dense_activation_relu__prompt_kernel_w4_eg4p14
  s_sub_u32 s31, s31, 1
  s_cmp_eq_u32 s31, 0
  s_cbranch_scc1 L_sequential_preLN__sliding_block__dense_activation_relu__prompt_kernel_w4_eg4p14
  s_nop 0
  s_branch L_sequential_preLN__sliding_block__dense_activation_relu__prompt_kernel_en_g4p14
L_sequential_preLN__sliding_block__dense_activation_relu__prompt_kernel_w4_eg4p14:
  s_waitcnt vmcnt(11)
  s_barrier
  s_add_u32 s22, s21, 14
  s_and_b32 s22, s22, 15
  s_mul_i32 s22, s22, 262144
  s_add_u32 s24, s32, s22
  s_mov_b32 s23, 90112
  s_add_u32 m0, s23, s44
  s_nop 0
  buffer_load_dwordx4 v96, s[12:15], s24 offen offset:0 sc1 lds
  v_mov_b32 v16, v52
  s_nop 1
  buffer_load_dwordx4 v96, s[12:15], s24 offen offset:1024 sc1 lds
  v_permlane32_swap_b32 v52, v16
  s_nop 1
  buffer_load_dwordx4 v96, s[12:15], s24 offen offset:2048 sc1 lds
  v_add_f32 v52, v52, v16
  v_mov_b32 v16, v53
  buffer_load_dwordx4 v96, s[12:15], s24 offen offset:3072 sc1 lds
  s_nop 1
  v_permlane32_swap_b32 v53, v16
  s_add_u32 s22, s21, 14
  s_and_b32 s22, s22, 15
  s_mul_i32 s22, s22, 458752
  s_add_u32 s25, s33, s22
  s_mov_b32 s23, 90112
  s_add_u32 m0, s23, s45
  s_mov_b32 s30, s25
  buffer_load_dwordx4 v98, s[48:51], s30 offen lds
  s_nop 1
  v_add_f32 v53, v53, v16
  s_add_u32 m0, m0, 1024
  s_nop 0
  buffer_load_dwordx4 v99, s[48:51], s30 offen lds
  v_mul_f32 v52, 0xba800000, v52
  v_mul_f32 v53, 0x3a800000, v53
  s_add_u32 m0, m0, 1024
  s_nop 0
  buffer_load_dwordx4 v100, s[48:51], s30 offen lds
  v_fma_f32 v53, -v52, v52, v53
  v_max_f32 v53, 0, v53
  s_add_u32 m0, m0, 1024
  s_nop 0
  buffer_load_dwordx4 v101, s[48:51], s30 offen lds
  v_add_f32 v53, 0x3727c5ac, v53
  v_rsq_f32 v53, v53
  s_add_u32 m0, m0, 1024
  s_nop 0
  buffer_load_dwordx4 v102, s[48:51], s30 offen lds
  s_sub_u32 s36, s3, 4
  s_lshl_b32 s36, s36, 8
  s_add_u32 m0, m0, 1024
  s_nop 0
  buffer_load_dwordx4 v103, s[48:51], s30 offen lds
  s_add_u32 s36, s36, 155648
  v_and_b32 v3, 31, v1
  s_add_u32 m0, m0, 1024
  s_nop 0
  buffer_load_dwordx4 v104, s[48:51], s30 offen lds
  v_lshl_add_u32 v2, v3, 3, s36
  ds_write_b64 v2, v[52:53]
  s_cmp_eq_u32 s3, 4
  s_cbranch_scc0 L_sequential_preLN__sliding_block__dense_activation_relu__prompt_kernel_w4_g4m12
  v_readfirstlane_b32 s37, v111
  s_nop 3
  s_or_b32 s43, s43, s37
L_sequential_preLN__sliding_block__dense_activation_relu__prompt_kernel_w4_g4m12:
  s_cmp_eq_u32 s3, 4
  s_cbranch_scc0 L_sequential_preLN__sliding_block__dense_activation_relu__prompt_kernel_w4_eg4p15
  s_add_u32 s22, s21, 15
  s_and_b32 s22, s22, 15
  s_lshl_b32 s36, 1, s22
  s_and_b32 s37, s43, s36
  s_cmp_eq_u32 s37, s36
  s_cbranch_scc1 L_sequential_preLN__sliding_block__dense_activation_relu__prompt_kernel_w4_eg4p15
  s_mov_b32 s31, 40000
L_sequential_preLN__sliding_block__dense_activation_relu__prompt_kernel_en_g4p15:
  buffer_load_dword v110, v109, s[12:15], 0 offen sc1
  s_waitcnt vmcnt(0)
  v_readfirstlane_b32 s43, v110
  s_nop 3
  s_and_b32 s37, s43, s36
  s_cmp_eq_u32 s37, s36
  s_cbranch_scc1 L_sequential_preLN__sliding_block__dense_activation_relu__prompt_kernel_w4_eg4p15
  s_sub_u32 s31, s31, 1
  s_cmp_eq_u32 s31, 0
  s_cbranch_scc1 L_sequential_preLN__sliding_block__dense_activation_relu__prompt_kernel_w4_eg4p15
  s_nop 0
  s_branch L_sequential_preLN__sliding_block__dense_activation_relu__prompt_kernel_en_g4p15
L_sequential_preLN__sliding_block__dense_activation_relu__prompt_kernel_w4_eg4p15:
  s_waitcnt vmcnt(11)
  s_barrier
  s_add_u32 s22, s21, 15
  s_and_b32 s22, s22, 15
  s_mul_i32 s22, s22, 262144
  s_add_u32 s24, s32, s22
  s_mov_b32 s23, 0
  s_add_u32 m0, s23, s44
  s_nop 0
  buffer_load_dwordx4 v96, s[12:15], s24 offen offset:0 sc1 lds
  v_add_f32 v76, v60, v64
  v_add_f32 v77, v61, v65
  v_add_f32 v78, v62, v66
  v_add_f32 v79, v63, v67
  v_add_f32 v76, v76, v68
  v_add_f32 v77, v77, v69
  buffer_load_dwordx4 v96, s[12:15], s24 offen offset:1024 sc1 lds
  v_add_f32 v78, v78, v70
  v_add_f32 v79, v79, v71
  v_add_f32 v76, v76, v72
  v_add_f32 v77, v77, v73
  v_add_f32 v78, v78, v74
  v_add_f32 v79, v79, v75
  buffer_load_dwordx4 v96, s[12:15], s24 offen offset:2048 sc1 lds
  v_mov_b32 v16, v76
  s_nop 1
  v_permlane16_swap_b32 v76, v16
  s_nop 1
  v_add_f32 v76, v76, v16
  v_mov_b32 v16, v76
  buffer_load_dwordx4 v96, s[12:15], s24 offen offset:3072 sc1 lds
  s_nop 1
  v_permlane32_swap_b32 v76, v16
  s_nop 1
  v_add_f32 v76, v76, v16
  v_mov_b32 v16, v77
  s_nop 1
  s_add_u32 s22, s21, 15
  s_and_b32 s22, s22, 15
  s_mul_i32 s22, s22, 458752
  s_add_u32 s25, s33, s22
  s_mov_b32 s23, 0
  s_add_u32 m0, s23, s45
  s_mov_b32 s30, s25
  buffer_load_dwordx4 v98, s[48:51], s30 offen lds
  v_permlane16_swap_b32 v77, v16
  s_nop 1
  v_add_f32 v77, v77, v16
  v_mov_b32 v16, v77
  s_nop 1
  v_permlane32_swap_b32 v77, v16
  s_add_u32 m0, m0, 1024
  s_nop 0
  buffer_load_dwordx4 v99, s[48:51], s30 offen lds
  s_nop 1
  v_add_f32 v77, v77, v16
  v_mov_b32 v16, v78
  s_nop 1
  v_permlane16_swap_b32 v78, v16
  s_nop 1
  s_add_u32 m0, m0, 1024
  s_nop 0
  buffer_load_dwordx4 v100, s[48:51], s30 offen lds
  v_add_f32 v78, v78, v16
  v_mov_b32 v16, v78
  s_nop 1
  v_permlane32_swap_b32 v78, v16
  s_nop 1
  v_add_f32 v78, v78, v16
  s_add_u32 m0, m0, 1024
  s_nop 0
  buffer_load_dwordx4 v101, s[48:51], s30 offen lds
  v_mov_b32 v16, v79
  s_nop 1
  v_permlane16_swap_b32 v79, v16
  s_nop 1
  v_add_f32 v79, v79, v16
  v_mov_b32 v16, v79
  s_add_u32 m0, m0, 1024
  s_nop 0
  buffer_load_dwordx4 v102, s[48:51], s30 offen lds
  s_nop 1
  v_permlane32_swap_b32 v79, v16
  s_nop 1
  v_add_f32 v79, v79, v16
  s_sub_u32 s26, s3, 4
  s_mul_i32 s27, s26, 224
  s_add_u32 m0, m0, 1024
  s_nop 0
  buffer_load_dwordx4 v103, s[48:51], s30 offen lds
  s_add_u32 s27, s27, 156672
  v_and_b32 v3, 15, v1
  v_lshl_add_u32 v2, v3, 4, s27
  v_cmp_gt_u32 vcc, 14, v1
  s_and_saveexec_b64 s[34:35], vcc
  ds_write_b128 v2, v[76:79]
  s_mov_b64 exec, s[34:35]
  s_add_u32 m0, m0, 1024
  s_nop 0
  buffer_load_dwordx4 v104, s[48:51], s30 offen lds
  s_waitcnt vmcnt(11)
  s_barrier
  s_waitcnt vmcnt(0)
  s_waitcnt lgkmcnt(0)
  s_barrier
  s_barrier
  s_sub_u32 s26, s3, 4
  s_lshr_b32 s27, s21, 3
  s_mul_i32 s24, s27, 7340032
  s_lshl_b32 s27, s20, 13
  s_add_u32 s24, s24, s27
  s_add_u32 s24, s24, 25165824
  s_lshr_b32 s27, s26, 1
  s_mul_i32 s27, s27, 131072
  s_add_u32 s24, s24, s27
  s_and_b32 s27, s26, 1
  s_lshl_b32 s27, s27, 12
  s_add_u32 s24, s24, s27
  s_mul_i32 s44, s26, 4096
  s_add_u32 s44, s44, 0
  s_lshr_b32 s27, s21, 3
  s_mul_i32 s25, s27, 3670016
  s_and_b32 s27, s21, 7
  s_lshl_b32 s27, s27, 8
  s_add_u32 s25, s25, s27
  s_mul_i32 s27, s26, 32768
  s_add_u32 s25, s25, s27
  s_mul_i32 s45, s26, 4096
  s_add_u32 s45, s45, 16384
  s_mov_b32 s23, 0
  s_mov_b32 s32, s24
  s_mov_b32 s33, s25
  s_sub_u32 s42, s3, 4
  s_lshr_b32 s42, s42, 1
  s_lshl_b32 s29, s20, 1
  s_lshr_b32 s30, s21, 3
  s_add_u32 s29, s29, s30
  s_lshl_b32 s29, s29, 7
  s_add_u32 s29, s29, 3215360
  v_mov_b32 v109, s29
  s_mov_b32 s43, 0
  v_mov_b32 v110, 0
  v_mov_b32 v111, 0
  v_mov_b32 v112, 0
  v_mov_b32 v116, 0
  v_mov_b32 v117, 0
  s_barrier
  s_add_u32 s22, s21, 0
  s_and_b32 s22, s22, 7
  s_mul_i32 s22, s22, 7
  s_add_u32 s22, s22, 0
  s_mul_i32 s22, s22, 65536
  s_add_u32 s25, s33, s22
  s_mov_b32 s23, 0
  s_add_u32 m0, s23, s45
  s_mov_b32 s30, s25
  buffer_load_dwordx4 v105, s[52:55], s30 offen lds
  s_add_u32 m0, m0, 1024
  s_nop 0
  buffer_load_dwordx4 v106, s[52:55], s30 offen lds
  s_add_u32 m0, m0, 1024
  s_add_u32 s30, s30, 16384
  buffer_load_dwordx4 v105, s[52:55], s30 offen lds
  s_add_u32 m0, m0, 1024
  s_nop 0
  buffer_load_dwordx4 v106, s[52:55], s30 offen lds
  s_add_u32 s22, s21, 0
  s_and_b32 s22, s22, 7
  s_mul_i32 s22, s22, 7
  s_add_u32 s22, s22, 2
  s_mul_i32 s22, s22, 65536
  s_add_u32 s25, s33, s22
  s_mov_b32 s23, 32768
  s_add_u32 m0, s23, s45
  s_mov_b32 s30, s25
  buffer_load_dwordx4 v105, s[52:55], s30 offen lds
  s_add_u32 m0, m0, 1024
  s_nop 0
  buffer_load_dwordx4 v106, s[52:55], s30 offen lds
  s_add_u32 m0, m0, 1024
  s_add_u32 s30, s30, 16384
  buffer_load_dwordx4 v105, s[52:55], s30 offen lds
  s_add_u32 m0, m0, 1024
  s_nop 0
  buffer_load_dwordx4 v106, s[52:55], s30 offen lds
  s_barrier
  s_cmp_eq_u32 s3, 4
  s_cbranch_scc0 L_sequential_preLN__sliding_block__dense_activation_relu__prompt_kernel_w4_g5s
  s_lshl_b32 s28, s20, 1
  s_lshr_b32 s30, s21, 3
  s_add_u32 s28, s28, s30
  s_lshl_b32 s28, s28, 7
  s_add_u32 s28, s28, 3215360
  s_and_b32 s29, s21, 7
  s_lshl_b32 s29, 1, s29
  v_mov_b32 v2, 0
  v_mov_b32 v3, s29
  s_mov_b64 exec, 1
  buffer_atomic_or v3, v2, s[12:15], s28 offen sc1
  s_mov_b64 exec, -1
L_sequential_preLN__sliding_block__dense_activation_relu__prompt_kernel_w4_g5s:
  s_add_u32 s22, s21, 0
  s_and_b32 s22, s22, 7
  s_mul_i32 s22, s22, 7
  s_add_u32 s22, s22, 4
  s_mul_i32 s22, s22, 65536
  s_add_u32 s25, s33, s22
  s_mov_b32 s23, 65536
  s_add_u32 m0, s23, s45
  s_mov_b32 s30, s25
  buffer_load_dwordx4 v105, s[52:55], s30 offen lds
  s_add_u32 m0, m0, 1024
  s_nop 0
  buffer_load_dwordx4 v106, s[52:55], s30 offen lds
  s_add_u32 m0, m0, 1024
  s_add_u32 s30, s30, 16384
  buffer_load_dwordx4 v105, s[52:55], s30 offen lds
  s_add_u32 m0, m0, 1024
  s_nop 0
  buffer_load_dwordx4 v106, s[52:55], s30 offen lds
  s_add_u32 s22, s21, 0
  s_and_b32 s22, s22, 7
  s_mul_i32 s22, s22, 7
  s_add_u32 s22, s22, 6
  s_add_u32 s27, s21, 1
  s_and_b32 s27, s27, 7
  s_mul_i32 s27, s27, 7
  s_sub_u32 s27, s27, 1
  s_cmp_eq_u32 s42, 0
  s_cselect_b32 s22, s22, s27
  s_mul_i32 s22, s22, 65536
  s_add_u32 s25, s33, s22
  s_mov_b32 s23, 98304
  s_add_u32 m0, s23, s45
  s_mov_b32 s30, s25
  buffer_load_dwordx4 v105, s[52:55], s30 offen lds
  s_add_u32 m0, m0, 1024
  s_nop 0
  buffer_load_dwordx4 v106, s[52:55], s30 offen lds
  s_add_u32 m0, m0, 1024
  s_add_u32 s30, s30, 16384
  buffer_load_dwordx4 v105, s[52:55], s30 offen lds
  s_add_u32 m0, m0, 1024
  s_nop 0
  buffer_load_dwordx4 v106, s[52:55], s30 offen lds
  s_barrier
  s_add_u32 s22, s21, 0
  s_and_b32 s22, s22, 7
  s_mul_i32 s22, s22, 7
  s_add_u32 s22, s22, 0
  s_mul_i32 s22, s22, 131072
  s_add_u32 s24, s32, s22
  s_mov_b32 s23, 0
  s_add_u32 m0, s23, s44
  s_nop 0
  buffer_load_dwordx4 v96, s[12:15], s24 offen offset:0 sc1 lds
  buffer_load_dwordx4 v96, s[12:15], s24 offen offset:1024 sc1 lds
  buffer_load_dwordx4 v96, s[12:15], s24 offen offset:2048 sc1 lds
  buffer_load_dwordx4 v96, s[12:15], s24 offen offset:3072 sc1 lds
  s_add_u32 s22, s21, 0
  s_and_b32 s22, s22, 7
  s_mul_i32 s22, s22, 7
  s_add_u32 s22, s22, 2
  s_mul_i32 s22, s22, 131072
  s_add_u32 s24, s32, s22
  s_mov_b32 s23, 32768
  s_add_u32 m0, s23, s44
  s_nop 0
  buffer_load_dwordx4 v96, s[12:15], s24 offen offset:0 sc1 lds
  buffer_load_dwordx4 v96, s[12:15], s24 offen offset:1024 sc1 lds
  buffer_load_dwordx4 v96, s[12:15], s24 offen offset:2048 sc1 lds
  buffer_load_dwordx4 v96, s[12:15], s24 offen offset:3072 sc1 lds
  s_waitcnt vmcnt(4)
  s_barrier
  s_add_u32 s22, s21, 0
  s_and_b32 s22, s22, 7
  s_mul_i32 s22, s22, 7
  s_add_u32 s22, s22, 4
  s_mul_i32 s22, s22, 131072
  s_add_u32 s24, s32, s22
  s_mov_b32 s23, 65536
  s_add_u32 m0, s23, s44
  s_nop 0
  buffer_load_dwordx4 v96, s[12:15], s24 offen offset:0 sc1 lds
  buffer_load_dwordx4 v96, s[12:15], s24 offen offset:1024 sc1 lds
  buffer_load_dwordx4 v96, s[12:15], s24 offen offset:2048 sc1 lds
  buffer_load_dwordx4 v96, s[12:15], s24 offen offset:3072 sc1 lds
  s_cmp_eq_u32 s3, 4
  s_cbranch_scc0 L_sequential_preLN__sliding_block__dense_activation_relu__prompt_kernel_w4_eg5p3
  s_add_u32 s22, s21, 1
  s_and_b32 s22, s22, 7
  s_lshl_b32 s36, 1, s22
  s_and_b32 s37, s43, s36
  s_cmp_eq_u32 s37, s36
  s_cbranch_scc1 L_sequential_preLN__sliding_block__dense_activation_relu__prompt_kernel_w4_eg5p3
  s_mov_b32 s31, 40000
L_sequential_preLN__sliding_block__dense_activation_relu__prompt_kernel_en_g5p3:
  buffer_load_dword v110, v109, s[12:15], 0 offen sc1
  s_waitcnt vmcnt(0)
  v_readfirstlane_b32 s43, v110
  s_nop 3
  s_and_b32 s37, s43, s36
  s_cmp_eq_u32 s37, s36
  s_cbranch_scc1 L_sequential_preLN__sliding_block__dense_activation_relu__prompt_kernel_w4_eg5p3
  s_sub_u32 s31, s31, 1
  s_cmp_eq_u32 s31, 0
  s_cbranch_scc1 L_sequential_preLN__sliding_block__dense_activation_relu__prompt_kernel_w4_eg5p3
  s_nop 0
  s_branch L_sequential_preLN__sliding_block__dense_activation_relu__prompt_kernel_en_g5p3
L_sequential_preLN__sliding_block__dense_activation_relu__prompt_kernel_w4_eg5p3:
  s_waitcnt vmcnt(4)
  s_barrier
  s_cmp_eq_u32 s3, 4
  s_cbranch_scc0 L_sequential_preLN__sliding_block__dense_activation_relu__prompt_kernel_w4_g5r0
  buffer_load_dword v111, v109, s[12:15], 0 offen sc1
L_sequential_preLN__sliding_block__dense_activation_relu__prompt_kernel_w4_g5r0:
  s_add_u32 s22, s21, 0
  s_and_b32 s22, s22, 7
  s_mul_i32 s22, s22, 7
  s_add_u32 s22, s22, 6
  s_add_u32 s27, s21, 1
  s_and_b32 s27, s27, 7
  s_mul_i32 s27, s27, 7
  s_sub_u32 s27, s27, 1
  s_cmp_eq_u32 s42, 0
  s_cselect_b32 s22, s22, s27
  s_mul_i32 s22, s22, 131072
  s_add_u32 s24, s32, s22
  s_mov_b32 s23, 98304
  s_add_u32 m0, s23, s44
  s_nop 0
  buffer_load_dwordx4 v96, s[12:15], s24 offen offset:0 sc1 lds
  buffer_load_dwordx4 v96, s[12:15], s24 offen offset:1024 sc1 lds
  buffer_load_dwordx4 v96, s[12:15], s24 offen offset:2048 sc1 lds
  buffer_load_dwordx4 v96, s[12:15], s24 offen offset:3072 sc1 lds
  s_add_u32 s22, s21, 1
  s_and_b32 s22, s22, 7
  s_mul_i32 s22, s22, 7
  s_add_u32 s22, s22, 1
  s_mul_i32 s22, s22, 131072
  s_add_u32 s24, s32, s22
  s_mov_b32 s23, 0
  s_add_u32 m0, s23, s44
  s_nop 0
  buffer_load_dwordx4 v96, s[12:15], s24 offen offset:0 sc1 lds
  buffer_load_dwordx4 v96, s[12:15], s24 offen offset:1024 sc1 lds
  buffer_load_dwordx4 v96, s[12:15], s24 offen offset:2048 sc1 lds
  buffer_load_dwordx4 v96, s[12:15], s24 offen offset:3072 sc1 lds
  s_add_u32 s22, s21, 1
  s_and_b32 s22, s22, 7
  s_mul_i32 s22, s22, 7
  s_add_u32 s22, s22, 1
  s_mul_i32 s22, s22, 65536
  s_add_u32 s25, s33, s22
  s_mov_b32 s23, 0
  s_add_u32 m0, s23, s45
  s_mov_b32 s30, s25
  buffer_load_dwordx4 v105, s[52:55], s30 offen lds
  s_add_u32 m0, m0, 1024
  s_nop 0
  buffer_load_dwordx4 v106, s[52:55], s30 offen lds
  s_add_u32 m0, m0, 1024
  s_add_u32 s30, s30, 16384
  buffer_load_dwordx4 v105, s[52:55], s30 offen lds
  s_add_u32 m0, m0, 1024
  s_nop 0
  buffer_load_dwordx4 v106, s[52:55], s30 offen lds
  s_waitcnt vmcnt(12)
  s_barrier
  s_cmp_eq_u32 s3, 4
  s_cbranch_scc0 L_sequential_preLN__sliding_block__dense_activation_relu__prompt_kernel_w4_g5r1
  buffer_load_dword v112, v109, s[12:15], 0 offen sc1
L_sequential_preLN__sliding_block__dense_activation_relu__prompt_kernel_w4_g5r1:
  s_add_u32 s22, s21, 1
  s_and_b32 s22, s22, 7
  s_mul_i32 s22, s22, 7
  s_add_u32 s22, s22, 3
  s_mul_i32 s22, s22, 131072
  s_add_u32 s24, s32, s22
  s_mov_b32 s23, 32768
  s_add_u32 m0, s23, s44
  s_nop 0
  buffer_load_dwordx4 v96, s[12:15], s24 offen offset:0 sc1 lds
  buffer_load_dwordx4 v96, s[12:15], s24 offen offset:1024 sc1 lds
  buffer_load_dwordx4 v96, s[12:15], s24 offen offset:2048 sc1 lds
  buffer_load_dwordx4 v96, s[12:15], s24 offen offset:3072 sc1 lds
  s_add_u32 s22, s21, 1
  s_and_b32 s22, s22, 7
  s_mul_i32 s22, s22, 7
  s_add_u32 s22, s22, 3
  s_mul_i32 s22, s22, 65536
  s_add_u32 s25, s33, s22
  s_mov_b32 s23, 32768
  s_add_u32 m0, s23, s45
  s_mov_b32 s30, s25
  buffer_load_dwordx4 v105, s[52:55], s30 offen lds
  s_add_u32 m0, m0, 1024
  s_nop 0
  buffer_load_dwordx4 v106, s[52:55], s30 offen lds
  s_add_u32 m0, m0, 1024
  s_add_u32 s30, s30, 16384
  buffer_load_dwordx4 v105, s[52:55], s30 offen lds
  s_add_u32 m0, m0, 1024
  s_nop 0
  buffer_load_dwordx4 v106, s[52:55], s30 offen lds
  s_waitcnt vmcnt(16)
  s_barrier
  s_cmp_eq_u32 s3, 4
  s_cbranch_scc0 L_sequential_preLN__sliding_block__dense_activation_relu__prompt_kernel_w4_g5r2
  buffer_load_dword v116, v109, s[12:15], 0 offen sc1
L_sequential_preLN__sliding_block__dense_activation_relu__prompt_kernel_w4_g5r2:
  s_add_u32 s22, s21, 1
  s_and_b32 s22, s22, 7
  s_mul_i32 s22, s22, 7
  s_add_u32 s22, s22, 5
  s_mul_i32 s22, s22, 131072
  s_add_u32 s24, s32, s22
  s_mov_b32 s23, 65536
  s_add_u32 m0, s23, s44
  s_nop 0
  buffer_load_dwordx4 v96, s[12:15], s24 offen offset:0 sc1 lds
  buffer_load_dwordx4 v96, s[12:15], s24 offen offset:1024 sc1 lds
  buffer_load_dwordx4 v96, s[12:15], s24 offen offset:2048 sc1 lds
  buffer_load_dwordx4 v96, s[12:15], s24 offen offset:3072 sc1 lds
  s_add_u32 s22, s21, 1
  s_and_b32 s22, s22, 7
  s_mul_i32 s22, s22, 7
  s_add_u32 s22, s22, 5
  s_mul_i32 s22, s22, 65536
  s_add_u32 s25, s33, s22
  s_mov_b32 s23, 65536
  s_add_u32 m0, s23, s45
  s_mov_b32 s30, s25
  buffer_load_dwordx4 v105, s[52:55], s30 offen lds
  s_add_u32 m0, m0, 1024
  s_nop 0
  buffer_load_dwordx4 v106, s[52:55], s30 offen lds
  s_add_u32 m0, m0, 1024
  s_add_u32 s30, s30, 16384
  buffer_load_dwordx4 v105, s[52:55], s30 offen lds
  s_add_u32 m0, m0, 1024
  s_nop 0
  buffer_load_dwordx4 v106, s[52:55], s30 offen lds
  s_cmp_eq_u32 s3, 4
  s_cbranch_scc0 L_sequential_preLN__sliding_block__dense_activation_relu__prompt_kernel_w4_eg5p7
  s_add_u32 s22, s21, 2
  s_and_b32 s22, s22, 7
  s_lshl_b32 s36, 1, s22
  s_and_b32 s37, s43, s36
  s_cmp_eq_u32 s37, s36
  s_cbranch_scc1 L_sequential_preLN__sliding_block__dense_activation_relu__prompt_kernel_w4_eg5p7
  s_mov_b32 s31, 40000
L_sequential_preLN__sliding_block__dense_activation_relu__prompt_kernel_en_g5p7:
  buffer_load_dword v110, v109, s[12:15], 0 offen sc1
  s_waitcnt vmcnt(0)
  v_readfirstlane_b32 s43, v110
  s_nop 3
  s_and_b32 s37, s43, s36
  s_cmp_eq_u32 s37, s36
  s_cbranch_scc1 L_sequential_preLN__sliding_block__dense_activation_relu__prompt_kernel_w4_eg5p7
  s_sub_u32 s31, s31, 1
  s_cmp_eq_u32 s31, 0
  s_cbranch_scc1 L_sequential_preLN__sliding_block__dense_activation_relu__prompt_kernel_w4_eg5p7
  s_nop 0
  s_branch L_sequential_preLN__sliding_block__dense_activation_relu__prompt_kernel_en_g5p7
L_sequential_preLN__sliding_block__dense_activation_relu__prompt_kernel_w4_eg5p7:
  s_waitcnt vmcnt(16)
  s_barrier
  s_cmp_eq_u32 s3, 4
  s_cbranch_scc0 L_sequential_preLN__sliding_block__dense_activation_relu__prompt_kernel_w4_g5r3
  buffer_load_dword v117, v109, s[12:15], 0 offen sc1
L_sequential_preLN__sliding_block__dense_activation_relu__prompt_kernel_w4_g5r3:
  s_add_u32 s22, s21, 2
  s_and_b32 s22, s22, 7
  s_mul_i32 s22, s22, 7
  s_add_u32 s22, s22, 0
  s_mul_i32 s22, s22, 131072
  s_add_u32 s24, s32, s22
  s_mov_b32 s23, 98304
  s_add_u32 m0, s23, s44
  s_nop 0
  buffer_load_dwordx4 v96, s[12:15], s24 offen offset:0 sc1 lds
  buffer_load_dwordx4 v96, s[12:15], s24 offen offset:1024 sc1 lds
  buffer_load_dwordx4 v96, s[12:15], s24 offen offset:2048 sc1 lds
  buffer_load_dwordx4 v96, s[12:15], s24 offen offset:3072 sc1 lds
  s_add_u32 s22, s21, 2
  s_and_b32 s22, s22, 7
  s_mul_i32 s22, s22, 7
  s_add_u32 s22, s22, 0
  s_mul_i32 s22, s22, 65536
  s_add_u32 s25, s33, s22
  s_mov_b32 s23, 98304
  s_add_u32 m0, s23, s45
  s_mov_b32 s30, s25
  buffer_load_dwordx4 v105, s[52:55], s30 offen lds
  s_add_u32 m0, m0, 1024
  s_nop 0
  buffer_load_dwordx4 v106, s[52:55], s30 offen lds
  s_add_u32 m0, m0, 1024
  s_add_u32 s30, s30, 16384
  buffer_load_dwordx4 v105, s[52:55], s30 offen lds
  s_add_u32 m0, m0, 1024
  s_nop 0
  buffer_load_dwordx4 v106, s[52:55], s30 offen lds
  s_cmp_eq_u32 s3, 4
  s_cbranch_scc0 L_sequential_preLN__sliding_block__dense_activation_relu__prompt_kernel_w4_g5m4
  v_readfirstlane_b32 s37, v111
  s_nop 3
  s_or_b32 s43, s43, s37
L_sequential_preLN__sliding_block__dense_activation_relu__prompt_kernel_w4_g5m4:
  s_waitcnt vmcnt(16)
  s_barrier
  s_cmp_eq_u32 s3, 4
  s_cbranch_scc0 L_sequential_preLN__sliding_block__dense_activation_relu__prompt_kernel_w4_g5r4
  buffer_load_dword v111, v109, s[12:15], 0 offen sc1
L_sequential_preLN__sliding_block__dense_activation_relu__prompt_kernel_w4_g5r4:
  s_add_u32 s22, s21, 2
  s_and_b32 s22, s22, 7
  s_mul_i32 s22, s22, 7
  s_add_u32 s22, s22, 2
  s_mul_i32 s22, s22, 131072
  s_add_u32 s24, s32, s22
  s_mov_b32 s23, 0
  s_add_u32 m0, s23, s44
  s_nop 0
  buffer_load_dwordx4 v96, s[12:15], s24 offen offset:0 sc1 lds
  buffer_load_dwordx4 v96, s[12:15], s24 offen offset:1024 sc1 lds
  buffer_load_dwordx4 v96, s[12:15], s24 offen offset:2048 sc1 lds
  buffer_load_dwordx4 v96, s[12:15], s24 offen offset:3072 sc1 lds
  s_add_u32 s22, s21, 2
  s_and_b32 s22, s22, 7
  s_mul_i32 s22, s22, 7
  s_add_u32 s22, s22, 2
  s_mul_i32 s22, s22, 65536
  s_add_u32 s25, s33, s22
  s_mov_b32 s23, 0
  s_add_u32 m0, s23, s45
  s_mov_b32 s30, s25
  buffer_load_dwordx4 v105, s[52:55], s30 offen lds
  s_add_u32 m0, m0, 1024
  s_nop 0
  buffer_load_dwordx4 v106, s[52:55], s30 offen lds
  s_add_u32 m0, m0, 1024
  s_add_u32 s30, s30, 16384
  buffer_load_dwordx4 v105, s[52:55], s30 offen lds
  s_add_u32 m0, m0, 1024
  s_nop 0
  buffer_load_dwordx4 v106, s[52:55], s30 offen lds
  s_cmp_eq_u32 s3, 4
  s_cbranch_scc0 L_sequential_preLN__sliding_block__dense_activation_relu__prompt_kernel_w4_g5m5
  v_readfirstlane_b32 s37, v112
  s_nop 3
  s_or_b32 s43, s43, s37
L_sequential_preLN__sliding_block__dense_activation_relu__prompt_kernel_w4_g5m5:
  s_waitcnt vmcnt(16)
  s_barrier
  s_cmp_eq_u32 s3, 4
  s_cbranch_scc0 L_sequential_preLN__sliding_block__dense_activation_relu__prompt_kernel_w4_g5r5
  buffer_load_dword v112, v109, s[12:15], 0 offen sc1
L_sequential_preLN__sliding_block__dense_activation_relu__prompt_kernel_w4_g5r5:
  s_add_u32 s22, s21, 2
  s_and_b32 s22, s22, 7
  s_mul_i32 s22, s22, 7
  s_add_u32 s22, s22, 4
  s_mul_i32 s22, s22, 131072
  s_add_u32 s24, s32, s22
  s_mov_b32 s23, 32768
  s_add_u32 m0, s23, s44
  s_nop 0
  buffer_load_dwordx4 v96, s[12:15], s24 offen offset:0 sc1 lds
  buffer_load_dwordx4 v96, s[12:15], s24 offen offset:1024 sc1 lds
  buffer_load_dwordx4 v96, s[12:15], s24 offen offset:2048 sc1 lds
  buffer_load_dwordx4 v96, s[12:15], s24 offen offset:3072 sc1 lds
  s_add_u32 s22, s21, 2
  s_and_b32 s22, s22, 7
  s_mul_i32 s22, s22, 7
  s_add_u32 s22, s22, 4
  s_mul_i32 s22, s22, 65536
  s_add_u32 s25, s33, s22
  s_mov_b32 s23, 32768
  s_add_u32 m0, s23, s45
  s_mov_b32 s30, s25
  buffer_load_dwordx4 v105, s[52:55], s30 offen lds
  s_add_u32 m0, m0, 1024
  s_nop 0
  buffer_load_dwordx4 v106, s[52:55], s30 offen lds
  s_add_u32 m0, m0, 1024
  s_add_u32 s30, s30, 16384
  buffer_load_dwordx4 v105, s[52:55], s30 offen lds
  s_add_u32 m0, m0, 1024
  s_nop 0
  buffer_load_dwordx4 v106, s[52:55], s30 offen lds
  s_cmp_eq_u32 s3, 4
  s_cbranch_scc0 L_sequential_preLN__sliding_block__dense_activation_relu__prompt_kernel_w4_g5m6
  v_readfirstlane_b32 s37, v116
  s_nop 3
  s_or_b32 s43, s43, s37
L_sequential_preLN__sliding_block__dense_activation_relu__prompt_kernel_w4_g5m6:
  s_cmp_eq_u32 s3, 4
  s_cbranch_scc0 L_sequential_preLN__sliding_block__dense_activation_relu__prompt_kernel_w4_eg5p10
  s_add_u32 s22, s21, 3
  s_and_b32 s22, s22, 7
  s_lshl_b32 s36, 1, s22
  s_and_b32 s37, s43, s36
  s_cmp_eq_u32 s37, s36
  s_cbranch_scc1 L_sequential_preLN__sliding_block__dense_activation_relu__prompt_kernel_w4_eg5p10
  s_mov_b32 s31, 40000
L_sequential_preLN__sliding_block__dense_activation_relu__prompt_kernel_en_g5p10:
  buffer_load_dword v110, v109, s[12:15], 0 offen sc1
  s_waitcnt vmcnt(0)
  v_readfirstlane_b32 s43, v110
  s_nop 3
  s_and_b32 s37, s43, s36
  s_cmp_eq_u32 s37, s36
  s_cbranch_scc1 L_sequential_preLN__sliding_block__dense_activation_relu__prompt_kernel_w4_eg5p10
  s_sub_u32 s31, s31, 1
  s_cmp_eq_u32 s31, 0
  s_cbranch_scc1 L_sequential_preLN__sliding_block__dense_activation_relu__prompt_kernel_w4_eg5p10
  s_nop 0
  s_branch L_sequential_preLN__sliding_block__dense_activation_relu__prompt_kernel_en_g5p10
L_sequential_preLN__sliding_block__dense_activation_relu__prompt_kernel_w4_eg5p10:
  s_waitcnt vmcnt(16)
  s_barrier
  s_cmp_eq_u32 s3, 4
  s_cbranch_scc0 L_sequential_preLN__sliding_block__dense_activation_relu__prompt_kernel_w4_g5r6
  buffer_load_dword v116, v109, s[12:15], 0 offen sc1
L_sequential_preLN__sliding_block__dense_activation_relu__prompt_kernel_w4_g5r6:
  s_add_u32 s22, s21, 2
  s_and_b32 s22, s22, 7
  s_mul_i32 s22, s22, 7
  s_add_u32 s22, s22, 6
  s_add_u32 s27, s21, 3
  s_and_b32 s27, s27, 7
  s_mul_i32 s27, s27, 7
  s_sub_u32 s27, s27, 1
  s_cmp_eq_u32 s42, 0
  s_cselect_b32 s22, s22, s27
  s_mul_i32 s22, s22, 131072
  s_add_u32 s24, s32, s22
  s_mov_b32 s23, 65536
  s_add_u32 m0, s23, s44
  s_nop 0
  buffer_load_dwordx4 v96, s[12:15], s24 offen offset:0 sc1 lds
  buffer_load_dwordx4 v96, s[12:15], s24 offen offset:1024 sc1 lds
  buffer_load_dwordx4 v96, s[12:15], s24 offen offset:2048 sc1 lds
  buffer_load_dwordx4 v96, s[12:15], s24 offen offset:3072 sc1 lds
  s_add_u32 s22, s21, 2
  s_and_b32 s22, s22, 7
  s_mul_i32 s22, s22, 7
  s_add_u32 s22, s22, 6
  s_add_u32 s27, s21, 3
  s_and_b32 s27, s27, 7
  s_mul_i32 s27, s27, 7
  s_sub_u32 s27, s27, 1
  s_cmp_eq_u32 s42, 0
  s_cselect_b32 s22, s22, s27
  s_mul_i32 s22, s22, 65536
  s_add_u32 s25, s33, s22
  s_mov_b32 s23, 65536
  s_add_u32 m0, s23, s45
  s_mov_b32 s30, s25
  buffer_load_dwordx4 v105, s[52:55], s30 offen lds
  s_add_u32 m0, m0, 1024
  s_nop 0
  buffer_load_dwordx4 v106, s[52:55], s30 offen lds
  s_add_u32 m0, m0, 1024
  s_add_u32 s30, s30, 16384
  buffer_load_dwordx4 v105, s[52:55], s30 offen lds
  s_add_u32 m0, m0, 1024
  s_nop 0
  buffer_load_dwordx4 v106, s[52:55], s30 offen lds
  s_cmp_eq_u32 s3, 4
  s_cbranch_scc0 L_sequential_preLN__sliding_block__dense_activation_relu__prompt_kernel_w4_g5m7
  v_readfirstlane_b32 s37, v117
  s_nop 3
  s_or_b32 s43, s43, s37
L_sequential_preLN__sliding_block__dense_activation_relu__prompt_kernel_w4_g5m7:
  s_waitcnt vmcnt(16)
  s_barrier
  s_cmp_eq_u32 s3, 4
  s_cbranch_scc0 L_sequential_preLN__sliding_block__dense_activation_relu__prompt_kernel_w4_g5r7
  buffer_load_dword v117, v109, s[12:15], 0 offen sc1
L_sequential_preLN__sliding_block__dense_activation_relu__prompt_kernel_w4_g5r7:
  s_add_u32 s22, s21, 3
  s_and_b32 s22, s22, 7
  s_mul_i32 s22, s22, 7
  s_add_u32 s22, s22, 1
  s_mul_i32 s22, s22, 131072
  s_add_u32 s24, s32, s22
  s_mov_b32 s23, 98304
  s_add_u32 m0, s23, s44
  s_nop 0
  buffer_load_dwordx4 v96, s[12:15], s24 offen offset:0 sc1 lds
  buffer_load_dwordx4 v96, s[12:15], s24 offen offset:1024 sc1 lds
  buffer_load_dwordx4 v96, s[12:15], s24 offen offset:2048 sc1 lds
  buffer_load_dwordx4 v96, s[12:15], s24 offen offset:3072 sc1 lds
  s_add_u32 s22, s21, 3
  s_and_b32 s22, s22, 7
  s_mul_i32 s22, s22, 7
  s_add_u32 s22, s22, 1
  s_mul_i32 s22, s22, 65536
  s_add_u32 s25, s33, s22
  s_mov_b32 s23, 98304
  s_add_u32 m0, s23, s45
  s_mov_b32 s30, s25
  buffer_load_dwordx4 v105, s[52:55], s30 offen lds
  s_add_u32 m0, m0, 1024
  s_nop 0
  buffer_load_dwordx4 v106, s[52:55], s30 offen lds
  s_add_u32 m0, m0, 1024
  s_add_u32 s30, s30, 16384
  buffer_load_dwordx4 v105, s[52:55], s30 offen lds
  s_add_u32 m0, m0, 1024
  s_nop 0
  buffer_load_dwordx4 v106, s[52:55], s30 offen lds
  s_cmp_eq_u32 s3, 4
  s_cbranch_scc0 L_sequential_preLN__sliding_block__dense_activation_relu__prompt_kernel_w4_g5m8
  v_readfirstlane_b32 s37, v111
  s_nop 3
  s_or_b32 s43, s43, s37
L_sequential_preLN__sliding_block__dense_activation_relu__prompt_kernel_w4_g5m8:
  s_waitcnt vmcnt(16)
  s_barrier
  s_cmp_eq_u32 s3, 4
  s_cbranch_scc0 L_sequential_preLN__sliding_block__dense_activation_relu__prompt_kernel_w4_g5r8
  buffer_load_dword v111, v109, s[12:15], 0 offen sc1
L_sequential_preLN__sliding_block__dense_activation_relu__prompt_kernel_w4_g5r8:
  s_add_u32 s22, s21, 3
  s_and_b32 s22, s22, 7
  s_mul_i32 s22, s22, 7
  s_add_u32 s22, s22, 3
  s_mul_i32 s22, s22, 131072
  s_add_u32 s24, s32, s22
  s_mov_b32 s23, 0
  s_add_u32 m0, s23, s44
  s_nop 0
  buffer_load_dwordx4 v96, s[12:15], s24 offen offset:0 sc1 lds
  buffer_load_dwordx4 v96, s[12:15], s24 offen offset:1024 sc1 lds
  buffer_load_dwordx4 v96, s[12:15], s24 offen offset:2048 sc1 lds
  buffer_load_dwordx4 v96, s[12:15], s24 offen offset:3072 sc1 lds
  s_add_u32 s22, s21, 3
  s_and_b32 s22, s22, 7
  s_mul_i32 s22, s22, 7
  s_add_u32 s22, s22, 3
  s_mul_i32 s22, s22, 65536
  s_add_u32 s25, s33, s22
  s_mov_b32 s23, 0
  s_add_u32 m0, s23, s45
  s_mov_b32 s30, s25
  buffer_load_dwordx4 v105, s[52:55], s30 offen lds
  s_add_u32 m0, m0, 1024
  s_nop 0
  buffer_load_dwordx4 v106, s[52:55], s30 offen lds
  s_add_u32 m0, m0, 1024
  s_add_u32 s30, s30, 16384
  buffer_load_dwordx4 v105, s[52:55], s30 offen lds
  s_add_u32 m0, m0, 1024
  s_nop 0
  buffer_load_dwordx4 v106, s[52:55], s30 offen lds
  s_cmp_eq_u32 s3, 4
  s_cbranch_scc0 L_sequential_preLN__sliding_block__dense_activation_relu__prompt_kernel_w4_g5m9
  v_readfirstlane_b32 s37, v112
  s_nop 3
  s_or_b32 s43, s43, s37
L_sequential_preLN__sliding_block__dense_activation_relu__prompt_kernel_w4_g5m9:
  s_waitcnt vmcnt(16)
  s_barrier
  s_cmp_eq_u32 s3, 4
  s_cbranch_scc0 L_sequential_preLN__sliding_block__dense_activation_relu__prompt_kernel_w4_g5r9
  buffer_load_dword v112, v109, s[12:15], 0 offen sc1
L_sequential_preLN__sliding_block__dense_activation_relu__prompt_kernel_w4_g5r9:
  s_add_u32 s22, s21, 3
  s_and_b32 s22, s22, 7
  s_mul_i32 s22, s22, 7
  s_add_u32 s22, s22, 5
  s_mul_i32 s22, s22, 131072
  s_add_u32 s24, s32, s22
  s_mov_b32 s23, 32768
  s_add_u32 m0, s23, s44
  s_nop 0
  buffer_load_dwordx4 v96, s[12:15], s24 offen offset:0 sc1 lds
  buffer_load_dwordx4 v96, s[12:15], s24 offen offset:1024 sc1 lds
  buffer_load_dwordx4 v96, s[12:15], s24 offen offset:2048 sc1 lds
  buffer_load_dwordx4 v96, s[12:15], s24 offen offset:3072 sc1 lds
  s_add_u32 s22, s21, 3
  s_and_b32 s22, s22, 7
  s_mul_i32 s22, s22, 7
  s_add_u32 s22, s22, 5
  s_mul_i32 s22, s22, 65536
  s_add_u32 s25, s33, s22
  s_mov_b32 s23, 32768
  s_add_u32 m0, s23, s45
  s_mov_b32 s30, s25
  buffer_load_dwordx4 v105, s[52:55], s30 offen lds
  s_add_u32 m0, m0, 1024
  s_nop 0
  buffer_load_dwordx4 v106, s[52:55], s30 offen lds
  s_add_u32 m0, m0, 1024
  s_add_u32 s30, s30, 16384
  buffer_load_dwordx4 v105, s[52:55], s30 offen lds
  s_add_u32 m0, m0, 1024
  s_nop 0
  buffer_load_dwordx4 v106, s[52:55], s30 offen lds
  s_cmp_eq_u32 s3, 4
  s_cbranch_scc0 L_sequential_preLN__sliding_block__dense_activation_relu__prompt_kernel_w4_g5m10
  v_readfirstlane_b32 s37, v116
  s_nop 3
  s_or_b32 s43, s43, s37
L_sequential_preLN__sliding_block__dense_activation_relu__prompt_kernel_w4_g5m10:
  s_cmp_eq_u32 s3, 4
  s_cbranch_scc0 L_sequential_preLN__sliding_block__dense_activation_relu__prompt_kernel_w4_eg5p14
  s_add_u32 s22, s21, 4
  s_and_b32 s22, s22, 7
  s_lshl_b32 s36, 1, s22
  s_and_b32 s37, s43, s36
  s_cmp_eq_u32 s37, s36
  s_cbranch_scc1 L_sequential_preLN__sliding_block__dense_activation_relu__prompt_kernel_w4_eg5p14
  s_mov_b32 s31, 40000
L_sequential_preLN__sliding_block__dense_activation_relu__prompt_kernel_en_g5p14:
  buffer_load_dword v110, v109, s[12:15], 0 offen sc1
  s_waitcnt vmcnt(0)
  v_readfirstlane_b32 s43, v110
  s_nop 3
  s_and_b32 s37, s43, s36
  s_cmp_eq_u32 s37, s36
  s_cbranch_scc1 L_sequential_preLN__sliding_block__dense_activation_relu__prompt_kernel_w4_eg5p14
  s_sub_u32 s31, s31, 1
  s_cmp_eq_u32 s31, 0
  s_cbranch_scc1 L_sequential_preLN__sliding_block__dense_activation_relu__prompt_kernel_w4_eg5p14
  s_nop 0
  s_branch L_sequential_preLN__sliding_block__dense_activation_relu__prompt_kernel_en_g5p14
L_sequential_preLN__sliding_block__dense_activation_relu__prompt_kernel_w4_eg5p14:
  s_waitcnt vmcnt(16)
  s_barrier
  s_cmp_eq_u32 s3, 4
  s_cbranch_scc0 L_sequential_preLN__sliding_block__dense_activation_relu__prompt_kernel_w4_g5r10
  buffer_load_dword v116, v109, s[12:15], 0 offen sc1
L_sequential_preLN__sliding_block__dense_activation_relu__prompt_kernel_w4_g5r10:
  s_add_u32 s22, s21, 4
  s_and_b32 s22, s22, 7
  s_mul_i32 s22, s22, 7
  s_add_u32 s22, s22, 0
  s_mul_i32 s22, s22, 131072
  s_add_u32 s24, s32, s22
  s_mov_b32 s23, 65536
  s_add_u32 m0, s23, s44
  s_nop 0
  buffer_load_dwordx4 v96, s[12:15], s24 offen offset:0 sc1 lds
  buffer_load_dwordx4 v96, s[12:15], s24 offen offset:1024 sc1 lds
  buffer_load_dwordx4 v96, s[12:15], s24 offen offset:2048 sc1 lds
  buffer_load_dwordx4 v96, s[12:15], s24 offen offset:3072 sc1 lds
  s_add_u32 s22, s21, 4
  s_and_b32 s22, s22, 7
  s_mul_i32 s22, s22, 7
  s_add_u32 s22, s22, 0
  s_mul_i32 s22, s22, 65536
  s_add_u32 s25, s33, s22
  s_mov_b32 s23, 65536
  s_add_u32 m0, s23, s45
  s_mov_b32 s30, s25
  buffer_load_dwordx4 v105, s[52:55], s30 offen lds
  s_add_u32 m0, m0, 1024
  s_nop 0
  buffer_load_dwordx4 v106, s[52:55], s30 offen lds
  s_add_u32 m0, m0, 1024
  s_add_u32 s30, s30, 16384
  buffer_load_dwordx4 v105, s[52:55], s30 offen lds
  s_add_u32 m0, m0, 1024
  s_nop 0
  buffer_load_dwordx4 v106, s[52:55], s30 offen lds
  s_cmp_eq_u32 s3, 4
  s_cbranch_scc0 L_sequential_preLN__sliding_block__dense_activation_relu__prompt_kernel_w4_g5m11
  v_readfirstlane_b32 s37, v117
  s_nop 3
  s_or_b32 s43, s43, s37
L_sequential_preLN__sliding_block__dense_activation_relu__prompt_kernel_w4_g5m11:
  s_waitcnt vmcnt(16)
  s_barrier
  s_cmp_eq_u32 s3, 4
  s_cbranch_scc0 L_sequential_preLN__sliding_block__dense_activation_relu__prompt_kernel_w4_g5r11
  buffer_load_dword v117, v109, s[12:15], 0 offen sc1
L_sequential_preLN__sliding_block__dense_activation_relu__prompt_kernel_w4_g5r11:
  s_add_u32 s22, s21, 4
  s_and_b32 s22, s22, 7
  s_mul_i32 s22, s22, 7
  s_add_u32 s22, s22, 2
  s_mul_i32 s22, s22, 131072
  s_add_u32 s24, s32, s22
  s_mov_b32 s23, 98304
  s_add_u32 m0, s23, s44
  s_nop 0
  buffer_load_dwordx4 v96, s[12:15], s24 offen offset:0 sc1 lds
  buffer_load_dwordx4 v96, s[12:15], s24 offen offset:1024 sc1 lds
  buffer_load_dwordx4 v96, s[12:15], s24 offen offset:2048 sc1 lds
  buffer_load_dwordx4 v96, s[12:15], s24 offen offset:3072 sc1 lds
  s_add_u32 s22, s21, 4
  s_and_b32 s22, s22, 7
  s_mul_i32 s22, s22, 7
  s_add_u32 s22, s22, 2
  s_mul_i32 s22, s22, 65536
  s_add_u32 s25, s33, s22
  s_mov_b32 s23, 98304
  s_add_u32 m0, s23, s45
  s_mov_b32 s30, s25
  buffer_load_dwordx4 v105, s[52:55], s30 offen lds
  s_add_u32 m0, m0, 1024
  s_nop 0
  buffer_load_dwordx4 v106, s[52:55], s30 offen lds
  s_add_u32 m0, m0, 1024
  s_add_u32 s30, s30, 16384
  buffer_load_dwordx4 v105, s[52:55], s30 offen lds
  s_add_u32 m0, m0, 1024
  s_nop 0
  buffer_load_dwordx4 v106, s[52:55], s30 offen lds
  s_cmp_eq_u32 s3, 4
  s_cbranch_scc0 L_sequential_preLN__sliding_block__dense_activation_relu__prompt_kernel_w4_g5m12
  v_readfirstlane_b32 s37, v111
  s_nop 3
  s_or_b32 s43, s43, s37
L_sequential_preLN__sliding_block__dense_activation_relu__prompt_kernel_w4_g5m12:
  s_waitcnt vmcnt(16)
  s_barrier
  s_cmp_eq_u32 s3, 4
  s_cbranch_scc0 L_sequential_preLN__sliding_block__dense_activation_relu__prompt_kernel_w4_g5r12
  buffer_load_dword v111, v109, s[12:15], 0 offen sc1
L_sequential_preLN__sliding_block__dense_activation_relu__prompt_kernel_w4_g5r12:
  s_add_u32 s22, s21, 4
  s_and_b32 s22, s22, 7
  s_mul_i32 s22, s22, 7
  s_add_u32 s22, s22, 4
  s_mul_i32 s22, s22, 131072
  s_add_u32 s24, s32, s22
  s_mov_b32 s23, 0
  s_add_u32 m0, s23, s44
  s_nop 0
  buffer_load_dwordx4 v96, s[12:15], s24 offen offset:0 sc1 lds
  buffer_load_dwordx4 v96, s[12:15], s24 offen offset:1024 sc1 lds
  buffer_load_dwordx4 v96, s[12:15], s24 offen offset:2048 sc1 lds
  buffer_load_dwordx4 v96, s[12:15], s24 offen offset:3072 sc1 lds
  s_add_u32 s22, s21, 4
  s_and_b32 s22, s22, 7
  s_mul_i32 s22, s22, 7
  s_add_u32 s22, s22, 4
  s_mul_i32 s22, s22, 65536
  s_add_u32 s25, s33, s22
  s_mov_b32 s23, 0
  s_add_u32 m0, s23, s45
  s_mov_b32 s30, s25
  buffer_load_dwordx4 v105, s[52:55], s30 offen lds
  s_add_u32 m0, m0, 1024
  s_nop 0
  buffer_load_dwordx4 v106, s[52:55], s30 offen lds
  s_add_u32 m0, m0, 1024
  s_add_u32 s30, s30, 16384
  buffer_load_dwordx4 v105, s[52:55], s30 offen lds
  s_add_u32 m0, m0, 1024
  s_nop 0
  buffer_load_dwordx4 v106, s[52:55], s30 offen lds
  s_cmp_eq_u32 s3, 4
  s_cbranch_scc0 L_sequential_preLN__sliding_block__dense_activation_relu__prompt_kernel_w4_g5m13
  v_readfirstlane_b32 s37, v112
  s_nop 3
  s_or_b32 s43, s43, s37
L_sequential_preLN__sliding_block__dense_activation_relu__prompt_kernel_w4_g5m13:
  s_cmp_eq_u32 s3, 4
  s_cbranch_scc0 L_sequential_preLN__sliding_block__dense_activation_relu__prompt_kernel_w4_eg5p17
  s_add_u32 s22, s21, 5
  s_and_b32 s22, s22, 7
  s_lshl_b32 s36, 1, s22
  s_and_b32 s37, s43, s36
  s_cmp_eq_u32 s37, s36
  s_cbranch_scc1 L_sequential_preLN__sliding_block__dense_activation_relu__prompt_kernel_w4_eg5p17
  s_mov_b32 s31, 40000
L_sequential_preLN__sliding_block__dense_activation_relu__prompt_kernel_en_g5p17:
  buffer_load_dword v110, v109, s[12:15], 0 offen sc1
  s_waitcnt vmcnt(0)
  v_readfirstlane_b32 s43, v110
  s_nop 3
  s_and_b32 s37, s43, s36
  s_cmp_eq_u32 s37, s36
  s_cbranch_scc1 L_sequential_preLN__sliding_block__dense_activation_relu__prompt_kernel_w4_eg5p17
  s_sub_u32 s31, s31, 1
  s_cmp_eq_u32 s31, 0
  s_cbranch_scc1 L_sequential_preLN__sliding_block__dense_activation_relu__prompt_kernel_w4_eg5p17
  s_nop 0
  s_branch L_sequential_preLN__sliding_block__dense_activation_relu__prompt_kernel_en_g5p17
L_sequential_preLN__sliding_block__dense_activation_relu__prompt_kernel_w4_eg5p17:
  s_waitcnt vmcnt(16)
  s_barrier
  s_cmp_eq_u32 s3, 4
  s_cbranch_scc0 L_sequential_preLN__sliding_block__dense_activation_relu__prompt_kernel_w4_g5r13
  buffer_load_dword v112, v109, s[12:15], 0 offen sc1
L_sequential_preLN__sliding_block__dense_activation_relu__prompt_kernel_w4_g5r13:
  s_add_u32 s22, s21, 4
  s_and_b32 s22, s22, 7
  s_mul_i32 s22, s22, 7
  s_add_u32 s22, s22, 6
  s_add_u32 s27, s21, 5
  s_and_b32 s27, s27, 7
  s_mul_i32 s27, s27, 7
  s_sub_u32 s27, s27, 1
  s_cmp_eq_u32 s42, 0
  s_cselect_b32 s22, s22, s27
  s_mul_i32 s22, s22, 131072
  s_add_u32 s24, s32, s22
  s_mov_b32 s23, 32768
  s_add_u32 m0, s23, s44
  s_nop 0
  buffer_load_dwordx4 v96, s[12:15], s24 offen offset:0 sc1 lds
  buffer_load_dwordx4 v96, s[12:15], s24 offen offset:1024 sc1 lds
  buffer_load_dwordx4 v96, s[12:15], s24 offen offset:2048 sc1 lds
  buffer_load_dwordx4 v96, s[12:15], s24 offen offset:3072 sc1 lds
  s_add_u32 s22, s21, 4
  s_and_b32 s22, s22, 7
  s_mul_i32 s22, s22, 7
  s_add_u32 s22, s22, 6
  s_add_u32 s27, s21, 5
  s_and_b32 s27, s27, 7
  s_mul_i32 s27, s27, 7
  s_sub_u32 s27, s27, 1
  s_cmp_eq_u32 s42, 0
  s_cselect_b32 s22, s22, s27
  s_mul_i32 s22, s22, 65536
  s_add_u32 s25, s33, s22
  s_mov_b32 s23, 32768
  s_add_u32 m0, s23, s45
  s_mov_b32 s30, s25
  buffer_load_dwordx4 v105, s[52:55], s30 offen lds
  s_add_u32 m0, m0, 1024
  s_nop 0
  buffer_load_dwordx4 v106, s[52:55], s30 offen lds
  s_add_u32 m0, m0, 1024
  s_add_u32 s30, s30, 16384
  buffer_load_dwordx4 v105, s[52:55], s30 offen lds
  s_add_u32 m0, m0, 1024
  s_nop 0
  buffer_load_dwordx4 v106, s[52:55], s30 offen lds
  s_cmp_eq_u32 s3, 4
  s_cbranch_scc0 L_sequential_preLN__sliding_block__dense_activation_relu__prompt_kernel_w4_g5m14
  v_readfirstlane_b32 s37, v116
  s_nop 3
  s_or_b32 s43, s43, s37
L_sequential_preLN__sliding_block__dense_activation_relu__prompt_kernel_w4_g5m14:
  s_waitcnt vmcnt(16)
  s_barrier
  s_cmp_eq_u32 s3, 4
  s_cbranch_scc0 L_sequential_preLN__sliding_block__dense_activation_relu__prompt_kernel_w4_g5r14
  buffer_load_dword v116, v109, s[12:15], 0 offen sc1
L_sequential_preLN__sliding_block__dense_activation_relu__prompt_kernel_w4_g5r14:
  s_add_u32 s22, s21, 5
  s_and_b32 s22, s22, 7
  s_mul_i32 s22, s22, 7
  s_add_u32 s22, s22, 1
  s_mul_i32 s22, s22, 131072
  s_add_u32 s24, s32, s22
  s_mov_b32 s23, 65536
  s_add_u32 m0, s23, s44
  s_nop 0
  buffer_load_dwordx4 v96, s[12:15], s24 offen offset:0 sc1 lds
  buffer_load_dwordx4 v96, s[12:15], s24 offen offset:1024 sc1 lds
  buffer_load_dwordx4 v96, s[12:15], s24 offen offset:2048 sc1 lds
  buffer_load_dwordx4 v96, s[12:15], s24 offen offset:3072 sc1 lds
  s_add_u32 s22, s21, 5
  s_and_b32 s22, s22, 7
  s_mul_i32 s22, s22, 7
  s_add_u32 s22, s22, 1
  s_mul_i32 s22, s22, 65536
  s_add_u32 s25, s33, s22
  s_mov_b32 s23, 65536
  s_add_u32 m0, s23, s45
  s_mov_b32 s30, s25
  buffer_load_dwordx4 v105, s[52:55], s30 offen lds
  s_add_u32 m0, m0, 1024
  s_nop 0
  buffer_load_dwordx4 v106, s[52:55], s30 offen lds
  s_add_u32 m0, m0, 1024
  s_add_u32 s30, s30, 16384
  buffer_load_dwordx4 v105, s[52:55], s30 offen lds
  s_add_u32 m0, m0, 1024
  s_nop 0
  buffer_load_dwordx4 v106, s[52:55], s30 offen lds
  s_cmp_eq_u32 s3, 4
  s_cbranch_scc0 L_sequential_preLN__sliding_block__dense_activation_relu__prompt_kernel_w4_g5m15
  v_readfirstlane_b32 s37, v117
  s_nop 3
  s_or_b32 s43, s43, s37
L_sequential_preLN__sliding_block__dense_activation_relu__prompt_kernel_w4_g5m15:
  s_waitcnt vmcnt(16)
  s_barrier
  s_cmp_eq_u32 s3, 4
  s_cbranch_scc0 L_sequential_preLN__sliding_block__dense_activation_relu__prompt_kernel_w4_g5r15
  buffer_load_dword v117, v109, s[12:15], 0 offen sc1
L_sequential_preLN__sliding_block__dense_activation_relu__prompt_kernel_w4_g5r15:
  s_add_u32 s22, s21, 5
  s_and_b32 s22, s22, 7
  s_mul_i32 s22, s22, 7
  s_add_u32 s22, s22, 3
  s_mul_i32 s22, s22, 131072
  s_add_u32 s24, s32, s22
  s_mov_b32 s23, 98304
  s_add_u32 m0, s23, s44
  s_nop 0
  buffer_load_dwordx4 v96, s[12:15], s24 offen offset:0 sc1 lds
  buffer_load_dwordx4 v96, s[12:15], s24 offen offset:1024 sc1 lds
  buffer_load_dwordx4 v96, s[12:15], s24 offen offset:2048 sc1 lds
  buffer_load_dwordx4 v96, s[12:15], s24 offen offset:3072 sc1 lds
  s_add_u32 s22, s21, 5
  s_and_b32 s22, s22, 7
  s_mul_i32 s22, s22, 7
  s_add_u32 s22, s22, 3
  s_mul_i32 s22, s22, 65536
  s_add_u32 s25, s33, s22
  s_mov_b32 s23, 98304
  s_add_u32 m0, s23, s45
  s_mov_b32 s30, s25
  buffer_load_dwordx4 v105, s[52:55], s30 offen lds
  s_add_u32 m0, m0, 1024
  s_nop 0
  buffer_load_dwordx4 v106, s[52:55], s30 offen lds
  s_add_u32 m0, m0, 1024
  s_add_u32 s30, s30, 16384
  buffer_load_dwordx4 v105, s[52:55], s30 offen lds
  s_add_u32 m0, m0, 1024
  s_nop 0
  buffer_load_dwordx4 v106, s[52:55], s30 offen lds
  s_cmp_eq_u32 s3, 4
  s_cbranch_scc0 L_sequential_preLN__sliding_block__dense_activation_relu__prompt_kernel_w4_g5m16
  v_readfirstlane_b32 s37, v111
  s_nop 3
  s_or_b32 s43, s43, s37
L_sequential_preLN__sliding_block__dense_activation_relu__prompt_kernel_w4_g5m16:
  s_waitcnt vmcnt(16)
  s_barrier
  s_cmp_eq_u32 s3, 4
  s_cbranch_scc0 L_sequential_preLN__sliding_block__dense_activation_relu__prompt_kernel_w4_g5r16
  buffer_load_dword v111, v109, s[12:15], 0 offen sc1
L_sequential_preLN__sliding_block__dense_activation_relu__prompt_kernel_w4_g5r16:
  s_add_u32 s22, s21, 5
  s_and_b32 s22, s22, 7
  s_mul_i32 s22, s22, 7
  s_add_u32 s22, s22, 5
  s_mul_i32 s22, s22, 131072
  s_add_u32 s24, s32, s22
  s_mov_b32 s23, 0
  s_add_u32 m0, s23, s44
  s_nop 0
  buffer_load_dwordx4 v96, s[12:15], s24 offen offset:0 sc1 lds
  buffer_load_dwordx4 v96, s[12:15], s24 offen offset:1024 sc1 lds
  buffer_load_dwordx4 v96, s[12:15], s24 offen offset:2048 sc1 lds
  buffer_load_dwordx4 v96, s[12:15], s24 offen offset:3072 sc1 lds
  s_add_u32 s22, s21, 5
  s_and_b32 s22, s22, 7
  s_mul_i32 s22, s22, 7
  s_add_u32 s22, s22, 5
  s_mul_i32 s22, s22, 65536
  s_add_u32 s25, s33, s22
  s_mov_b32 s23, 0
  s_add_u32 m0, s23, s45
  s_mov_b32 s30, s25
  buffer_load_dwordx4 v105, s[52:55], s30 offen lds
  s_add_u32 m0, m0, 1024
  s_nop 0
  buffer_load_dwordx4 v106, s[52:55], s30 offen lds
  s_add_u32 m0, m0, 1024
  s_add_u32 s30, s30, 16384
  buffer_load_dwordx4 v105, s[52:55], s30 offen lds
  s_add_u32 m0, m0, 1024
  s_nop 0
  buffer_load_dwordx4 v106, s[52:55], s30 offen lds
  s_cmp_eq_u32 s3, 4
  s_cbranch_scc0 L_sequential_preLN__sliding_block__dense_activation_relu__prompt_kernel_w4_g5m17
  v_readfirstlane_b32 s37, v112
  s_nop 3
  s_or_b32 s43, s43, s37
L_sequential_preLN__sliding_block__dense_activation_relu__prompt_kernel_w4_g5m17:
  s_cmp_eq_u32 s3, 4
  s_cbranch_scc0 L_sequential_preLN__sliding_block__dense_activation_relu__prompt_kernel_w4_eg5p21
  s_add_u32 s22, s21, 6
  s_and_b32 s22, s22, 7
  s_lshl_b32 s36, 1, s22
  s_and_b32 s37, s43, s36
  s_cmp_eq_u32 s37, s36
  s_cbranch_scc1 L_sequential_preLN__sliding_block__dense_activation_relu__prompt_kernel_w4_eg5p21
  s_mov_b32 s31, 40000
L_sequential_preLN__sliding_block__dense_activation_relu__prompt_kernel_en_g5p21:
  buffer_load_dword v110, v109, s[12:15], 0 offen sc1
  s_waitcnt vmcnt(0)
  v_readfirstlane_b32 s43, v110
  s_nop 3
  s_and_b32 s37, s43, s36
  s_cmp_eq_u32 s37, s36
  s_cbranch_scc1 L_sequential_preLN__sliding_block__dense_activation_relu__prompt_kernel_w4_eg5p21
  s_sub_u32 s31, s31, 1
  s_cmp_eq_u32 s31, 0
  s_cbranch_scc1 L_sequential_preLN__sliding_block__dense_activation_relu__prompt_kernel_w4_eg5p21
  s_nop 0
  s_branch L_sequential_preLN__sliding_block__dense_activation_relu__prompt_kernel_en_g5p21
L_sequential_preLN__sliding_block__dense_activation_relu__prompt_kernel_w4_eg5p21:
  s_waitcnt vmcnt(16)
  s_barrier
  s_add_u32 s22, s21, 6
  s_and_b32 s22, s22, 7
  s_mul_i32 s22, s22, 7
  s_add_u32 s22, s22, 0
  s_mul_i32 s22, s22, 131072
  s_add_u32 s24, s32, s22
  s_mov_b32 s23, 32768
  s_add_u32 m0, s23, s44
  s_nop 0
  buffer_load_dwordx4 v96, s[12:15], s24 offen offset:0 sc1 lds
  buffer_load_dwordx4 v96, s[12:15], s24 offen offset:1024 sc1 lds
  buffer_load_dwordx4 v96, s[12:15], s24 offen offset:2048 sc1 lds
  buffer_load_dwordx4 v96, s[12:15], s24 offen offset:3072 sc1 lds
  s_add_u32 s22, s21, 6
  s_and_b32 s22, s22, 7
  s_mul_i32 s22, s22, 7
  s_add_u32 s22, s22, 0
  s_mul_i32 s22, s22, 65536
  s_add_u32 s25, s33, s22
  s_mov_b32 s23, 32768
  s_add_u32 m0, s23, s45
  s_mov_b32 s30, s25
  buffer_load_dwordx4 v105, s[52:55], s30 offen lds
  s_add_u32 m0, m0, 1024
  s_nop 0
  buffer_load_dwordx4 v106, s[52:55], s30 offen lds
  s_add_u32 m0, m0, 1024
  s_add_u32 s30, s30, 16384
  buffer_load_dwordx4 v105, s[52:55], s30 offen lds
  s_add_u32 m0, m0, 1024
  s_nop 0
  buffer_load_dwordx4 v106, s[52:55], s30 offen lds
  s_cmp_eq_u32 s3, 4
  s_cbranch_scc0 L_sequential_preLN__sliding_block__dense_activation_relu__prompt_kernel_w4_g5m18
  v_readfirstlane_b32 s37, v116
  s_nop 3
  s_or_b32 s43, s43, s37
L_sequential_preLN__sliding_block__dense_activation_relu__prompt_kernel_w4_g5m18:
  s_waitcnt vmcnt(16)
  s_barrier
  s_add_u32 s22, s21, 6
  s_and_b32 s22, s22, 7
  s_mul_i32 s22, s22, 7
  s_add_u32 s22, s22, 2
  s_mul_i32 s22, s22, 131072
  s_add_u32 s24, s32, s22
  s_mov_b32 s23, 65536
  s_add_u32 m0, s23, s44
  s_nop 0
  buffer_load_dwordx4 v96, s[12:15], s24 offen offset:0 sc1 lds
  buffer_load_dwordx4 v96, s[12:15], s24 offen offset:1024 sc1 lds
  buffer_load_dwordx4 v96, s[12:15], s24 offen offset:2048 sc1 lds
  buffer_load_dwordx4 v96, s[12:15], s24 offen offset:3072 sc1 lds
  s_add_u32 s22, s21, 6
  s_and_b32 s22, s22, 7
  s_mul_i32 s22, s22, 7
  s_add_u32 s22, s22, 2
  s_mul_i32 s22, s22, 65536
  s_add_u32 s25, s33, s22
  s_mov_b32 s23, 65536
  s_add_u32 m0, s23, s45
  s_mov_b32 s30, s25
  buffer_load_dwordx4 v105, s[52:55], s30 offen lds
  s_add_u32 m0, m0, 1024
  s_nop 0
  buffer_load_dwordx4 v106, s[52:55], s30 offen lds
  s_add_u32 m0, m0, 1024
  s_add_u32 s30, s30, 16384
  buffer_load_dwordx4 v105, s[52:55], s30 offen lds
  s_add_u32 m0, m0, 1024
  s_nop 0
  buffer_load_dwordx4 v106, s[52:55], s30 offen lds
  s_cmp_eq_u32 s3, 4
  s_cbranch_scc0 L_sequential_preLN__sliding_block__dense_activation_relu__prompt_kernel_w4_g5m19
  v_readfirstlane_b32 s37, v117
  s_nop 3
  s_or_b32 s43, s43, s37
L_sequential_preLN__sliding_block__dense_activation_relu__prompt_kernel_w4_g5m19:
  s_waitcnt vmcnt(16)
  s_barrier
  s_add_u32 s22, s21, 6
  s_and_b32 s22, s22, 7
  s_mul_i32 s22, s22, 7
  s_add_u32 s22, s22, 4
  s_mul_i32 s22, s22, 131072
  s_add_u32 s24, s32, s22
  s_mov_b32 s23, 98304
  s_add_u32 m0, s23, s44
  s_nop 0
  buffer_load_dwordx4 v96, s[12:15], s24 offen offset:0 sc1 lds
  buffer_load_dwordx4 v96, s[12:15], s24 offen offset:1024 sc1 lds
  buffer_load_dwordx4 v96, s[12:15], s24 offen offset:2048 sc1 lds
  buffer_load_dwordx4 v96, s[12:15], s24 offen offset:3072 sc1 lds
  s_add_u32 s22, s21, 6
  s_and_b32 s22, s22, 7
  s_mul_i32 s22, s22, 7
  s_add_u32 s22, s22, 4
  s_mul_i32 s22, s22, 65536
  s_add_u32 s25, s33, s22
  s_mov_b32 s23, 98304
  s_add_u32 m0, s23, s45
  s_mov_b32 s30, s25
  buffer_load_dwordx4 v105, s[52:55], s30 offen lds
  s_add_u32 m0, m0, 1024
  s_nop 0
  buffer_load_dwordx4 v106, s[52:55], s30 offen lds
  s_add_u32 m0, m0, 1024
  s_add_u32 s30, s30, 16384
  buffer_load_dwordx4 v105, s[52:55], s30 offen lds
  s_add_u32 m0, m0, 1024
  s_nop 0
  buffer_load_dwordx4 v106, s[52:55], s30 offen lds
  s_cmp_eq_u32 s3, 4
  s_cbranch_scc0 L_sequential_preLN__sliding_block__dense_activation_relu__prompt_kernel_w4_g5m20
  v_readfirstlane_b32 s37, v111
  s_nop 3
  s_or_b32 s43, s43, s37
L_sequential_preLN__sliding_block__dense_activation_relu__prompt_kernel_w4_g5m20:
  s_cmp_eq_u32 s3, 4
  s_cbranch_scc0 L_sequential_preLN__sliding_block__dense_activation_relu__prompt_kernel_w4_eg5p24
  s_add_u32 s22, s21, 7
  s_and_b32 s22, s22, 7
  s_lshl_b32 s36, 1, s22
  s_and_b32 s37, s43, s36
  s_cmp_eq_u32 s37, s36
  s_cbranch_scc1 L_sequential_preLN__sliding_block__dense_activation_relu__prompt_kernel_w4_eg5p24
  s_mov_b32 s31, 40000
L_sequential_preLN__sliding_block__dense_activation_relu__prompt_kernel_en_g5p24:
  buffer_load_dword v110, v109, s[12:15], 0 offen sc1
  s_waitcnt vmcnt(0)
  v_readfirstlane_b32 s43, v110
  s_nop 3
  s_and_b32 s37, s43, s36
  s_cmp_eq_u32 s37, s36
  s_cbranch_scc1 L_sequential_preLN__sliding_block__dense_activation_relu__prompt_kernel_w4_eg5p24
  s_sub_u32 s31, s31, 1
  s_cmp_eq_u32 s31, 0
  s_cbranch_scc1 L_sequential_preLN__sliding_block__dense_activation_relu__prompt_kernel_w4_eg5p24
  s_nop 0
  s_branch L_sequential_preLN__sliding_block__dense_activation_relu__prompt_kernel_en_g5p24
L_sequential_preLN__sliding_block__dense_activation_relu__prompt_kernel_w4_eg5p24:
  s_waitcnt vmcnt(16)
  s_barrier
  s_add_u32 s22, s21, 6
  s_and_b32 s22, s22, 7
  s_mul_i32 s22, s22, 7
  s_add_u32 s22, s22, 6
  s_add_u32 s27, s21, 7
  s_and_b32 s27, s27, 7
  s_mul_i32 s27, s27, 7
  s_sub_u32 s27, s27, 1
  s_cmp_eq_u32 s42, 0
  s_cselect_b32 s22, s22, s27
  s_mul_i32 s22, s22, 131072
  s_add_u32 s24, s32, s22
  s_mov_b32 s23, 0
  s_add_u32 m0, s23, s44
  s_nop 0
  buffer_load_dwordx4 v96, s[12:15], s24 offen offset:0 sc1 lds
  buffer_load_dwordx4 v96, s[12:15], s24 offen offset:1024 sc1 lds
  buffer_load_dwordx4 v96, s[12:15], s24 offen offset:2048 sc1 lds
  buffer_load_dwordx4 v96, s[12:15], s24 offen offset:3072 sc1 lds
  s_add_u32 s22, s21, 6
  s_and_b32 s22, s22, 7
  s_mul_i32 s22, s22, 7
  s_add_u32 s22, s22, 6
  s_add_u32 s27, s21, 7
  s_and_b32 s27, s27, 7
  s_mul_i32 s27, s27, 7
  s_sub_u32 s27, s27, 1
  s_cmp_eq_u32 s42, 0
  s_cselect_b32 s22, s22, s27
  s_mul_i32 s22, s22, 65536
  s_add_u32 s25, s33, s22
  s_mov_b32 s23, 0
  s_add_u32 m0, s23, s45
  s_mov_b32 s30, s25
  buffer_load_dwordx4 v105, s[52:55], s30 offen lds
  s_add_u32 m0, m0, 1024
  s_nop 0
  buffer_load_dwordx4 v106, s[52:55], s30 offen lds
  s_add_u32 m0, m0, 1024
  s_add_u32 s30, s30, 16384
  buffer_load_dwordx4 v105, s[52:55], s30 offen lds
  s_add_u32 m0, m0, 1024
  s_nop 0
  buffer_load_dwordx4 v106, s[52:55], s30 offen lds
  s_waitcnt vmcnt(16)
  s_barrier
  s_add_u32 s22, s21, 7
  s_and_b32 s22, s22, 7
  s_mul_i32 s22, s22, 7
  s_add_u32 s22, s22, 1
  s_mul_i32 s22, s22, 131072
  s_add_u32 s24, s32, s22
  s_mov_b32 s23, 32768
  s_add_u32 m0, s23, s44
  s_nop 0
  buffer_load_dwordx4 v96, s[12:15], s24 offen offset:0 sc1 lds
  buffer_load_dwordx4 v96, s[12:15], s24 offen offset:1024 sc1 lds
  buffer_load_dwordx4 v96, s[12:15], s24 offen offset:2048 sc1 lds
  buffer_load_dwordx4 v96, s[12:15], s24 offen offset:3072 sc1 lds
  s_add_u32 s22, s21, 7
  s_and_b32 s22, s22, 7
  s_mul_i32 s22, s22, 7
  s_add_u32 s22, s22, 1
  s_mul_i32 s22, s22, 65536
  s_add_u32 s25, s33, s22
  s_mov_b32 s23, 32768
  s_add_u32 m0, s23, s45
  s_mov_b32 s30, s25
  buffer_load_dwordx4 v105, s[52:55], s30 offen lds
  s_add_u32 m0, m0, 1024
  s_nop 0
  buffer_load_dwordx4 v106, s[52:55], s30 offen lds
  s_add_u32 m0, m0, 1024
  s_add_u32 s30, s30, 16384
  buffer_load_dwordx4 v105, s[52:55], s30 offen lds
  s_add_u32 m0, m0, 1024
  s_nop 0
  buffer_load_dwordx4 v106, s[52:55], s30 offen lds
  s_waitcnt vmcnt(16)
  s_barrier
  s_add_u32 s22, s21, 7
  s_and_b32 s22, s22, 7
  s_mul_i32 s22, s22, 7
  s_add_u32 s22, s22, 3
  s_mul_i32 s22, s22, 131072
  s_add_u32 s24, s32, s22
  s_mov_b32 s23, 65536
  s_add_u32 m0, s23, s44
  s_nop 0
  buffer_load_dwordx4 v96, s[12:15], s24 offen offset:0 sc1 lds
  buffer_load_dwordx4 v96, s[12:15], s24 offen offset:1024 sc1 lds
  buffer_load_dwordx4 v96, s[12:15], s24 offen offset:2048 sc1 lds
  buffer_load_dwordx4 v96, s[12:15], s24 offen offset:3072 sc1 lds
  s_add_u32 s22, s21, 7
  s_and_b32 s22, s22, 7
  s_mul_i32 s22, s22, 7
  s_add_u32 s22, s22, 3
  s_mul_i32 s22, s22, 65536
  s_add_u32 s25, s33, s22
  s_mov_b32 s23, 65536
  s_add_u32 m0, s23, s45
  s_mov_b32 s30, s25
  buffer_load_dwordx4 v105, s[52:55], s30 offen lds
  s_add_u32 m0, m0, 1024
  s_nop 0
  buffer_load_dwordx4 v106, s[52:55], s30 offen lds
  s_add_u32 m0, m0, 1024
  s_add_u32 s30, s30, 16384
  buffer_load_dwordx4 v105, s[52:55], s30 offen lds
  s_add_u32 m0, m0, 1024
  s_nop 0
  buffer_load_dwordx4 v106, s[52:55], s30 offen lds
  s_waitcnt vmcnt(16)
  s_barrier
  s_add_u32 s22, s21, 7
  s_and_b32 s22, s22, 7
  s_mul_i32 s22, s22, 7
  s_add_u32 s22, s22, 5
  s_mul_i32 s22, s22, 131072
  s_add_u32 s24, s32, s22
  s_mov_b32 s23, 98304
  s_add_u32 m0, s23, s44
  s_nop 0
  buffer_load_dwordx4 v96, s[12:15], s24 offen offset:0 sc1 lds
  buffer_load_dwordx4 v96, s[12:15], s24 offen offset:1024 sc1 lds
  buffer_load_dwordx4 v96, s[12:15], s24 offen offset:2048 sc1 lds
  buffer_load_dwordx4 v96, s[12:15], s24 offen offset:3072 sc1 lds
  s_add_u32 s22, s21, 7
  s_and_b32 s22, s22, 7
  s_mul_i32 s22, s22, 7
  s_add_u32 s22, s22, 5
  s_mul_i32 s22, s22, 65536
  s_add_u32 s25, s33, s22
  s_mov_b32 s23, 98304
  s_add_u32 m0, s23, s45
  s_mov_b32 s30, s25
  buffer_load_dwordx4 v105, s[52:55], s30 offen lds
  s_add_u32 m0, m0, 1024
  s_nop 0
  buffer_load_dwordx4 v106, s[52:55], s30 offen lds
  s_add_u32 m0, m0, 1024
  s_add_u32 s30, s30, 16384
  buffer_load_dwordx4 v105, s[52:55], s30 offen lds
  s_add_u32 m0, m0, 1024
  s_nop 0
  buffer_load_dwordx4 v106, s[52:55], s30 offen lds
  s_waitcnt vmcnt(16)
  s_barrier
  s_waitcnt vmcnt(8)
  s_barrier
  s_waitcnt vmcnt(0)
  s_barrier
  s_barrier
L_sequential_preLN__sliding_block__dense_activation_relu__prompt_kernel_end:
  s_endpgm
.section .rodata,"a"
.p2align 6
.amdhsa_kernel sequential_preLN__sliding_block__dense_activation_relu__prompt_kernel
  .amdhsa_next_free_vgpr 217
  .amdhsa_next_free_sgpr 102
  .amdhsa_accum_offset 128
  .amdhsa_group_segment_fixed_size 0
  .amdhsa_kernarg_size 72
  .amdhsa_user_sgpr_count 2
  .amdhsa_user_sgpr_kernarg_segment_ptr 1
  .amdhsa_system_sgpr_workgroup_id_x 1
.end_amdhsa_kernel
```
